```python
import torch

def _softmax(x, axis=-1):
    return torch.softmax(x, dim=axis)
def _gelu(x):
    return torch.nn.functional.gelu(x, approximate="tanh")
def _silu(x):
    return torch.nn.functional.silu(x)
def _sigmoid(x):
    return torch.sigmoid(x)
def _layernorm(x, axis=-1, eps=1e-5):
    m = x.mean(dim=axis, keepdim=True)
    v = x.var(dim=axis, keepdim=True, unbiased=False)
    return (x - m) / torch.sqrt(v + eps)
def _scatter_add(tgt, idx, src, axis=0):
    return tgt.clone().index_add_(axis, idx, src)
def _segment_sum(src, seg, n):
    out = torch.zeros((n,) + src.shape[1:], dtype=src.dtype)
    return out.index_add_(0, seg, src)
def _pad(x, pw):
    flat = tuple(v for pair in reversed(pw) for v in pair)
    return torch.nn.functional.pad(x, flat)

kernel_name = 'sequential_preLN__mha_block_cached__geglu_ffn__decode'

def setup_inputs():

    _w = (lambda a: (lambda t: t.to(torch.bfloat16) if t.is_floating_point() else t)(torch.as_tensor(a)))
    def _A_setup():
        B, Sq, D = 2, 1, 640
        H, Sk, Dh = 32, 8192, 128
        return {
            "x": _w((lambda *s: torch.randn(*s, dtype=torch.bfloat16) * 0.05)(B, Sq, D)),
            "k_cache": _w((lambda *s: torch.randn(*s, dtype=torch.bfloat16) * 3.2)(B, H, Sk, Dh)),
            "v_cache": _w((lambda *s: torch.randn(*s, dtype=torch.bfloat16) * 0.4)(B, H, Sk, Dh)),
            "wq": _w((lambda *s: torch.randn(*s, dtype=torch.bfloat16) * 3.2)(D, H * Dh) * (D ** -0.5)),
            "wo": _w((lambda *s: torch.randn(*s, dtype=torch.bfloat16) * 0.4)(H * Dh, D) * ((H * Dh) ** -0.5)),
        }
    _A_in = _A_setup()

    def _B_setup():
        B, S, D, F = 2, 1, 640, 1728
        return {
            "x": _w((lambda *s: torch.randn(*s, dtype=torch.bfloat16) * 0.05)(B, S, D)),
            "w_gate": _w((lambda *s: torch.randn(*s, dtype=torch.bfloat16) * 0.05)(D, F)),
            "w_up": _w((lambda *s: torch.randn(*s, dtype=torch.bfloat16) * 0.05)(D, F)),
            "w_down": _w((lambda *s: torch.randn(*s, dtype=torch.bfloat16) * 0.05)(F, D)),
        }
    _B_in = _B_setup()

    return {
        "A_x": _A_in["x"],
        "A_k_cache": _A_in["k_cache"],
        "A_v_cache": _A_in["v_cache"],
        "A_wq": _A_in["wq"],
        "A_wo": _A_in["wo"],
        "B_x": _B_in["x"],
        "B_w_gate": _B_in["w_gate"],
        "B_w_up": _B_in["w_up"],
        "B_w_down": _B_in["w_down"],
    }

def reference(A_x, A_k_cache, A_v_cache, A_wq, A_wo, B_x, B_w_gate, B_w_up, B_w_down):
    def _A_ref(x, k_cache, v_cache, wq, wo):
        B, Sq, D = x.shape
        H, Dh = 32, 128
        q = (lambda x, *d: x.permute(*d))((x @ wq).reshape(B, Sq, H, Dh), 0, 2, 1, 3)
        scores = torch.einsum("bhqd,bhkd->bhqk", q, k_cache) * (Dh ** -0.5)
        p = _softmax(scores, axis=-1)
        o = torch.einsum("bhqk,bhkd->bhqd", p, v_cache)
        return (lambda x, *d: x.permute(*d))(o, 0, 2, 1, 3).reshape(B, Sq, H * Dh) @ wo

    def _B_ref(x, w_gate, w_up, w_down):
        return (_gelu(x @ w_gate) * (x @ w_up)) @ w_down

    x = A_x
    h = x + _A_ref(_layernorm(x, axis=-1), A_k_cache, A_v_cache, A_wq, A_wo)
    h2 = h + _B_ref(_layernorm(h, axis=-1), B_w_gate, B_w_up, B_w_down)
    return h2
```

```asm
; @launch grid=(256,1,1) block=(512,1,1) lds=24576
.amdgcn_target "amdgcn-amd-amdhsa--gfx950"
.text
.globl sequential_preLN__mha_block_cached__geglu_ffn__decode_kernel
.p2align 8
.type sequential_preLN__mha_block_cached__geglu_ffn__decode_kernel,@function
sequential_preLN__mha_block_cached__geglu_ffn__decode_kernel:
    s_cmp_ge_u32 s2, 256
    s_cbranch_scc1 L_exit
    s_load_dwordx8 s[8:15], s[0:1], 0
    s_getpc_b64 s[4:5]
L_pc:
    s_lshr_b32 s3, s2, 4
    v_lshrrev_b32 v4, 4, v0
    v_lshlrev_b32 v4, 4, v4
    v_add_lshl_u32 v4, v4, s3, 7
    v_min_u32 v4, L_code_end-L_pc-4, v4
    global_load_dword v4, v4, s[4:5]
    v_lshrrev_b32 v5, 6, v0
    v_and_b32 v1, 63, v0
    v_readfirstlane_b32 s3, v5
    s_and_b32 s72, s2, 7
    s_lshr_b32 s73, s2, 3
    s_lshl_b32 s6, s72, 5
    s_add_u32 s6, s6, s73
    s_lshr_b32 s74, s6, 3
    s_and_b32 s75, s6, 7
    s_and_b32 s76, s3, 3
    v_and_b32 v6, 15, v1
    v_lshrrev_b32 v7, 4, v1
    s_mov_b32 s42, 0x00280000
    s_mov_b32 s43, 0x20000
    s_mov_b32 s79, 1048576
    s_cmp_lt_u32 s3, 4
    s_cbranch_scc1 L_aux0
    s_setprio 2
    v_bfe_u32 v8, v1, 2, 2
    v_lshlrev_b32 v8, 8, v8
    v_lshl_or_b32 v8, v7, 6, v8
    v_and_b32 v9, 3, v1
    v_lshl_or_b32 v2, v9, 4, v8
    s_and_b32 s80, s75, 3
    s_cselect_b32 s71, 0, 0x80000000
    s_lshl_b32 s70, s75, 18
    s_lshl_b32 s7, s74, 21
    s_lshl_b32 s80, s76, 10
    s_add_u32 s7, s7, s80
    v_add_u32 v2, s7, v2
    v_lshl_add_u32 v3, v1, 4, s7
    s_mov_b32 s34, 0x08000000
    s_mov_b32 s35, 0x20000
    s_mov_b32 s38, 0x08000000
    s_mov_b32 s39, 0x20000
    s_waitcnt lgkmcnt(0)
    s_mov_b64 s[32:33], s[10:11]
    s_mov_b64 s[36:37], s[12:13]
    s_add_u32 s7, s70, 0x00000000
    s_or_b32 s73, s7, s71
    buffer_load_dwordx4 v[100:103], v2, s[32:35], s73 offen nt
    s_addk_i32 s7, 0x1000
    buffer_load_dwordx4 v[104:107], v2, s[32:35], s7 offen nt
    s_addk_i32 s7, 0x1000
    buffer_load_dwordx4 v[108:111], v2, s[32:35], s7 offen nt
    s_addk_i32 s7, 0x1000
    buffer_load_dwordx4 v[112:115], v2, s[32:35], s7 offen nt
    s_addk_i32 s7, 0x1000
    buffer_load_dwordx4 v[116:119], v2, s[32:35], s7 offen nt
    s_load_dwordx2 s[40:41], s[0:1], 88
    s_barrier
    s_branch L_stream
L_aux0:
    v_lshlrev_b32 v96, 4, v0
    v_mov_b32 v112, -1
    v_mov_b32 v113, -1
    v_mov_b32 v114, -1
    v_mov_b32 v115, -1
    ds_write_b128 v96, v[112:115]
    ds_write_b128 v96, v[112:115] offset:4096
    v_and_b32 v8, 31, v1
    v_lshlrev_b32 v8, 3, v8
    v_lshrrev_b32 v9, 5, v1
    v_mul_u32_u24 v9, 1280, v9
    v_add_u32 v2, v8, v9
    s_mul_i32 s7, s75, 80
    s_mul_i32 s80, s76, 20
    s_add_u32 s7, s7, s80
    v_add_u32 v8, s7, v7
    v_bfe_u32 v9, v1, 3, 1
    v_mul_u32_u24 v9, 1280, v9
    v_lshl_add_u32 v3, v8, 1, v9
    s_lshl_b32 s7, s74, 8
    v_lshlrev_b32 v8, 13, v8
    v_lshl_add_u32 v9, v6, 4, s7
    v_add_u32 v5, v8, v9
    s_mov_b32 s46, 0x00000a00
    s_mov_b32 s47, 0x20000
    s_mov_b32 s50, 0x00500000
    s_mov_b32 s51, 0x20000
    s_mov_b32 s7, 0
    s_waitcnt lgkmcnt(0)
    s_mov_b64 s[44:45], s[8:9]
    s_mov_b64 s[48:49], s[14:15]
    buffer_load_dwordx2 v[8:9], v2, s[44:47], 0 offen offset:0
    buffer_load_dwordx2 v[10:11], v2, s[44:47], 0 offen offset:256
    buffer_load_dwordx2 v[12:13], v2, s[44:47], 0 offen offset:512
    buffer_load_dwordx2 v[14:15], v2, s[44:47], 0 offen offset:768
    buffer_load_dwordx2 v[16:17], v2, s[44:47], 0 offen offset:1024
    buffer_load_ushort v18, v3, s[44:47], 0 offen offset:0
    buffer_load_ushort v19, v3, s[44:47], 0 offen offset:8
    buffer_load_ushort v20, v3, s[44:47], 0 offen offset:16
    buffer_load_ushort v21, v3, s[44:47], 0 offen offset:24
    buffer_load_ushort v22, v3, s[44:47], 0 offen offset:32
    buffer_load_dwordx4 v[24:27], v5, s[48:51], s7 offen nt
    s_add_u32 s7, s7, 0x8000
    buffer_load_dwordx4 v[28:31], v5, s[48:51], s7 offen nt
    s_add_u32 s7, s7, 0x8000
    buffer_load_dwordx4 v[32:35], v5, s[48:51], s7 offen nt
    s_add_u32 s7, s7, 0x8000
    buffer_load_dwordx4 v[36:39], v5, s[48:51], s7 offen nt
    s_add_u32 s7, s7, 0x8000
    buffer_load_dwordx4 v[40:43], v5, s[48:51], s7 offen nt
    s_load_dwordx8 s[16:23], s[0:1], 32
    s_load_dwordx8 s[24:31], s[0:1], 64
    s_barrier
    s_branch L_aux
L_stream:
    s_getreg_b32 s78, hwreg(HW_REG_XCC_ID, 0, 4)
    s_and_b32 s72, s75, 4
    s_lshl_b32 s72, s72, 18
    s_and_b32 s80, s75, 3
    s_mul_i32 s80, s80, 20480
    s_add_u32 s72, s72, s80
    v_and_b32 v8, 1, v6
    v_lshlrev_b32 v8, 4, v8
    v_mov_b32 v9, 0xffff
    v_lshlrev_b32 v8, v8, v9
    v_lshrrev_b32 v9, 1, v6
    v_cmp_eq_u32 vcc, 0, v9
    s_nop 1
    v_cndmask_b32 v10, 0, v8, vcc
    v_cmp_eq_u32 vcc, 1, v9
    s_nop 1
    v_cndmask_b32 v11, 0, v8, vcc
    v_cmp_eq_u32 vcc, 2, v9
    s_nop 1
    v_cndmask_b32 v12, 0, v8, vcc
    v_cmp_eq_u32 vcc, 3, v9
    s_nop 1
    v_cndmask_b32 v13, 0, v8, vcc
    v_and_b32 v9, 3, v1
    v_lshlrev_b32 v9, 4, v9
    v_lshl_or_b32 v14, v7, 6, v9
    v_and_b32 v15, 31, v1
    v_lshlrev_b32 v15, 4, v15
    v_lshl_add_u32 v9, v7, 3, v6
    v_lshlrev_b32 v9, 4, v9
    s_lshl_b32 s80, s76, 9
    v_add_u32 v62, s80, v9
    s_lshl_b32 s80, s6, 9
    v_add_u32 v63, s80, v15
    v_mov_b32 v61, 0
    v_mov_b32 v5, 1
    v_mov_b32 v98, 0xff800000
    s_addk_i32 s7, 0x1000
    s_or_b32 s73, s7, s71
    s_waitcnt vmcnt(4)
    buffer_load_dwordx4 v[120:123], v2, s[32:35], s73 offen nt
    s_addk_i32 s7, 0x1000
    s_waitcnt vmcnt(4)
    buffer_load_dwordx4 v[124:127], v2, s[32:35], s7 offen nt
    s_addk_i32 s7, 0x1000
    s_waitcnt vmcnt(4)
    buffer_load_dwordx4 v[128:131], v2, s[32:35], s7 offen nt
    s_addk_i32 s7, 0x1000
    s_waitcnt vmcnt(4)
    buffer_load_dwordx4 v[132:135], v2, s[32:35], s7 offen nt
    s_addk_i32 s7, 0x1000
    s_waitcnt vmcnt(4)
    buffer_load_dwordx4 v[136:139], v2, s[32:35], s7 offen nt
    s_waitcnt lgkmcnt(0)
    s_load_dword s77, s[40:41], 0
    s_lshr_b32 s90, s6, 5
    s_lshl_b32 s90, s90, 12
    s_add_u32 s90, s90, 1245184
    s_lshl_b32 s91, s6, 7
    s_add_u32 s91, s91, 1245184
    v_bfe_u32 v9, v1, 2, 3
    v_lshlrev_b32 v9, 7, v9
    v_and_b32 v4, 3, v1
    v_lshl_or_b32 v0, v4, 4, v9
    s_and_b32 s80, s74, 3
    s_lshl_b32 s80, s80, 10
    v_add_u32 v0, s80, v0
    v_and_b32 v8, 31, v1
    v_min_u32 v8, 11, v8
    v_and_b32 v9, 3, v8
    v_lshrrev_b32 v8, 2, v8
    v_lshl_add_u32 v8, v9, 3, v8
    v_lshlrev_b32 v8, 7, v8
    v_add_u32 v8, 192, v8
    v_cmp_gt_u32 vcc, 32, v1
    s_nop 1
    v_cndmask_b32 v99, v8, v0, vcc
    v_lshlrev_b32 v4, 3, v4
    s_lshl_b32 s99, s76, 3
    s_ashr_i32 s98, s71, 31
    s_sub_u32 s65, s2, 248
    s_cselect_b32 s64, 0, 1
    s_cmp_eq_u32 s76, 0
    s_cselect_b32 s64, s64, 0
    s_mul_i32 s65, s65, 4352
    s_add_u32 s65, s65, 4096
    s_add_u32 s66, s40, 4096
    s_addc_u32 s67, s41, 0
    s_mov_b32 s62, 0
    s_mov_b32 s63, 0
    s_mov_b32 s80, 0x000f000f
    s_mov_b32 s81, 0x000f000f
    s_mov_b32 s82, 0x00f000f0
    s_mov_b32 s83, 0x00f000f0
    s_mov_b32 s84, 0x0f000f00
    s_mov_b32 s85, 0x0f000f00
    s_mov_b32 s86, 0xf000f000
    s_mov_b32 s87, 0xf000f000
    s_mov_b32 s88, 0x00ff00ff
    s_mov_b32 s89, 0x00ff00ff
    s_mov_b32 s92, 0x3db504f3
    s_mov_b32 s93, 0x3fb8aa3b
    s_addk_i32 s7, 0x1000
    s_or_b32 s73, s7, s71
    s_waitcnt vmcnt(4)
    buffer_load_dwordx4 v[140:143], v2, s[32:35], s73 offen nt
    s_addk_i32 s7, 0x1000
    s_waitcnt vmcnt(4)
    buffer_load_dwordx4 v[144:147], v2, s[32:35], s7 offen nt
    s_addk_i32 s7, 0x1000
    s_waitcnt vmcnt(4)
    buffer_load_dwordx4 v[148:151], v2, s[32:35], s7 offen nt
    s_addk_i32 s7, 0x1000
    s_waitcnt vmcnt(4)
    buffer_load_dwordx4 v[152:155], v2, s[32:35], s7 offen nt
    s_addk_i32 s7, 0x1000
    s_waitcnt vmcnt(4)
    buffer_load_dwordx4 v[156:159], v2, s[32:35], s7 offen nt
    s_addk_i32 s7, 0x1000
    s_or_b32 s73, s7, s71
    s_waitcnt vmcnt(4)
    buffer_load_dwordx4 v[160:163], v2, s[32:35], s73 offen nt
    s_add_u32 s73, s72, 0x00000000
    s_waitcnt vmcnt(4)
    buffer_load_dwordx4 v[164:167], v2, s[32:35], s73 offen nt
    s_addk_i32 s7, 0x1000
    s_or_b32 s73, s7, s71
    s_waitcnt vmcnt(4)
    buffer_load_dwordx4 v[168:171], v2, s[32:35], s73 offen nt
    s_addk_i32 s7, 0x1000
    s_waitcnt vmcnt(4)
    buffer_load_dwordx4 v[172:175], v2, s[32:35], s7 offen nt
    s_addk_i32 s7, 0x1000
    s_waitcnt vmcnt(4)
    buffer_load_dwordx4 v[176:179], v2, s[32:35], s7 offen nt
    s_addk_i32 s7, 0x1000
    s_waitcnt vmcnt(4)
    buffer_load_dwordx4 v[180:183], v2, s[32:35], s7 offen nt
    s_waitcnt lgkmcnt(0)
    s_mul_i32 s77, s77, 1664525
    s_add_u32 s77, s77, 1013904223
    v_and_b32 v1, 3, v1
    v_mul_u32_u24 v1, 7, v1
    v_lshrrev_b32 v1, v1, s77
    v_and_b32 v1, 0xffe, v1
    v_and_or_b32 v1, s77, 1, v1
    s_addk_i32 s7, 0x1000
    s_waitcnt vmcnt(4)
    buffer_load_dwordx4 v[184:187], v2, s[32:35], s7 offen nt
    s_addk_i32 s7, 0x1000
    s_or_b32 s73, s7, s71
    s_waitcnt vmcnt(4)
    buffer_load_dwordx4 v[188:191], v2, s[32:35], s73 offen nt
    s_addk_i32 s7, 0x1000
    s_waitcnt vmcnt(4)
    buffer_load_dwordx4 v[192:195], v2, s[32:35], s7 offen nt
    s_addk_i32 s7, 0x1000
    s_waitcnt vmcnt(4)
    buffer_load_dwordx4 v[196:199], v2, s[32:35], s7 offen nt
    s_addk_i32 s7, 0x1000
    s_waitcnt vmcnt(4)
    buffer_load_dwordx4 v[200:203], v2, s[32:35], s7 offen nt
    s_addk_i32 s7, 0x1000
    s_waitcnt vmcnt(4)
    buffer_load_dwordx4 v[204:207], v2, s[32:35], s7 offen nt
    s_addk_i32 s7, 0x1000
    s_or_b32 s73, s7, s71
    s_waitcnt vmcnt(4)
    buffer_load_dwordx4 v[208:211], v2, s[32:35], s73 offen nt
    s_addk_i32 s7, 0x1000
    s_waitcnt vmcnt(4)
    buffer_load_dwordx4 v[212:215], v2, s[32:35], s7 offen nt
    s_addk_i32 s7, 0x1000
    s_waitcnt vmcnt(4)
    buffer_load_dwordx4 v[216:219], v2, s[32:35], s7 offen nt
    s_addk_i32 s7, 0x1000
    s_waitcnt vmcnt(4)
    buffer_load_dwordx4 v[220:223], v2, s[32:35], s7 offen nt
    s_addk_i32 s7, 0x1000
    s_waitcnt vmcnt(4)
    buffer_load_dwordx4 v[224:227], v2, s[32:35], s7 offen nt
    s_addk_i32 s7, 0x1000
    s_or_b32 s73, s7, s71
    s_waitcnt vmcnt(4)
    buffer_load_dwordx4 v[228:231], v2, s[32:35], s73 offen nt
    s_add_u32 s73, s72, 0x00010000
    s_waitcnt vmcnt(4)
    buffer_load_dwordx4 v[232:235], v2, s[32:35], s73 offen nt
    s_addk_i32 s7, 0x1000
    s_or_b32 s73, s7, s71
    s_waitcnt vmcnt(4)
    buffer_load_dwordx4 v[236:239], v2, s[32:35], s73 offen nt
    s_addk_i32 s7, 0x1000
    s_waitcnt vmcnt(4)
    buffer_load_dwordx4 v[240:243], v2, s[32:35], s7 offen nt
    s_addk_i32 s7, 0x1000
    s_waitcnt vmcnt(4)
    buffer_load_dwordx4 v[244:247], v2, s[32:35], s7 offen nt
    s_addk_i32 s7, 0x1000
    s_waitcnt vmcnt(4)
    buffer_load_dwordx4 v[248:251], v2, s[32:35], s7 offen nt
    s_addk_i32 s7, 0x1000
    s_waitcnt vmcnt(4)
    buffer_load_dwordx4 v[252:255], v2, s[32:35], s7 offen nt
L_q_1:
    ds_read_b128 v[44:47], v14 offset:4096
    s_waitcnt lgkmcnt(0)
    v_max3_u32 v48, v44, v45, v46
    v_max_u32 v48, v48, v47
    v_cmp_eq_u32 vcc, -1, v48
    s_nop 0
    s_cbranch_vccnz L_q_1_r
L_q_1_d:
    ds_read_b32 v8, v61 offset:4624
    s_waitcnt lgkmcnt(0)
    v_readfirstlane_b32 s31, v8
    v_cndmask_b32 v16, 0, v44, s[80:81]
    v_cndmask_b32 v17, 0, v45, s[80:81]
    v_cndmask_b32 v18, 0, v46, s[80:81]
    v_cndmask_b32 v19, 0, v47, s[80:81]
    v_cndmask_b32 v20, 0, v44, s[82:83]
    v_cndmask_b32 v21, 0, v45, s[82:83]
    v_cndmask_b32 v22, 0, v46, s[82:83]
    v_cndmask_b32 v23, 0, v47, s[82:83]
    v_cndmask_b32 v24, 0, v44, s[84:85]
    v_cndmask_b32 v25, 0, v45, s[84:85]
    v_cndmask_b32 v26, 0, v46, s[84:85]
    v_cndmask_b32 v27, 0, v47, s[84:85]
    v_cndmask_b32 v28, 0, v44, s[86:87]
    v_cndmask_b32 v29, 0, v45, s[86:87]
    v_cndmask_b32 v30, 0, v46, s[86:87]
    v_cndmask_b32 v31, 0, v47, s[86:87]
    v_mfma_f32_16x16x32_bf16 v[32:35], v[100:103], v[16:19], 0
    v_mfma_f32_16x16x32_bf16 v[32:35], v[104:107], v[20:23], v[32:35]
    v_mfma_f32_16x16x32_bf16 v[32:35], v[108:111], v[24:27], v[32:35]
    v_mfma_f32_16x16x32_bf16 v[32:35], v[112:115], v[28:31], v[32:35]
    v_mfma_f32_16x16x32_bf16 v[36:39], v[116:119], v[16:19], 0
    s_nop 6
    v_mov_b32_dpp v64, v32 quad_perm:[0,0,0,0] row_mask:0xf bank_mask:0xf
    s_nop 1
    v_add_f32_dpp v64, v33, v64 quad_perm:[1,1,1,1] row_mask:0xf bank_mask:0xf
    s_nop 1
    v_add_f32_dpp v64, v34, v64 quad_perm:[2,2,2,2] row_mask:0xf bank_mask:0xf
    s_nop 1
    v_add_f32_dpp v64, v35, v64 quad_perm:[3,3,3,3] row_mask:0xf bank_mask:0xf
    v_cvt_pk_bf16_f32 v64, v64, v64
    v_and_b32 v64, 0xffff0000, v64
    v_mul_f32 v64, s92, v64
    v_cvt_pk_bf16_f32 v64, v64, v64
    v_and_b32 v64, 0xffff0000, v64
    s_and_b32 s0, s98, 0x000f000f
    s_mov_b32 s1, s0
    v_cndmask_b32 v64, v64, v98, s[0:1]
    v_mov_b32 v60, v64
    s_addk_i32 s7, 0x1000
    s_or_b32 s73, s7, s71
    s_waitcnt vmcnt(4)
    buffer_load_dwordx4 v[100:103], v2, s[32:35], s73 offen nt
    v_mfma_f32_16x16x32_bf16 v[36:39], v[120:123], v[20:23], v[36:39]
    v_mfma_f32_16x16x32_bf16 v[36:39], v[124:127], v[24:27], v[36:39]
    v_mfma_f32_16x16x32_bf16 v[36:39], v[128:131], v[28:31], v[36:39]
    v_mfma_f32_16x16x32_bf16 v[32:35], v[132:135], v[16:19], 0
    s_nop 6
    v_mov_b32_dpp v65, v36 quad_perm:[0,0,0,0] row_mask:0xf bank_mask:0xf
    s_nop 1
    v_add_f32_dpp v65, v37, v65 quad_perm:[1,1,1,1] row_mask:0xf bank_mask:0xf
    s_nop 1
    v_add_f32_dpp v65, v38, v65 quad_perm:[2,2,2,2] row_mask:0xf bank_mask:0xf
    s_nop 1
    v_add_f32_dpp v65, v39, v65 quad_perm:[3,3,3,3] row_mask:0xf bank_mask:0xf
    v_cvt_pk_bf16_f32 v65, v65, v65
    v_and_b32 v65, 0xffff0000, v65
    v_mul_f32 v65, s92, v65
    v_cvt_pk_bf16_f32 v65, v65, v65
    v_and_b32 v65, 0xffff0000, v65
    s_and_b32 s0, s98, 0x00f000f0
    s_mov_b32 s1, s0
    v_cndmask_b32 v65, v65, v98, s[0:1]
    v_max_f32 v60, v60, v65
    v_mfma_f32_16x16x32_bf16 v[32:35], v[136:139], v[20:23], v[32:35]
    v_mfma_f32_16x16x32_bf16 v[32:35], v[140:143], v[24:27], v[32:35]
    v_mfma_f32_16x16x32_bf16 v[32:35], v[144:147], v[28:31], v[32:35]
    v_mfma_f32_16x16x32_bf16 v[36:39], v[148:151], v[16:19], 0
    s_nop 6
    v_mov_b32_dpp v66, v32 quad_perm:[0,0,0,0] row_mask:0xf bank_mask:0xf
    s_nop 1
    v_add_f32_dpp v66, v33, v66 quad_perm:[1,1,1,1] row_mask:0xf bank_mask:0xf
    s_nop 1
    v_add_f32_dpp v66, v34, v66 quad_perm:[2,2,2,2] row_mask:0xf bank_mask:0xf
    s_nop 1
    v_add_f32_dpp v66, v35, v66 quad_perm:[3,3,3,3] row_mask:0xf bank_mask:0xf
    v_cvt_pk_bf16_f32 v66, v66, v66
    v_and_b32 v66, 0xffff0000, v66
    v_mul_f32 v66, s92, v66
    v_cvt_pk_bf16_f32 v66, v66, v66
    v_and_b32 v66, 0xffff0000, v66
    s_and_b32 s0, s98, 0x0f000f00
    s_mov_b32 s1, s0
    v_cndmask_b32 v66, v66, v98, s[0:1]
    v_max_f32 v60, v60, v66
    s_addk_i32 s7, 0x1000
    s_waitcnt vmcnt(4)
    buffer_load_dwordx4 v[104:107], v2, s[32:35], s7 offen nt
    v_mfma_f32_16x16x32_bf16 v[36:39], v[152:155], v[20:23], v[36:39]
    v_mfma_f32_16x16x32_bf16 v[36:39], v[156:159], v[24:27], v[36:39]
    v_mfma_f32_16x16x32_bf16 v[36:39], v[160:163], v[28:31], v[36:39]
    v_mfma_f32_16x16x32_bf16 v[32:35], v[164:167], v[16:19], 0
    s_nop 6
    v_mov_b32_dpp v67, v36 quad_perm:[0,0,0,0] row_mask:0xf bank_mask:0xf
    s_nop 1
    v_add_f32_dpp v67, v37, v67 quad_perm:[1,1,1,1] row_mask:0xf bank_mask:0xf
    s_nop 1
    v_add_f32_dpp v67, v38, v67 quad_perm:[2,2,2,2] row_mask:0xf bank_mask:0xf
    s_nop 1
    v_add_f32_dpp v67, v39, v67 quad_perm:[3,3,3,3] row_mask:0xf bank_mask:0xf
    v_cvt_pk_bf16_f32 v67, v67, v67
    v_and_b32 v67, 0xffff0000, v67
    v_mul_f32 v67, s92, v67
    v_cvt_pk_bf16_f32 v67, v67, v67
    v_and_b32 v67, 0xffff0000, v67
    s_and_b32 s0, s98, 0xf000f000
    s_mov_b32 s1, s0
    v_cndmask_b32 v67, v67, v98, s[0:1]
    v_max_f32 v60, v60, v67
    v_mfma_f32_16x16x32_bf16 v[32:35], v[168:171], v[20:23], v[32:35]
    v_mfma_f32_16x16x32_bf16 v[32:35], v[172:175], v[24:27], v[32:35]
    v_mfma_f32_16x16x32_bf16 v[32:35], v[176:179], v[28:31], v[32:35]
    v_mfma_f32_16x16x32_bf16 v[36:39], v[180:183], v[16:19], 0
    s_nop 6
    v_mov_b32_dpp v68, v32 quad_perm:[0,0,0,0] row_mask:0xf bank_mask:0xf
    s_nop 1
    v_add_f32_dpp v68, v33, v68 quad_perm:[1,1,1,1] row_mask:0xf bank_mask:0xf
    s_nop 1
    v_add_f32_dpp v68, v34, v68 quad_perm:[2,2,2,2] row_mask:0xf bank_mask:0xf
    s_nop 1
    v_add_f32_dpp v68, v35, v68 quad_perm:[3,3,3,3] row_mask:0xf bank_mask:0xf
    v_cvt_pk_bf16_f32 v68, v68, v68
    v_and_b32 v68, 0xffff0000, v68
    v_mul_f32 v68, s92, v68
    v_cvt_pk_bf16_f32 v68, v68, v68
    v_and_b32 v68, 0xffff0000, v68
    s_and_b32 s0, s98, 0x00f000f0
    s_mov_b32 s1, s0
    v_cndmask_b32 v68, v68, v98, s[0:1]
    v_max_f32 v60, v60, v68
    s_addk_i32 s7, 0x1000
    s_waitcnt vmcnt(4)
    buffer_load_dwordx4 v[108:111], v2, s[32:35], s7 offen nt
    s_memrealtime s[60:61]
    v_mfma_f32_16x16x32_bf16 v[36:39], v[184:187], v[20:23], v[36:39]
    v_mfma_f32_16x16x32_bf16 v[36:39], v[188:191], v[24:27], v[36:39]
    v_mfma_f32_16x16x32_bf16 v[36:39], v[192:195], v[28:31], v[36:39]
    v_mfma_f32_16x16x32_bf16 v[32:35], v[196:199], v[16:19], 0
    s_nop 6
    v_mov_b32_dpp v69, v36 quad_perm:[0,0,0,0] row_mask:0xf bank_mask:0xf
    s_nop 1
    v_add_f32_dpp v69, v37, v69 quad_perm:[1,1,1,1] row_mask:0xf bank_mask:0xf
    s_nop 1
    v_add_f32_dpp v69, v38, v69 quad_perm:[2,2,2,2] row_mask:0xf bank_mask:0xf
    s_nop 1
    v_add_f32_dpp v69, v39, v69 quad_perm:[3,3,3,3] row_mask:0xf bank_mask:0xf
    v_cvt_pk_bf16_f32 v69, v69, v69
    v_and_b32 v69, 0xffff0000, v69
    v_mul_f32 v69, s92, v69
    v_cvt_pk_bf16_f32 v69, v69, v69
    v_and_b32 v69, 0xffff0000, v69
    s_and_b32 s0, s98, 0x0f000f00
    s_mov_b32 s1, s0
    v_cndmask_b32 v69, v69, v98, s[0:1]
    v_max_f32 v60, v60, v69
    v_mfma_f32_16x16x32_bf16 v[32:35], v[200:203], v[20:23], v[32:35]
    v_mfma_f32_16x16x32_bf16 v[32:35], v[204:207], v[24:27], v[32:35]
    v_mfma_f32_16x16x32_bf16 v[32:35], v[208:211], v[28:31], v[32:35]
    v_mfma_f32_16x16x32_bf16 v[36:39], v[212:215], v[16:19], 0
    s_nop 6
    v_mov_b32_dpp v70, v32 quad_perm:[0,0,0,0] row_mask:0xf bank_mask:0xf
    s_nop 1
    v_add_f32_dpp v70, v33, v70 quad_perm:[1,1,1,1] row_mask:0xf bank_mask:0xf
    s_nop 1
    v_add_f32_dpp v70, v34, v70 quad_perm:[2,2,2,2] row_mask:0xf bank_mask:0xf
    s_nop 1
    v_add_f32_dpp v70, v35, v70 quad_perm:[3,3,3,3] row_mask:0xf bank_mask:0xf
    v_cvt_pk_bf16_f32 v70, v70, v70
    v_and_b32 v70, 0xffff0000, v70
    v_mul_f32 v70, s92, v70
    v_cvt_pk_bf16_f32 v70, v70, v70
    v_and_b32 v70, 0xffff0000, v70
    s_and_b32 s0, s98, 0xf000f000
    s_mov_b32 s1, s0
    v_cndmask_b32 v70, v70, v98, s[0:1]
    v_max_f32 v60, v60, v70
    s_addk_i32 s7, 0x1000
    s_waitcnt vmcnt(4)
    buffer_load_dwordx4 v[112:115], v2, s[32:35], s7 offen nt
    s_cmp_lg_u32 s64, 0
    s_cbranch_scc1 L_ref_2_r
L_ref_2:
    v_mfma_f32_16x16x32_bf16 v[36:39], v[216:219], v[20:23], v[36:39]
    v_mfma_f32_16x16x32_bf16 v[36:39], v[220:223], v[24:27], v[36:39]
    v_mfma_f32_16x16x32_bf16 v[36:39], v[224:227], v[28:31], v[36:39]
    v_mfma_f32_16x16x32_bf16 v[32:35], v[228:231], v[16:19], 0
    s_nop 6
    v_mov_b32_dpp v71, v36 quad_perm:[0,0,0,0] row_mask:0xf bank_mask:0xf
    s_nop 1
    v_add_f32_dpp v71, v37, v71 quad_perm:[1,1,1,1] row_mask:0xf bank_mask:0xf
    s_nop 1
    v_add_f32_dpp v71, v38, v71 quad_perm:[2,2,2,2] row_mask:0xf bank_mask:0xf
    s_nop 1
    v_add_f32_dpp v71, v39, v71 quad_perm:[3,3,3,3] row_mask:0xf bank_mask:0xf
    v_cvt_pk_bf16_f32 v71, v71, v71
    v_and_b32 v71, 0xffff0000, v71
    v_mul_f32 v71, s92, v71
    v_cvt_pk_bf16_f32 v71, v71, v71
    v_and_b32 v71, 0xffff0000, v71
    v_max_f32 v60, v60, v71
    v_mfma_f32_16x16x32_bf16 v[32:35], v[232:235], v[20:23], v[32:35]
    v_mfma_f32_16x16x32_bf16 v[32:35], v[236:239], v[24:27], v[32:35]
    v_mfma_f32_16x16x32_bf16 v[32:35], v[240:243], v[28:31], v[32:35]
    v_mfma_f32_16x16x32_bf16 v[36:39], v[244:247], v[16:19], 0
    s_nop 6
    v_mov_b32_dpp v72, v32 quad_perm:[0,0,0,0] row_mask:0xf bank_mask:0xf
    s_nop 1
    v_add_f32_dpp v72, v33, v72 quad_perm:[1,1,1,1] row_mask:0xf bank_mask:0xf
    s_nop 1
    v_add_f32_dpp v72, v34, v72 quad_perm:[2,2,2,2] row_mask:0xf bank_mask:0xf
    s_nop 1
    v_add_f32_dpp v72, v35, v72 quad_perm:[3,3,3,3] row_mask:0xf bank_mask:0xf
    v_cvt_pk_bf16_f32 v72, v72, v72
    v_and_b32 v72, 0xffff0000, v72
    v_mul_f32 v72, s92, v72
    v_cvt_pk_bf16_f32 v72, v72, v72
    v_and_b32 v72, 0xffff0000, v72
    s_and_b32 s0, s98, 0x0f0f0f0f
    s_mov_b32 s1, s0
    v_cndmask_b32 v72, v72, v98, s[0:1]
    v_max_f32 v60, v60, v72
    s_addk_i32 s7, 0x1000
    s_waitcnt vmcnt(4)
    buffer_load_dwordx4 v[116:119], v2, s[32:35], s7 offen nt
    v_mfma_f32_16x16x32_bf16 v[36:39], v[248:251], v[20:23], v[36:39]
    v_mfma_f32_16x16x32_bf16 v[36:39], v[252:255], v[24:27], v[36:39]
    s_addk_i32 s7, 0x1000
    s_or_b32 s73, s7, s71
    s_waitcnt vmcnt(4)
    buffer_load_dwordx4 v[120:123], v2, s[32:35], s73 offen nt
    v_mfma_f32_16x16x32_bf16 v[36:39], v[100:103], v[28:31], v[36:39]
    s_addk_i32 s7, 0x1000
    s_waitcnt vmcnt(4)
    buffer_load_dwordx4 v[124:127], v2, s[32:35], s7 offen nt
    v_mfma_f32_16x16x32_bf16 v[32:35], v[104:107], v[16:19], 0
    s_nop 3
    v_mov_b32_dpp v73, v36 quad_perm:[0,0,0,0] row_mask:0xf bank_mask:0xf
    s_nop 1
    v_add_f32_dpp v73, v37, v73 quad_perm:[1,1,1,1] row_mask:0xf bank_mask:0xf
    s_nop 1
    v_add_f32_dpp v73, v38, v73 quad_perm:[2,2,2,2] row_mask:0xf bank_mask:0xf
    s_nop 1
    v_add_f32_dpp v73, v39, v73 quad_perm:[3,3,3,3] row_mask:0xf bank_mask:0xf
    v_cvt_pk_bf16_f32 v73, v73, v73
    v_and_b32 v73, 0xffff0000, v73
    v_mul_f32 v73, s92, v73
    v_cvt_pk_bf16_f32 v73, v73, v73
    v_and_b32 v73, 0xffff0000, v73
    s_and_b32 s0, s98, 0xf000f000
    s_mov_b32 s1, s0
    v_cndmask_b32 v73, v73, v98, s[0:1]
    v_max_f32 v60, v60, v73
    s_addk_i32 s7, 0x1000
    s_waitcnt vmcnt(4)
    buffer_load_dwordx4 v[128:131], v2, s[32:35], s7 offen nt
    v_mfma_f32_16x16x32_bf16 v[32:35], v[108:111], v[20:23], v[32:35]
    s_addk_i32 s7, 0x1000
    s_waitcnt vmcnt(4)
    buffer_load_dwordx4 v[132:135], v2, s[32:35], s7 offen nt
    v_mfma_f32_16x16x32_bf16 v[32:35], v[112:115], v[24:27], v[32:35]
    s_addk_i32 s7, 0x1000
    s_waitcnt vmcnt(4)
    buffer_load_dwordx4 v[136:139], v2, s[32:35], s7 offen nt
    v_mfma_f32_16x16x32_bf16 v[32:35], v[116:119], v[28:31], v[32:35]
    s_addk_i32 s7, 0x1000
    s_or_b32 s73, s7, s71
    s_waitcnt vmcnt(4)
    buffer_load_dwordx4 v[140:143], v2, s[32:35], s73 offen nt
    v_mfma_f32_16x16x32_bf16 v[36:39], v[120:123], v[16:19], 0
    s_nop 2
    v_mov_b32_dpp v74, v32 quad_perm:[0,0,0,0] row_mask:0xf bank_mask:0xf
    s_nop 1
    v_add_f32_dpp v74, v33, v74 quad_perm:[1,1,1,1] row_mask:0xf bank_mask:0xf
    s_nop 1
    v_add_f32_dpp v74, v34, v74 quad_perm:[2,2,2,2] row_mask:0xf bank_mask:0xf
    s_nop 1
    v_add_f32_dpp v74, v35, v74 quad_perm:[3,3,3,3] row_mask:0xf bank_mask:0xf
    v_cvt_pk_bf16_f32 v74, v74, v74
    v_and_b32 v74, 0xffff0000, v74
    v_mul_f32 v74, s92, v74
    v_cvt_pk_bf16_f32 v74, v74, v74
    v_and_b32 v74, 0xffff0000, v74
    v_max_f32 v60, v60, v74
    s_add_u32 s73, s72, 0x00020000
    s_waitcnt vmcnt(4)
    buffer_load_dwordx4 v[144:147], v2, s[32:35], s73 offen nt
    v_mfma_f32_16x16x32_bf16 v[36:39], v[124:127], v[20:23], v[36:39]
    s_addk_i32 s7, 0x1000
    s_or_b32 s73, s7, s71
    s_waitcnt vmcnt(4)
    buffer_load_dwordx4 v[148:151], v2, s[32:35], s73 offen nt
    v_mfma_f32_16x16x32_bf16 v[36:39], v[128:131], v[24:27], v[36:39]
    s_addk_i32 s7, 0x1000
    s_waitcnt vmcnt(4)
    buffer_load_dwordx4 v[152:155], v2, s[32:35], s7 offen nt
    s_load_dwordx2 s[44:45], s[66:67], 128
    s_load_dwordx2 s[46:47], s[66:67], 4480
    s_load_dwordx2 s[48:49], s[66:67], 8832
    s_load_dwordx2 s[50:51], s[66:67], 13184
    s_load_dwordx2 s[52:53], s[66:67], 17536
    s_load_dwordx2 s[54:55], s[66:67], 21888
    s_load_dwordx2 s[56:57], s[66:67], 26240
    s_load_dwordx2 s[58:59], s[66:67], 30592
    v_mfma_f32_16x16x32_bf16 v[36:39], v[132:135], v[28:31], v[36:39]
    s_addk_i32 s7, 0x1000
    s_waitcnt vmcnt(4)
    buffer_load_dwordx4 v[156:159], v2, s[32:35], s7 offen nt
    v_mfma_f32_16x16x32_bf16 v[32:35], v[136:139], v[16:19], 0
    s_nop 3
    v_mov_b32_dpp v75, v36 quad_perm:[0,0,0,0] row_mask:0xf bank_mask:0xf
    s_nop 1
    v_add_f32_dpp v75, v37, v75 quad_perm:[1,1,1,1] row_mask:0xf bank_mask:0xf
    s_nop 1
    v_add_f32_dpp v75, v38, v75 quad_perm:[2,2,2,2] row_mask:0xf bank_mask:0xf
    s_nop 1
    v_add_f32_dpp v75, v39, v75 quad_perm:[3,3,3,3] row_mask:0xf bank_mask:0xf
    v_cvt_pk_bf16_f32 v75, v75, v75
    v_and_b32 v75, 0xffff0000, v75
    v_mul_f32 v75, s92, v75
    v_cvt_pk_bf16_f32 v75, v75, v75
    v_and_b32 v75, 0xffff0000, v75
    s_and_b32 s0, s98, 0x000f000f
    s_mov_b32 s1, s0
    v_cndmask_b32 v75, v75, v98, s[0:1]
    v_max_f32 v60, v60, v75
    s_addk_i32 s7, 0x1000
    s_waitcnt vmcnt(4)
    buffer_load_dwordx4 v[160:163], v2, s[32:35], s7 offen nt
    v_mfma_f32_16x16x32_bf16 v[32:35], v[140:143], v[20:23], v[32:35]
    s_addk_i32 s7, 0x1000
    s_waitcnt vmcnt(4)
    buffer_load_dwordx4 v[164:167], v2, s[32:35], s7 offen nt
    v_mfma_f32_16x16x32_bf16 v[32:35], v[144:147], v[24:27], v[32:35]
    s_addk_i32 s7, 0x1000
    s_or_b32 s73, s7, s71
    s_waitcnt vmcnt(4)
    buffer_load_dwordx4 v[168:171], v2, s[32:35], s73 offen nt
    v_mfma_f32_16x16x32_bf16 v[32:35], v[148:151], v[28:31], v[32:35]
    s_addk_i32 s7, 0x1000
    s_waitcnt vmcnt(4)
    buffer_load_dwordx4 v[172:175], v2, s[32:35], s7 offen nt
    v_mfma_f32_16x16x32_bf16 v[36:39], v[152:155], v[16:19], 0
    s_nop 3
    v_mov_b32_dpp v76, v32 quad_perm:[0,0,0,0] row_mask:0xf bank_mask:0xf
    s_nop 1
    v_add_f32_dpp v76, v33, v76 quad_perm:[1,1,1,1] row_mask:0xf bank_mask:0xf
    s_nop 1
    v_add_f32_dpp v76, v34, v76 quad_perm:[2,2,2,2] row_mask:0xf bank_mask:0xf
    s_nop 1
    v_add_f32_dpp v76, v35, v76 quad_perm:[3,3,3,3] row_mask:0xf bank_mask:0xf
    v_cvt_pk_bf16_f32 v76, v76, v76
    v_and_b32 v76, 0xffff0000, v76
    v_mul_f32 v76, s92, v76
    v_cvt_pk_bf16_f32 v76, v76, v76
    v_and_b32 v76, 0xffff0000, v76
    s_and_b32 s0, s98, 0xf0f0f0f0
    s_mov_b32 s1, s0
    v_cndmask_b32 v76, v76, v98, s[0:1]
    v_max_f32 v60, v60, v76
    s_addk_i32 s7, 0x1000
    s_waitcnt vmcnt(4)
    buffer_load_dwordx4 v[176:179], v2, s[32:35], s7 offen nt
    v_mfma_f32_16x16x32_bf16 v[36:39], v[156:159], v[20:23], v[36:39]
    s_addk_i32 s7, 0x1000
    s_waitcnt vmcnt(4)
    buffer_load_dwordx4 v[180:183], v2, s[32:35], s7 offen nt
    v_mfma_f32_16x16x32_bf16 v[36:39], v[160:163], v[24:27], v[36:39]
    s_addk_i32 s7, 0x1000
    s_waitcnt vmcnt(4)
    buffer_load_dwordx4 v[184:187], v2, s[32:35], s7 offen nt
    v_mfma_f32_16x16x32_bf16 v[36:39], v[164:167], v[28:31], v[36:39]
    s_addk_i32 s7, 0x1000
    s_or_b32 s73, s7, s71
    s_waitcnt vmcnt(4)
    buffer_load_dwordx4 v[188:191], v2, s[32:35], s73 offen nt
    v_mfma_f32_16x16x32_bf16 v[32:35], v[168:171], v[16:19], 0
    s_nop 2
    v_mov_b32_dpp v77, v36 quad_perm:[0,0,0,0] row_mask:0xf bank_mask:0xf
    s_nop 1
    v_add_f32_dpp v77, v37, v77 quad_perm:[1,1,1,1] row_mask:0xf bank_mask:0xf
    s_nop 1
    v_add_f32_dpp v77, v38, v77 quad_perm:[2,2,2,2] row_mask:0xf bank_mask:0xf
    s_nop 1
    v_add_f32_dpp v77, v39, v77 quad_perm:[3,3,3,3] row_mask:0xf bank_mask:0xf
    v_cvt_pk_bf16_f32 v77, v77, v77
    v_and_b32 v77, 0xffff0000, v77
    v_mul_f32 v77, s92, v77
    v_cvt_pk_bf16_f32 v77, v77, v77
    v_and_b32 v77, 0xffff0000, v77
    v_max_f32 v60, v60, v77
    s_addk_i32 s7, 0x1000
    s_waitcnt vmcnt(4)
    buffer_load_dwordx4 v[192:195], v2, s[32:35], s7 offen nt
    v_mfma_f32_16x16x32_bf16 v[32:35], v[172:175], v[20:23], v[32:35]
    s_addk_i32 s7, 0x1000
    s_waitcnt vmcnt(4)
    buffer_load_dwordx4 v[196:199], v2, s[32:35], s7 offen nt
    v_mfma_f32_16x16x32_bf16 v[32:35], v[176:179], v[24:27], v[32:35]
    s_addk_i32 s7, 0x1000
    s_waitcnt vmcnt(4)
    buffer_load_dwordx4 v[200:203], v2, s[32:35], s7 offen nt
    s_waitcnt lgkmcnt(0)
    s_mov_b32 s68, 0
    s_sub_u32 s69, s60, s44
    s_cmp_eq_u32 s45, s77
    s_cselect_b32 s69, s69, -154
    s_add_u32 s68, s68, s69
    s_sub_u32 s69, s60, s46
    s_cmp_eq_u32 s47, s77
    s_cselect_b32 s69, s69, -154
    s_add_u32 s68, s68, s69
    s_sub_u32 s69, s60, s48
    s_cmp_eq_u32 s49, s77
    s_cselect_b32 s69, s69, -154
    s_add_u32 s68, s68, s69
    s_sub_u32 s69, s60, s50
    s_cmp_eq_u32 s51, s77
    s_cselect_b32 s69, s69, -154
    s_add_u32 s68, s68, s69
    s_sub_u32 s69, s60, s52
    s_cmp_eq_u32 s53, s77
    s_cselect_b32 s69, s69, -154
    s_add_u32 s68, s68, s69
    s_sub_u32 s69, s60, s54
    s_cmp_eq_u32 s55, s77
    s_cselect_b32 s69, s69, -154
    s_add_u32 s68, s68, s69
    s_sub_u32 s69, s60, s56
    s_cmp_eq_u32 s57, s77
    s_cselect_b32 s69, s69, -154
    s_add_u32 s68, s68, s69
    s_sub_u32 s69, s60, s58
    s_cmp_eq_u32 s59, s77
    s_cselect_b32 s69, s69, -154
    s_add_u32 s68, s68, s69
    s_mul_i32 s69, s60, 8
    s_sub_u32 s69, s69, s68
    s_sub_u32 s76, s69, s2
    s_mov_b32 s2, s69
    s_max_i32 s69, s68, 0
    s_min_u32 s69, s69, 0x4000
    s_mul_i32 s69, s69, 1638
    s_lshr_b32 s69, s69, 16
    s_add_u32 s62, s69, 65
    s_sub_i32 s69, 0, s68
    s_max_i32 s69, s69, 0
    s_min_u32 s69, s69, 0x4000
    s_mul_i32 s69, s69, 1966
    s_lshr_b32 s69, s69, 16
    s_add_u32 s63, s69, 65
    v_mfma_f32_16x16x32_bf16 v[32:35], v[180:183], v[28:31], v[32:35]
    s_addk_i32 s7, 0x1000
    s_cmpk_gt_u32 s62, 65
    s_cbranch_scc1 L_go_3
    s_waitcnt vmcnt(5)
    s_cmpk_le_u32 s63, 65
    s_cbranch_scc1 L_go_3
    s_waitcnt vmcnt(4)
L_go_3:
    buffer_load_dwordx4 v[204:207], v2, s[32:35], s7 offen nt
    s_memrealtime s[60:61]
    s_addk_i32 s7, 0x1000
    s_or_b32 s73, s7, s71
    s_cmpk_gt_u32 s62, 66
    s_cbranch_scc1 L_go_4
    s_waitcnt vmcnt(5)
    s_cmpk_le_u32 s63, 66
    s_cbranch_scc1 L_go_4
    s_waitcnt vmcnt(4)
L_go_4:
    buffer_load_dwordx4 v[208:211], v2, s[32:35], s73 offen nt
    s_cmp_lg_u32 s64, 0
    s_cbranch_scc1 L_ref_5_r
L_ref_5:
    s_add_u32 s73, s72, 0x00030000
    s_cmpk_gt_u32 s62, 67
    s_cbranch_scc1 L_go_6
    s_waitcnt vmcnt(5)
    s_cmpk_le_u32 s63, 67
    s_cbranch_scc1 L_go_6
    s_waitcnt vmcnt(4)
L_go_6:
    buffer_load_dwordx4 v[212:215], v2, s[32:35], s73 offen nt
    s_add_u32 s7, s70, 0x04000000
    s_or_b32 s73, s7, s71
    s_waitcnt vmcnt(7)
    s_cmpk_gt_u32 s62, 68
    s_cbranch_scc1 L_go_7
    s_waitcnt vmcnt(5)
    s_cmpk_le_u32 s63, 68
    s_cbranch_scc1 L_go_7
    s_waitcnt vmcnt(4)
L_go_7:
    buffer_load_dwordx4 v[216:219], v2, s[32:35], s73 offen nt
    v_mfma_f32_16x16x32_bf16 v[36:39], v[184:187], v[16:19], 0
    v_mov_b32_dpp v78, v32 quad_perm:[0,0,0,0] row_mask:0xf bank_mask:0xf
    s_nop 1
    v_add_f32_dpp v78, v33, v78 quad_perm:[1,1,1,1] row_mask:0xf bank_mask:0xf
    s_nop 1
    v_add_f32_dpp v78, v34, v78 quad_perm:[2,2,2,2] row_mask:0xf bank_mask:0xf
    s_nop 1
    v_add_f32_dpp v78, v35, v78 quad_perm:[3,3,3,3] row_mask:0xf bank_mask:0xf
    v_cvt_pk_bf16_f32 v78, v78, v78
    v_and_b32 v78, 0xffff0000, v78
    v_mul_f32 v78, s92, v78
    v_cvt_pk_bf16_f32 v78, v78, v78
    v_and_b32 v78, 0xffff0000, v78
    s_and_b32 s0, s98, 0x000f000f
    s_mov_b32 s1, s0
    v_cndmask_b32 v78, v78, v98, s[0:1]
    v_max_f32 v60, v60, v78
    s_addk_i32 s7, 0x1000
    s_waitcnt vmcnt(7)
    s_cmpk_gt_u32 s62, 69
    s_cbranch_scc1 L_go_8
    s_waitcnt vmcnt(5)
    s_cmpk_le_u32 s63, 69
    s_cbranch_scc1 L_go_8
    s_waitcnt vmcnt(4)
L_go_8:
    buffer_load_dwordx4 v[220:223], v2, s[32:35], s7 offen nt
    v_mfma_f32_16x16x32_bf16 v[36:39], v[188:191], v[20:23], v[36:39]
    s_addk_i32 s7, 0x1000
    s_waitcnt vmcnt(7)
    s_cmpk_gt_u32 s62, 70
    s_cbranch_scc1 L_go_9
    s_waitcnt vmcnt(5)
    s_cmpk_le_u32 s63, 70
    s_cbranch_scc1 L_go_9
    s_waitcnt vmcnt(4)
L_go_9:
    buffer_load_dwordx4 v[224:227], v2, s[32:35], s7 offen nt
    v_mfma_f32_16x16x32_bf16 v[36:39], v[192:195], v[24:27], v[36:39]
    s_addk_i32 s7, 0x1000
    s_waitcnt vmcnt(7)
    s_cmpk_gt_u32 s62, 71
    s_cbranch_scc1 L_go_10
    s_waitcnt vmcnt(5)
    s_cmpk_le_u32 s63, 71
    s_cbranch_scc1 L_go_10
    s_waitcnt vmcnt(4)
L_go_10:
    buffer_load_dwordx4 v[228:231], v2, s[32:35], s7 offen nt
    v_mfma_f32_16x16x32_bf16 v[36:39], v[196:199], v[28:31], v[36:39]
    s_addk_i32 s7, 0x1000
    s_waitcnt vmcnt(7)
    s_cmpk_gt_u32 s62, 72
    s_cbranch_scc1 L_go_11
    s_waitcnt vmcnt(5)
    s_cmpk_le_u32 s63, 72
    s_cbranch_scc1 L_go_11
    s_waitcnt vmcnt(4)
L_go_11:
    buffer_load_dwordx4 v[232:235], v2, s[32:35], s7 offen nt
    v_mfma_f32_16x16x32_bf16 v[32:35], v[200:203], v[16:19], 0
    s_nop 1
    v_mov_b32_dpp v79, v36 quad_perm:[0,0,0,0] row_mask:0xf bank_mask:0xf
    s_nop 1
    v_add_f32_dpp v79, v37, v79 quad_perm:[1,1,1,1] row_mask:0xf bank_mask:0xf
    s_nop 1
    v_add_f32_dpp v79, v38, v79 quad_perm:[2,2,2,2] row_mask:0xf bank_mask:0xf
    s_nop 1
    v_add_f32_dpp v79, v39, v79 quad_perm:[3,3,3,3] row_mask:0xf bank_mask:0xf
    v_cvt_pk_bf16_f32 v79, v79, v79
    v_and_b32 v79, 0xffff0000, v79
    v_mul_f32 v79, s92, v79
    v_cvt_pk_bf16_f32 v79, v79, v79
    v_and_b32 v79, 0xffff0000, v79
    s_and_b32 s0, s98, 0x00f000f0
    s_mov_b32 s1, s0
    v_cndmask_b32 v79, v79, v98, s[0:1]
    v_max_f32 v60, v60, v79
    s_addk_i32 s7, 0x1000
    s_or_b32 s73, s7, s71
    s_waitcnt vmcnt(7)
    s_cmpk_gt_u32 s62, 73
    s_cbranch_scc1 L_go_12
    s_waitcnt vmcnt(5)
    s_cmpk_le_u32 s63, 73
    s_cbranch_scc1 L_go_12
    s_waitcnt vmcnt(4)
L_go_12:
    buffer_load_dwordx4 v[236:239], v2, s[32:35], s73 offen nt
    v_mfma_f32_16x16x32_bf16 v[32:35], v[204:207], v[20:23], v[32:35]
    s_addk_i32 s7, 0x1000
    s_waitcnt vmcnt(7)
    s_cmpk_gt_u32 s62, 74
    s_cbranch_scc1 L_go_13
    s_waitcnt vmcnt(5)
    s_cmpk_le_u32 s63, 74
    s_cbranch_scc1 L_go_13
    s_waitcnt vmcnt(4)
L_go_13:
    buffer_load_dwordx4 v[240:243], v2, s[32:35], s7 offen nt
    v_mfma_f32_16x16x32_bf16 v[32:35], v[208:211], v[24:27], v[32:35]
    s_addk_i32 s7, 0x1000
    s_waitcnt vmcnt(7)
    s_cmpk_gt_u32 s62, 75
    s_cbranch_scc1 L_go_14
    s_waitcnt vmcnt(5)
    s_cmpk_le_u32 s63, 75
    s_cbranch_scc1 L_go_14
    s_waitcnt vmcnt(4)
L_go_14:
    buffer_load_dwordx4 v[244:247], v2, s[32:35], s7 offen nt
    v_mfma_f32_16x16x32_bf16 v[32:35], v[212:215], v[28:31], v[32:35]
    s_nop 7
    v_mov_b32_dpp v80, v32 quad_perm:[0,0,0,0] row_mask:0xf bank_mask:0xf
    s_nop 1
    v_add_f32_dpp v80, v33, v80 quad_perm:[1,1,1,1] row_mask:0xf bank_mask:0xf
    s_nop 1
    v_add_f32_dpp v80, v34, v80 quad_perm:[2,2,2,2] row_mask:0xf bank_mask:0xf
    s_nop 1
    v_add_f32_dpp v80, v35, v80 quad_perm:[3,3,3,3] row_mask:0xf bank_mask:0xf
    v_cvt_pk_bf16_f32 v80, v80, v80
    v_and_b32 v80, 0xffff0000, v80
    v_mul_f32 v80, s92, v80
    v_cvt_pk_bf16_f32 v80, v80, v80
    v_and_b32 v80, 0xffff0000, v80
    s_and_b32 s0, s98, 0x0f000f00
    s_mov_b32 s1, s0
    v_cndmask_b32 v80, v80, v98, s[0:1]
    v_max_f32 v60, v60, v80
    s_nop 1
    v_max_f32_dpp v60, v60, v60 row_ror:8 row_mask:0xf bank_mask:0xf
    s_nop 1
    v_max_f32_dpp v60, v60, v60 row_ror:4 row_mask:0xf bank_mask:0xf
    v_mov_b32 v44, v60
    s_nop 1
    v_permlane16_swap_b32 v60, v44
    v_max_f32 v60, v60, v44
    v_mov_b32 v44, v60
    s_nop 1
    v_permlane32_swap_b32 v60, v44
    v_max_f32 v60, v60, v44
    v_mov_b32 v56, v60
    v_mov_b32 v57, 0
    v_sub_f32 v44, v64, v56
    v_sub_f32 v45, v65, v56
    v_sub_f32 v46, v66, v56
    v_sub_f32 v47, v67, v56
    v_mul_f32 v44, s93, v44
    v_mul_f32 v45, s93, v45
    v_mul_f32 v46, s93, v46
    v_mul_f32 v47, s93, v47
    v_exp_f32 v44, v44
    v_exp_f32 v45, v45
    v_exp_f32 v46, v46
    v_exp_f32 v47, v47
    v_add_f32 v57, v57, v44
    v_add_f32 v57, v57, v45
    v_add_f32 v57, v57, v46
    v_add_f32 v57, v57, v47
    s_addk_i32 s7, 0x1000
    s_waitcnt vmcnt(7)
    s_cmpk_gt_u32 s62, 76
    s_cbranch_scc1 L_go_15
    s_waitcnt vmcnt(5)
    s_cmpk_le_u32 s63, 76
    s_cbranch_scc1 L_go_15
    s_waitcnt vmcnt(4)
L_go_15:
    buffer_load_dwordx4 v[248:251], v2, s[32:35], s7 offen nt
    s_load_dwordx2 s[44:45], s[66:67], 256
    s_load_dwordx2 s[46:47], s[66:67], 4608
    s_load_dwordx2 s[48:49], s[66:67], 8960
    s_load_dwordx2 s[50:51], s[66:67], 13312
    s_load_dwordx2 s[52:53], s[66:67], 17664
    s_load_dwordx2 s[54:55], s[66:67], 22016
    s_load_dwordx2 s[56:57], s[66:67], 26368
    s_load_dwordx2 s[58:59], s[66:67], 30720
    v_sub_f32 v44, v68, v56
    v_sub_f32 v45, v69, v56
    v_sub_f32 v46, v70, v56
    v_sub_f32 v47, v71, v56
    v_mul_f32 v44, s93, v44
    v_mul_f32 v45, s93, v45
    v_mul_f32 v46, s93, v46
    v_mul_f32 v47, s93, v47
    v_exp_f32 v44, v44
    v_exp_f32 v45, v45
    v_exp_f32 v46, v46
    v_exp_f32 v47, v47
    v_add_f32 v57, v57, v44
    v_add_f32 v57, v57, v45
    v_add_f32 v57, v57, v46
    v_add_f32 v57, v57, v47
    v_sub_f32 v44, v72, v56
    v_sub_f32 v45, v73, v56
    v_sub_f32 v46, v74, v56
    v_sub_f32 v47, v75, v56
    v_mul_f32 v44, s93, v44
    v_mul_f32 v45, s93, v45
    v_mul_f32 v46, s93, v46
    v_mul_f32 v47, s93, v47
    v_exp_f32 v44, v44
    v_exp_f32 v45, v45
    v_exp_f32 v46, v46
    v_exp_f32 v47, v47
    v_add_f32 v57, v57, v44
    v_add_f32 v57, v57, v45
    v_add_f32 v57, v57, v46
    v_add_f32 v57, v57, v47
    v_sub_f32 v44, v76, v56
    v_sub_f32 v45, v77, v56
    v_sub_f32 v46, v78, v56
    v_sub_f32 v47, v79, v56
    v_mul_f32 v44, s93, v44
    v_mul_f32 v45, s93, v45
    v_mul_f32 v46, s93, v46
    v_mul_f32 v47, s93, v47
    v_exp_f32 v44, v44
    v_exp_f32 v45, v45
    v_exp_f32 v46, v46
    v_exp_f32 v47, v47
    v_add_f32 v57, v57, v44
    v_add_f32 v57, v57, v45
    v_add_f32 v57, v57, v46
    v_add_f32 v57, v57, v47
    s_addk_i32 s7, 0x1000
    s_waitcnt vmcnt(7)
    s_cmpk_gt_u32 s62, 77
    s_cbranch_scc1 L_go_16
    s_waitcnt vmcnt(5)
    s_cmpk_le_u32 s63, 77
    s_cbranch_scc1 L_go_16
    s_waitcnt vmcnt(4)
L_go_16:
    buffer_load_dwordx4 v[252:255], v2, s[32:35], s7 offen nt
    v_sub_f32 v44, v80, v56
    v_mul_f32 v44, s93, v44
    v_exp_f32 v44, v44
    s_nop 0
    v_add_f32 v57, v57, v44
    s_nop 1
    v_add_f32_dpp v57, v57, v57 row_ror:8 row_mask:0xf bank_mask:0xf
    s_nop 1
    v_add_f32_dpp v57, v57, v57 row_ror:4 row_mask:0xf bank_mask:0xf
    v_mov_b32 v44, v57
    s_nop 1
    v_permlane16_swap_b32 v57, v44
    v_add_f32 v57, v57, v44
    v_mov_b32 v44, v57
    s_nop 1
    v_permlane32_swap_b32 v57, v44
    v_add_f32 v57, v57, v44
    v_mov_b32 v8, s99
    s_mov_b64 exec, 1
    ds_write_b64 v8, v[56:57] offset:4672
    ds_add_rtn_u32 v8, v61, v5 offset:4616
    s_mov_b64 exec, -1
    ds_read_b64 v[44:45], v4 offset:4672
    s_waitcnt lgkmcnt(0)
    v_readfirstlane_b32 s96, v8
    s_nop 0
    s_cmp_lg_u32 s96, 2
    s_cbranch_scc1 L_mlast_17
    v_mov_b32 v8, s78
    v_cndmask_b32 v56, v8, v44, s[80:81]
    v_mov_b32 v57, s77
    v_mov_b32 v58, v45
    v_mov_b32 v59, s77
    s_add_u32 s96, s91, 0
    s_mov_b64 exec, 0xff
    s_cmp_lg_u32 s31, 0
    s_cbranch_scc1 L_mlast_17_far
    buffer_store_dwordx4 v[56:59], v15, s[40:43], s96 offen
L_mlast_17:
    s_mov_b64 exec, -1
    s_addk_i32 s7, 0x1000
    s_or_b32 s73, s7, s71
    s_waitcnt vmcnt(7)
    s_cmpk_gt_u32 s62, 78
    s_cbranch_scc1 L_go_18
    s_waitcnt vmcnt(5)
    s_cmpk_le_u32 s63, 78
    s_cbranch_scc1 L_go_18
    s_waitcnt vmcnt(4)
L_go_18:
    buffer_load_dwordx4 v[100:103], v2, s[32:35], s73 offen nt
L_q_19:
    ds_read_b128 v[44:47], v14 offset:4352
    s_waitcnt lgkmcnt(0)
    v_max3_u32 v48, v44, v45, v46
    v_max_u32 v48, v48, v47
    v_cmp_eq_u32 vcc, -1, v48
    s_nop 0
    s_cbranch_vccnz L_q_19_r
L_q_19_d:
    v_cndmask_b32 v16, 0, v44, s[80:81]
    v_cndmask_b32 v17, 0, v45, s[80:81]
    v_cndmask_b32 v18, 0, v46, s[80:81]
    v_cndmask_b32 v19, 0, v47, s[80:81]
    v_cndmask_b32 v20, 0, v44, s[82:83]
    v_cndmask_b32 v21, 0, v45, s[82:83]
    v_cndmask_b32 v22, 0, v46, s[82:83]
    v_cndmask_b32 v23, 0, v47, s[82:83]
    v_cndmask_b32 v24, 0, v44, s[84:85]
    v_cndmask_b32 v25, 0, v45, s[84:85]
    v_cndmask_b32 v26, 0, v46, s[84:85]
    v_cndmask_b32 v27, 0, v47, s[84:85]
    v_cndmask_b32 v28, 0, v44, s[86:87]
    v_cndmask_b32 v29, 0, v45, s[86:87]
    v_cndmask_b32 v30, 0, v46, s[86:87]
    v_cndmask_b32 v31, 0, v47, s[86:87]
    v_mfma_f32_16x16x32_bf16 v[32:35], v[216:219], v[16:19], 0
    v_mfma_f32_16x16x32_bf16 v[32:35], v[220:223], v[20:23], v[32:35]
    v_mfma_f32_16x16x32_bf16 v[32:35], v[224:227], v[24:27], v[32:35]
    s_addk_i32 s7, 0x1000
    s_waitcnt vmcnt(7)
    s_cmpk_gt_u32 s62, 79
    s_cbranch_scc1 L_go_20
    s_waitcnt vmcnt(5)
    s_cmpk_le_u32 s63, 79
    s_cbranch_scc1 L_go_20
    s_waitcnt vmcnt(4)
L_go_20:
    buffer_load_dwordx4 v[104:107], v2, s[32:35], s7 offen nt
    v_mfma_f32_16x16x32_bf16 v[32:35], v[228:231], v[28:31], v[32:35]
    s_addk_i32 s7, 0x1000
    s_waitcnt vmcnt(7)
    s_cmpk_gt_u32 s62, 80
    s_cbranch_scc1 L_go_21
    s_waitcnt vmcnt(5)
    s_cmpk_le_u32 s63, 80
    s_cbranch_scc1 L_go_21
    s_waitcnt vmcnt(4)
L_go_21:
    buffer_load_dwordx4 v[108:111], v2, s[32:35], s7 offen nt
    v_mfma_f32_16x16x32_bf16 v[36:39], v[232:235], v[16:19], 0
    s_nop 1
    v_mov_b32_dpp v81, v32 quad_perm:[0,0,0,0] row_mask:0xf bank_mask:0xf
    s_nop 1
    v_add_f32_dpp v81, v33, v81 quad_perm:[1,1,1,1] row_mask:0xf bank_mask:0xf
    s_nop 1
    v_add_f32_dpp v81, v34, v81 quad_perm:[2,2,2,2] row_mask:0xf bank_mask:0xf
    s_nop 1
    v_add_f32_dpp v81, v35, v81 quad_perm:[3,3,3,3] row_mask:0xf bank_mask:0xf
    v_cvt_pk_bf16_f32 v81, v81, v81
    v_and_b32 v81, 0xffff0000, v81
    v_mul_f32 v81, s92, v81
    v_cvt_pk_bf16_f32 v81, v81, v81
    v_and_b32 v81, 0xffff0000, v81
    s_and_b32 s0, s98, 0x000f000f
    s_mov_b32 s1, s0
    v_cndmask_b32 v81, v81, v98, s[0:1]
    v_mov_b32 v60, v81
    s_addk_i32 s7, 0x1000
    s_waitcnt vmcnt(7)
    s_cmpk_gt_u32 s62, 81
    s_cbranch_scc1 L_go_22
    s_waitcnt vmcnt(5)
    s_cmpk_le_u32 s63, 81
    s_cbranch_scc1 L_go_22
    s_waitcnt vmcnt(4)
L_go_22:
    buffer_load_dwordx4 v[112:115], v2, s[32:35], s7 offen nt
    v_mfma_f32_16x16x32_bf16 v[36:39], v[236:239], v[20:23], v[36:39]
    s_addk_i32 s7, 0x1000
    s_waitcnt vmcnt(7)
    s_cmpk_gt_u32 s62, 82
    s_cbranch_scc1 L_go_23
    s_waitcnt vmcnt(5)
    s_cmpk_le_u32 s63, 82
    s_cbranch_scc1 L_go_23
    s_waitcnt vmcnt(4)
L_go_23:
    buffer_load_dwordx4 v[116:119], v2, s[32:35], s7 offen nt
    v_mfma_f32_16x16x32_bf16 v[36:39], v[240:243], v[24:27], v[36:39]
    s_addk_i32 s7, 0x1000
    s_or_b32 s73, s7, s71
    s_waitcnt vmcnt(7)
    s_cmpk_gt_u32 s62, 83
    s_cbranch_scc1 L_go_24
    s_waitcnt vmcnt(5)
    s_cmpk_le_u32 s63, 83
    s_cbranch_scc1 L_go_24
    s_waitcnt vmcnt(4)
L_go_24:
    buffer_load_dwordx4 v[120:123], v2, s[32:35], s73 offen nt
    v_mfma_f32_16x16x32_bf16 v[36:39], v[244:247], v[28:31], v[36:39]
    s_add_u32 s73, s72, 0x04000000
    s_waitcnt vmcnt(7)
    s_cmpk_gt_u32 s62, 84
    s_cbranch_scc1 L_go_25
    s_waitcnt vmcnt(5)
    s_cmpk_le_u32 s63, 84
    s_cbranch_scc1 L_go_25
    s_waitcnt vmcnt(4)
L_go_25:
    buffer_load_dwordx4 v[124:127], v2, s[32:35], s73 offen nt
    v_mfma_f32_16x16x32_bf16 v[32:35], v[248:251], v[16:19], 0
    s_nop 1
    v_mov_b32_dpp v82, v36 quad_perm:[0,0,0,0] row_mask:0xf bank_mask:0xf
    s_nop 1
    v_add_f32_dpp v82, v37, v82 quad_perm:[1,1,1,1] row_mask:0xf bank_mask:0xf
    s_nop 1
    v_add_f32_dpp v82, v38, v82 quad_perm:[2,2,2,2] row_mask:0xf bank_mask:0xf
    s_nop 1
    v_add_f32_dpp v82, v39, v82 quad_perm:[3,3,3,3] row_mask:0xf bank_mask:0xf
    v_cvt_pk_bf16_f32 v82, v82, v82
    v_and_b32 v82, 0xffff0000, v82
    v_mul_f32 v82, s92, v82
    v_cvt_pk_bf16_f32 v82, v82, v82
    v_and_b32 v82, 0xffff0000, v82
    s_and_b32 s0, s98, 0x00f000f0
    s_mov_b32 s1, s0
    v_cndmask_b32 v82, v82, v98, s[0:1]
    v_max_f32 v60, v60, v82
    s_addk_i32 s7, 0x1000
    s_or_b32 s73, s7, s71
    s_waitcnt vmcnt(7)
    s_cmpk_gt_u32 s62, 85
    s_cbranch_scc1 L_go_26
    s_waitcnt vmcnt(5)
    s_cmpk_le_u32 s63, 85
    s_cbranch_scc1 L_go_26
    s_waitcnt vmcnt(4)
L_go_26:
    buffer_load_dwordx4 v[128:131], v2, s[32:35], s73 offen nt
    v_mfma_f32_16x16x32_bf16 v[32:35], v[252:255], v[20:23], v[32:35]
    s_addk_i32 s7, 0x1000
    s_waitcnt vmcnt(7)
    s_cmpk_gt_u32 s62, 86
    s_cbranch_scc1 L_go_27
    s_waitcnt vmcnt(5)
    s_cmpk_le_u32 s63, 86
    s_cbranch_scc1 L_go_27
    s_waitcnt vmcnt(4)
L_go_27:
    buffer_load_dwordx4 v[132:135], v2, s[32:35], s7 offen nt
    v_mfma_f32_16x16x32_bf16 v[32:35], v[100:103], v[24:27], v[32:35]
    s_addk_i32 s7, 0x1000
    s_waitcnt vmcnt(7)
    s_cmpk_gt_u32 s62, 87
    s_cbranch_scc1 L_go_28
    s_waitcnt vmcnt(5)
    s_cmpk_le_u32 s63, 87
    s_cbranch_scc1 L_go_28
    s_waitcnt vmcnt(4)
L_go_28:
    buffer_load_dwordx4 v[136:139], v2, s[32:35], s7 offen nt
    s_memrealtime s[74:75]
    v_mfma_f32_16x16x32_bf16 v[32:35], v[104:107], v[28:31], v[32:35]
    s_addk_i32 s7, 0x1000
    s_waitcnt vmcnt(7)
    s_cmpk_gt_u32 s62, 88
    s_cbranch_scc1 L_go_29
    s_waitcnt vmcnt(5)
    s_cmpk_le_u32 s63, 88
    s_cbranch_scc1 L_go_29
    s_waitcnt vmcnt(4)
L_go_29:
    buffer_load_dwordx4 v[140:143], v2, s[32:35], s7 offen nt
    s_waitcnt lgkmcnt(0)
    s_mov_b32 s68, 0
    s_sub_u32 s69, s60, s44
    s_cmp_eq_u32 s45, s77
    s_cselect_b32 s69, s69, -154
    s_add_u32 s68, s68, s69
    s_sub_u32 s69, s60, s46
    s_cmp_eq_u32 s47, s77
    s_cselect_b32 s69, s69, -154
    s_add_u32 s68, s68, s69
    s_sub_u32 s69, s60, s48
    s_cmp_eq_u32 s49, s77
    s_cselect_b32 s69, s69, -154
    s_add_u32 s68, s68, s69
    s_sub_u32 s69, s60, s50
    s_cmp_eq_u32 s51, s77
    s_cselect_b32 s69, s69, -154
    s_add_u32 s68, s68, s69
    s_sub_u32 s69, s60, s52
    s_cmp_eq_u32 s53, s77
    s_cselect_b32 s69, s69, -154
    s_add_u32 s68, s68, s69
    s_sub_u32 s69, s60, s54
    s_cmp_eq_u32 s55, s77
    s_cselect_b32 s69, s69, -154
    s_add_u32 s68, s68, s69
    s_sub_u32 s69, s60, s56
    s_cmp_eq_u32 s57, s77
    s_cselect_b32 s69, s69, -154
    s_add_u32 s68, s68, s69
    s_sub_u32 s69, s60, s58
    s_cmp_eq_u32 s59, s77
    s_cselect_b32 s69, s69, -154
    s_add_u32 s68, s68, s69
    s_mul_i32 s69, s60, 8
    s_sub_u32 s69, s69, s68
    s_sub_u32 s76, s69, s2
    s_mov_b32 s2, s69
    s_mul_i32 s96, s76, 235
    s_lshr_b32 s96, s96, 8
    s_sub_u32 s69, s74, s60
    s_mul_i32 s69, s69, 8
    s_sub_i32 s69, s69, s96
    s_mul_i32 s69, s69, 16
    s_ashr_i32 s69, s69, 4
    s_add_i32 s68, s68, s69
    s_max_i32 s69, s68, 0
    s_min_u32 s69, s69, 0x4000
    s_mul_i32 s69, s69, 1638
    s_lshr_b32 s69, s69, 16
    s_add_u32 s62, s69, 89
    s_sub_i32 s69, 0, s68
    s_max_i32 s69, s69, 0
    s_min_u32 s69, s69, 0x4000
    s_mul_i32 s69, s69, 1966
    s_lshr_b32 s69, s69, 16
    s_add_u32 s63, s69, 89
    v_mfma_f32_16x16x32_bf16 v[36:39], v[108:111], v[16:19], 0
    v_mov_b32_dpp v83, v32 quad_perm:[0,0,0,0] row_mask:0xf bank_mask:0xf
    s_nop 1
    v_add_f32_dpp v83, v33, v83 quad_perm:[1,1,1,1] row_mask:0xf bank_mask:0xf
    s_nop 1
    v_add_f32_dpp v83, v34, v83 quad_perm:[2,2,2,2] row_mask:0xf bank_mask:0xf
    s_nop 1
    v_add_f32_dpp v83, v35, v83 quad_perm:[3,3,3,3] row_mask:0xf bank_mask:0xf
    v_cvt_pk_bf16_f32 v83, v83, v83
    v_and_b32 v83, 0xffff0000, v83
    v_mul_f32 v83, s92, v83
    v_cvt_pk_bf16_f32 v83, v83, v83
    v_and_b32 v83, 0xffff0000, v83
    s_and_b32 s0, s98, 0x0f000f00
    s_mov_b32 s1, s0
    v_cndmask_b32 v83, v83, v98, s[0:1]
    v_max_f32 v60, v60, v83
    s_addk_i32 s7, 0x1000
    s_waitcnt vmcnt(7)
    s_cmpk_gt_u32 s62, 89
    s_cbranch_scc1 L_go_30
    s_waitcnt vmcnt(5)
    s_cmpk_le_u32 s63, 89
    s_cbranch_scc1 L_go_30
    s_waitcnt vmcnt(4)
L_go_30:
    buffer_load_dwordx4 v[144:147], v2, s[32:35], s7 offen nt
    s_memrealtime s[60:61]
    v_mfma_f32_16x16x32_bf16 v[36:39], v[112:115], v[20:23], v[36:39]
    s_addk_i32 s7, 0x1000
    s_or_b32 s73, s7, s71
    s_waitcnt vmcnt(7)
    s_cmpk_gt_u32 s62, 90
    s_cbranch_scc1 L_go_31
    s_waitcnt vmcnt(5)
    s_cmpk_le_u32 s63, 90
    s_cbranch_scc1 L_go_31
    s_waitcnt vmcnt(4)
L_go_31:
    buffer_load_dwordx4 v[148:151], v2, s[32:35], s73 offen nt
    s_cmp_lg_u32 s64, 0
    s_cbranch_scc1 L_ref_32_r
L_ref_32:
    v_mfma_f32_16x16x32_bf16 v[36:39], v[116:119], v[24:27], v[36:39]
    s_addk_i32 s7, 0x1000
    s_waitcnt vmcnt(7)
    s_cmpk_gt_u32 s62, 91
    s_cbranch_scc1 L_go_33
    s_waitcnt vmcnt(5)
    s_cmpk_le_u32 s63, 91
    s_cbranch_scc1 L_go_33
    s_waitcnt vmcnt(4)
L_go_33:
    buffer_load_dwordx4 v[152:155], v2, s[32:35], s7 offen nt
    v_mfma_f32_16x16x32_bf16 v[36:39], v[120:123], v[28:31], v[36:39]
    s_addk_i32 s7, 0x1000
    s_waitcnt vmcnt(7)
    s_cmpk_gt_u32 s62, 92
    s_cbranch_scc1 L_go_34
    s_waitcnt vmcnt(5)
    s_cmpk_le_u32 s63, 92
    s_cbranch_scc1 L_go_34
    s_waitcnt vmcnt(4)
L_go_34:
    buffer_load_dwordx4 v[156:159], v2, s[32:35], s7 offen nt
    v_mfma_f32_16x16x32_bf16 v[32:35], v[124:127], v[16:19], 0
    s_nop 1
    v_mov_b32_dpp v84, v36 quad_perm:[0,0,0,0] row_mask:0xf bank_mask:0xf
    s_nop 1
    v_add_f32_dpp v84, v37, v84 quad_perm:[1,1,1,1] row_mask:0xf bank_mask:0xf
    s_nop 1
    v_add_f32_dpp v84, v38, v84 quad_perm:[2,2,2,2] row_mask:0xf bank_mask:0xf
    s_nop 1
    v_add_f32_dpp v84, v39, v84 quad_perm:[3,3,3,3] row_mask:0xf bank_mask:0xf
    v_cvt_pk_bf16_f32 v84, v84, v84
    v_and_b32 v84, 0xffff0000, v84
    v_mul_f32 v84, s92, v84
    v_cvt_pk_bf16_f32 v84, v84, v84
    v_and_b32 v84, 0xffff0000, v84
    s_and_b32 s0, s98, 0xf000f000
    s_mov_b32 s1, s0
    v_cndmask_b32 v84, v84, v98, s[0:1]
    v_max_f32 v60, v60, v84
    s_addk_i32 s7, 0x1000
    s_waitcnt vmcnt(7)
    s_cmpk_gt_u32 s62, 93
    s_cbranch_scc1 L_go_35
    s_waitcnt vmcnt(5)
    s_cmpk_le_u32 s63, 93
    s_cbranch_scc1 L_go_35
    s_waitcnt vmcnt(4)
L_go_35:
    buffer_load_dwordx4 v[160:163], v2, s[32:35], s7 offen nt
    v_mfma_f32_16x16x32_bf16 v[32:35], v[128:131], v[20:23], v[32:35]
    s_addk_i32 s7, 0x1000
    s_waitcnt vmcnt(7)
    s_cmpk_gt_u32 s62, 94
    s_cbranch_scc1 L_go_36
    s_waitcnt vmcnt(5)
    s_cmpk_le_u32 s63, 94
    s_cbranch_scc1 L_go_36
    s_waitcnt vmcnt(4)
L_go_36:
    buffer_load_dwordx4 v[164:167], v2, s[32:35], s7 offen nt
    v_mfma_f32_16x16x32_bf16 v[32:35], v[132:135], v[24:27], v[32:35]
    s_addk_i32 s7, 0x1000
    s_or_b32 s73, s7, s71
    s_waitcnt vmcnt(7)
    s_cmpk_gt_u32 s62, 95
    s_cbranch_scc1 L_go_37
    s_waitcnt vmcnt(5)
    s_cmpk_le_u32 s63, 95
    s_cbranch_scc1 L_go_37
    s_waitcnt vmcnt(4)
L_go_37:
    buffer_load_dwordx4 v[168:171], v2, s[32:35], s73 offen nt
    v_mfma_f32_16x16x32_bf16 v[32:35], v[136:139], v[28:31], v[32:35]
    s_addk_i32 s7, 0x1000
    s_waitcnt vmcnt(7)
    s_cmpk_gt_u32 s62, 96
    s_cbranch_scc1 L_go_38
    s_waitcnt vmcnt(5)
    s_cmpk_le_u32 s63, 96
    s_cbranch_scc1 L_go_38
    s_waitcnt vmcnt(4)
L_go_38:
    buffer_load_dwordx4 v[172:175], v2, s[32:35], s7 offen nt
    v_mfma_f32_16x16x32_bf16 v[36:39], v[140:143], v[16:19], 0
    s_nop 1
    v_mov_b32_dpp v85, v32 quad_perm:[0,0,0,0] row_mask:0xf bank_mask:0xf
    s_nop 1
    v_add_f32_dpp v85, v33, v85 quad_perm:[1,1,1,1] row_mask:0xf bank_mask:0xf
    s_nop 1
    v_add_f32_dpp v85, v34, v85 quad_perm:[2,2,2,2] row_mask:0xf bank_mask:0xf
    s_nop 1
    v_add_f32_dpp v85, v35, v85 quad_perm:[3,3,3,3] row_mask:0xf bank_mask:0xf
    v_cvt_pk_bf16_f32 v85, v85, v85
    v_and_b32 v85, 0xffff0000, v85
    v_mul_f32 v85, s92, v85
    v_cvt_pk_bf16_f32 v85, v85, v85
    v_and_b32 v85, 0xffff0000, v85
    s_and_b32 s0, s98, 0x00f000f0
    s_mov_b32 s1, s0
    v_cndmask_b32 v85, v85, v98, s[0:1]
    v_max_f32 v60, v60, v85
    s_addk_i32 s7, 0x1000
    s_waitcnt vmcnt(7)
    s_cmpk_gt_u32 s62, 97
    s_cbranch_scc1 L_go_39
    s_waitcnt vmcnt(5)
    s_cmpk_le_u32 s63, 97
    s_cbranch_scc1 L_go_39
    s_waitcnt vmcnt(4)
L_go_39:
    buffer_load_dwordx4 v[176:179], v2, s[32:35], s7 offen nt
    v_mfma_f32_16x16x32_bf16 v[36:39], v[144:147], v[20:23], v[36:39]
    s_addk_i32 s7, 0x1000
    s_waitcnt vmcnt(7)
    s_cmpk_gt_u32 s62, 98
    s_cbranch_scc1 L_go_40
    s_waitcnt vmcnt(5)
    s_cmpk_le_u32 s63, 98
    s_cbranch_scc1 L_go_40
    s_waitcnt vmcnt(4)
L_go_40:
    buffer_load_dwordx4 v[180:183], v2, s[32:35], s7 offen nt
    s_memrealtime s[74:75]
    v_mfma_f32_16x16x32_bf16 v[36:39], v[148:151], v[24:27], v[36:39]
    s_addk_i32 s7, 0x1000
    s_waitcnt vmcnt(7)
    s_cmpk_gt_u32 s62, 99
    s_cbranch_scc1 L_go_41
    s_waitcnt vmcnt(5)
    s_cmpk_le_u32 s63, 99
    s_cbranch_scc1 L_go_41
    s_waitcnt vmcnt(4)
L_go_41:
    buffer_load_dwordx4 v[184:187], v2, s[32:35], s7 offen nt
    s_mul_i32 s96, s76, 352
    s_lshr_b32 s96, s96, 8
    s_add_u32 s96, s96, s2
    s_waitcnt lgkmcnt(0)
    s_mul_i32 s68, s74, 8
    s_sub_u32 s68, s68, s96
    s_max_i32 s69, s68, 0
    s_min_u32 s69, s69, 0x4000
    s_mul_i32 s69, s69, 1638
    s_lshr_b32 s69, s69, 16
    s_add_u32 s62, s69, 100
    s_sub_i32 s69, 0, s68
    s_max_i32 s69, s69, 0
    s_min_u32 s69, s69, 0x4000
    s_mul_i32 s69, s69, 1966
    s_lshr_b32 s69, s69, 16
    s_add_u32 s63, s69, 100
    v_mfma_f32_16x16x32_bf16 v[36:39], v[152:155], v[28:31], v[36:39]
    s_addk_i32 s7, 0x1000
    s_or_b32 s73, s7, s71
    s_waitcnt vmcnt(7)
    s_cmpk_gt_u32 s62, 100
    s_cbranch_scc1 L_go_42
    s_waitcnt vmcnt(5)
    s_cmpk_le_u32 s63, 100
    s_cbranch_scc1 L_go_42
    s_waitcnt vmcnt(4)
L_go_42:
    buffer_load_dwordx4 v[188:191], v2, s[32:35], s73 offen nt
    s_load_dwordx2 s[44:45], s[66:67], 384
    s_load_dwordx2 s[46:47], s[66:67], 4736
    s_load_dwordx2 s[48:49], s[66:67], 9088
    s_load_dwordx2 s[50:51], s[66:67], 13440
    s_load_dwordx2 s[52:53], s[66:67], 17792
    s_load_dwordx2 s[54:55], s[66:67], 22144
    s_load_dwordx2 s[56:57], s[66:67], 26496
    s_load_dwordx2 s[58:59], s[66:67], 30848
    v_mfma_f32_16x16x32_bf16 v[32:35], v[156:159], v[16:19], 0
    v_mov_b32_dpp v86, v36 quad_perm:[0,0,0,0] row_mask:0xf bank_mask:0xf
    s_nop 1
    v_add_f32_dpp v86, v37, v86 quad_perm:[1,1,1,1] row_mask:0xf bank_mask:0xf
    s_nop 1
    v_add_f32_dpp v86, v38, v86 quad_perm:[2,2,2,2] row_mask:0xf bank_mask:0xf
    s_nop 1
    v_add_f32_dpp v86, v39, v86 quad_perm:[3,3,3,3] row_mask:0xf bank_mask:0xf
    v_cvt_pk_bf16_f32 v86, v86, v86
    v_and_b32 v86, 0xffff0000, v86
    v_mul_f32 v86, s92, v86
    v_cvt_pk_bf16_f32 v86, v86, v86
    v_and_b32 v86, 0xffff0000, v86
    s_and_b32 s0, s98, 0x0f000f00
    s_mov_b32 s1, s0
    v_cndmask_b32 v86, v86, v98, s[0:1]
    v_max_f32 v60, v60, v86
    s_add_u32 s73, s72, 0x04010000
    s_waitcnt vmcnt(7)
    s_cmpk_gt_u32 s62, 101
    s_cbranch_scc1 L_go_43
    s_waitcnt vmcnt(5)
    s_cmpk_le_u32 s63, 101
    s_cbranch_scc1 L_go_43
    s_waitcnt vmcnt(4)
L_go_43:
    buffer_load_dwordx4 v[192:195], v2, s[32:35], s73 offen nt
    v_mfma_f32_16x16x32_bf16 v[32:35], v[160:163], v[20:23], v[32:35]
    s_addk_i32 s7, 0x1000
    s_or_b32 s73, s7, s71
    s_waitcnt vmcnt(7)
    s_cmpk_gt_u32 s62, 102
    s_cbranch_scc1 L_go_44
    s_waitcnt vmcnt(5)
    s_cmpk_le_u32 s63, 102
    s_cbranch_scc1 L_go_44
    s_waitcnt vmcnt(4)
L_go_44:
    buffer_load_dwordx4 v[196:199], v2, s[32:35], s73 offen nt
    v_mfma_f32_16x16x32_bf16 v[32:35], v[164:167], v[24:27], v[32:35]
    s_addk_i32 s7, 0x1000
    s_waitcnt vmcnt(7)
    s_cmpk_gt_u32 s62, 103
    s_cbranch_scc1 L_go_45
    s_waitcnt vmcnt(5)
    s_cmpk_le_u32 s63, 103
    s_cbranch_scc1 L_go_45
    s_waitcnt vmcnt(4)
L_go_45:
    buffer_load_dwordx4 v[200:203], v2, s[32:35], s7 offen nt
    v_mfma_f32_16x16x32_bf16 v[32:35], v[168:171], v[28:31], v[32:35]
    s_addk_i32 s7, 0x1000
    s_waitcnt vmcnt(7)
    s_cmpk_gt_u32 s62, 104
    s_cbranch_scc1 L_go_46
    s_waitcnt vmcnt(5)
    s_cmpk_le_u32 s63, 104
    s_cbranch_scc1 L_go_46
    s_waitcnt vmcnt(4)
L_go_46:
    buffer_load_dwordx4 v[204:207], v2, s[32:35], s7 offen nt
    v_mfma_f32_16x16x32_bf16 v[36:39], v[172:175], v[16:19], 0
    s_nop 1
    v_mov_b32_dpp v87, v32 quad_perm:[0,0,0,0] row_mask:0xf bank_mask:0xf
    s_nop 1
    v_add_f32_dpp v87, v33, v87 quad_perm:[1,1,1,1] row_mask:0xf bank_mask:0xf
    s_nop 1
    v_add_f32_dpp v87, v34, v87 quad_perm:[2,2,2,2] row_mask:0xf bank_mask:0xf
    s_nop 1
    v_add_f32_dpp v87, v35, v87 quad_perm:[3,3,3,3] row_mask:0xf bank_mask:0xf
    v_cvt_pk_bf16_f32 v87, v87, v87
    v_and_b32 v87, 0xffff0000, v87
    v_mul_f32 v87, s92, v87
    v_cvt_pk_bf16_f32 v87, v87, v87
    v_and_b32 v87, 0xffff0000, v87
    s_and_b32 s0, s98, 0xf000f000
    s_mov_b32 s1, s0
    v_cndmask_b32 v87, v87, v98, s[0:1]
    v_max_f32 v60, v60, v87
    s_addk_i32 s7, 0x1000
    s_waitcnt vmcnt(7)
    s_cmpk_gt_u32 s62, 105
    s_cbranch_scc1 L_go_47
    s_waitcnt vmcnt(5)
    s_cmpk_le_u32 s63, 105
    s_cbranch_scc1 L_go_47
    s_waitcnt vmcnt(4)
L_go_47:
    buffer_load_dwordx4 v[208:211], v2, s[32:35], s7 offen nt
    v_mfma_f32_16x16x32_bf16 v[36:39], v[176:179], v[20:23], v[36:39]
    s_addk_i32 s7, 0x1000
    s_waitcnt vmcnt(7)
    s_cmpk_gt_u32 s62, 106
    s_cbranch_scc1 L_go_48
    s_waitcnt vmcnt(5)
    s_cmpk_le_u32 s63, 106
    s_cbranch_scc1 L_go_48
    s_waitcnt vmcnt(4)
L_go_48:
    buffer_load_dwordx4 v[212:215], v2, s[32:35], s7 offen nt
    v_mfma_f32_16x16x32_bf16 v[36:39], v[180:183], v[24:27], v[36:39]
    s_addk_i32 s7, 0x1000
    s_or_b32 s73, s7, s71
    s_waitcnt vmcnt(7)
    s_cmpk_gt_u32 s62, 107
    s_cbranch_scc1 L_go_49
    s_waitcnt vmcnt(5)
    s_cmpk_le_u32 s63, 107
    s_cbranch_scc1 L_go_49
    s_waitcnt vmcnt(4)
L_go_49:
    buffer_load_dwordx4 v[216:219], v2, s[32:35], s73 offen nt
    v_mfma_f32_16x16x32_bf16 v[36:39], v[184:187], v[28:31], v[36:39]
    s_addk_i32 s7, 0x1000
    s_waitcnt vmcnt(7)
    s_cmpk_gt_u32 s62, 108
    s_cbranch_scc1 L_go_50
    s_waitcnt vmcnt(5)
    s_cmpk_le_u32 s63, 108
    s_cbranch_scc1 L_go_50
    s_waitcnt vmcnt(4)
L_go_50:
    buffer_load_dwordx4 v[220:223], v2, s[32:35], s7 offen nt
    v_mfma_f32_16x16x32_bf16 v[32:35], v[188:191], v[16:19], 0
    s_nop 1
    v_mov_b32_dpp v88, v36 quad_perm:[0,0,0,0] row_mask:0xf bank_mask:0xf
    s_nop 1
    v_add_f32_dpp v88, v37, v88 quad_perm:[1,1,1,1] row_mask:0xf bank_mask:0xf
    s_nop 1
    v_add_f32_dpp v88, v38, v88 quad_perm:[2,2,2,2] row_mask:0xf bank_mask:0xf
    s_nop 1
    v_add_f32_dpp v88, v39, v88 quad_perm:[3,3,3,3] row_mask:0xf bank_mask:0xf
    v_cvt_pk_bf16_f32 v88, v88, v88
    v_and_b32 v88, 0xffff0000, v88
    v_mul_f32 v88, s92, v88
    v_cvt_pk_bf16_f32 v88, v88, v88
    v_and_b32 v88, 0xffff0000, v88
    v_max_f32 v60, v60, v88
    s_addk_i32 s7, 0x1000
    s_waitcnt vmcnt(7)
    s_cmpk_gt_u32 s62, 109
    s_cbranch_scc1 L_go_51
    s_waitcnt vmcnt(5)
    s_cmpk_le_u32 s63, 109
    s_cbranch_scc1 L_go_51
    s_waitcnt vmcnt(4)
L_go_51:
    buffer_load_dwordx4 v[224:227], v2, s[32:35], s7 offen nt
    v_mfma_f32_16x16x32_bf16 v[32:35], v[192:195], v[20:23], v[32:35]
    s_addk_i32 s7, 0x1000
    s_waitcnt vmcnt(7)
    s_cmpk_gt_u32 s62, 110
    s_cbranch_scc1 L_go_52
    s_waitcnt vmcnt(5)
    s_cmpk_le_u32 s63, 110
    s_cbranch_scc1 L_go_52
    s_waitcnt vmcnt(4)
L_go_52:
    buffer_load_dwordx4 v[228:231], v2, s[32:35], s7 offen nt
    v_mfma_f32_16x16x32_bf16 v[32:35], v[196:199], v[24:27], v[32:35]
    s_addk_i32 s7, 0x1000
    s_waitcnt vmcnt(7)
    s_cmpk_gt_u32 s62, 111
    s_cbranch_scc1 L_go_53
    s_waitcnt vmcnt(5)
    s_cmpk_le_u32 s63, 111
    s_cbranch_scc1 L_go_53
    s_waitcnt vmcnt(4)
L_go_53:
    buffer_load_dwordx4 v[232:235], v2, s[32:35], s7 offen nt
    s_memrealtime s[74:75]
    v_mfma_f32_16x16x32_bf16 v[32:35], v[200:203], v[28:31], v[32:35]
    s_addk_i32 s7, 0x1000
    s_or_b32 s73, s7, s71
    s_waitcnt vmcnt(7)
    s_cmpk_gt_u32 s62, 112
    s_cbranch_scc1 L_go_54
    s_waitcnt vmcnt(5)
    s_cmpk_le_u32 s63, 112
    s_cbranch_scc1 L_go_54
    s_waitcnt vmcnt(4)
L_go_54:
    buffer_load_dwordx4 v[236:239], v2, s[32:35], s73 offen nt
    s_waitcnt lgkmcnt(0)
    s_mov_b32 s68, 0
    s_sub_u32 s69, s60, s44
    s_cmp_eq_u32 s45, s77
    s_cselect_b32 s69, s69, -154
    s_add_u32 s68, s68, s69
    s_sub_u32 s69, s60, s46
    s_cmp_eq_u32 s47, s77
    s_cselect_b32 s69, s69, -154
    s_add_u32 s68, s68, s69
    s_sub_u32 s69, s60, s48
    s_cmp_eq_u32 s49, s77
    s_cselect_b32 s69, s69, -154
    s_add_u32 s68, s68, s69
    s_sub_u32 s69, s60, s50
    s_cmp_eq_u32 s51, s77
    s_cselect_b32 s69, s69, -154
    s_add_u32 s68, s68, s69
    s_sub_u32 s69, s60, s52
    s_cmp_eq_u32 s53, s77
    s_cselect_b32 s69, s69, -154
    s_add_u32 s68, s68, s69
    s_sub_u32 s69, s60, s54
    s_cmp_eq_u32 s55, s77
    s_cselect_b32 s69, s69, -154
    s_add_u32 s68, s68, s69
    s_sub_u32 s69, s60, s56
    s_cmp_eq_u32 s57, s77
    s_cselect_b32 s69, s69, -154
    s_add_u32 s68, s68, s69
    s_sub_u32 s69, s60, s58
    s_cmp_eq_u32 s59, s77
    s_cselect_b32 s69, s69, -154
    s_add_u32 s68, s68, s69
    s_mul_i32 s69, s60, 8
    s_sub_u32 s69, s69, s68
    s_sub_u32 s76, s69, s2
    s_mov_b32 s2, s69
    s_mul_i32 s96, s76, 235
    s_lshr_b32 s96, s96, 8
    s_sub_u32 s69, s74, s60
    s_mul_i32 s69, s69, 8
    s_sub_i32 s69, s69, s96
    s_mul_i32 s69, s69, 16
    s_ashr_i32 s69, s69, 4
    s_add_i32 s68, s68, s69
    s_max_i32 s69, s68, 0
    s_min_u32 s69, s69, 0x4000
    s_mul_i32 s69, s69, 1638
    s_lshr_b32 s69, s69, 16
    s_add_u32 s62, s69, 113
    s_sub_i32 s69, 0, s68
    s_max_i32 s69, s69, 0
    s_min_u32 s69, s69, 0x4000
    s_mul_i32 s69, s69, 1966
    s_lshr_b32 s69, s69, 16
    s_add_u32 s63, s69, 113
    v_mfma_f32_16x16x32_bf16 v[36:39], v[204:207], v[16:19], 0
    v_mov_b32_dpp v89, v32 quad_perm:[0,0,0,0] row_mask:0xf bank_mask:0xf
    s_nop 1
    v_add_f32_dpp v89, v33, v89 quad_perm:[1,1,1,1] row_mask:0xf bank_mask:0xf
    s_nop 1
    v_add_f32_dpp v89, v34, v89 quad_perm:[2,2,2,2] row_mask:0xf bank_mask:0xf
    s_nop 1
    v_add_f32_dpp v89, v35, v89 quad_perm:[3,3,3,3] row_mask:0xf bank_mask:0xf
    v_cvt_pk_bf16_f32 v89, v89, v89
    v_and_b32 v89, 0xffff0000, v89
    v_mul_f32 v89, s92, v89
    v_cvt_pk_bf16_f32 v89, v89, v89
    v_and_b32 v89, 0xffff0000, v89
    s_and_b32 s0, s98, 0x0f0f0f0f
    s_mov_b32 s1, s0
    v_cndmask_b32 v89, v89, v98, s[0:1]
    v_max_f32 v60, v60, v89
    s_addk_i32 s7, 0x1000
    s_waitcnt vmcnt(7)
    s_cmpk_gt_u32 s62, 113
    s_cbranch_scc1 L_go_55
    s_waitcnt vmcnt(5)
    s_cmpk_le_u32 s63, 113
    s_cbranch_scc1 L_go_55
    s_waitcnt vmcnt(4)
L_go_55:
    buffer_load_dwordx4 v[240:243], v2, s[32:35], s7 offen nt
    s_memrealtime s[60:61]
    v_mfma_f32_16x16x32_bf16 v[36:39], v[208:211], v[20:23], v[36:39]
    s_addk_i32 s7, 0x1000
    s_waitcnt vmcnt(7)
    s_cmpk_gt_u32 s62, 114
    s_cbranch_scc1 L_go_56
    s_waitcnt vmcnt(5)
    s_cmpk_le_u32 s63, 114
    s_cbranch_scc1 L_go_56
    s_waitcnt vmcnt(4)
L_go_56:
    buffer_load_dwordx4 v[244:247], v2, s[32:35], s7 offen nt
    s_cmp_lg_u32 s64, 0
    s_cbranch_scc1 L_ref_57_r
L_ref_57:
    v_mfma_f32_16x16x32_bf16 v[36:39], v[212:215], v[24:27], v[36:39]
    s_addk_i32 s7, 0x1000
    s_waitcnt vmcnt(7)
    s_cmpk_gt_u32 s62, 115
    s_cbranch_scc1 L_go_58
    s_waitcnt vmcnt(5)
    s_cmpk_le_u32 s63, 115
    s_cbranch_scc1 L_go_58
    s_waitcnt vmcnt(4)
L_go_58:
    buffer_load_dwordx4 v[248:251], v2, s[32:35], s7 offen nt
    v_mfma_f32_16x16x32_bf16 v[36:39], v[216:219], v[28:31], v[36:39]
    s_addk_i32 s7, 0x1000
    s_waitcnt vmcnt(7)
    s_cmpk_gt_u32 s62, 116
    s_cbranch_scc1 L_go_59
    s_waitcnt vmcnt(5)
    s_cmpk_le_u32 s63, 116
    s_cbranch_scc1 L_go_59
    s_waitcnt vmcnt(4)
L_go_59:
    buffer_load_dwordx4 v[252:255], v2, s[32:35], s7 offen nt
    v_mfma_f32_16x16x32_bf16 v[32:35], v[220:223], v[16:19], 0
    s_nop 1
    v_mov_b32_dpp v90, v36 quad_perm:[0,0,0,0] row_mask:0xf bank_mask:0xf
    s_nop 1
    v_add_f32_dpp v90, v37, v90 quad_perm:[1,1,1,1] row_mask:0xf bank_mask:0xf
    s_nop 1
    v_add_f32_dpp v90, v38, v90 quad_perm:[2,2,2,2] row_mask:0xf bank_mask:0xf
    s_nop 1
    v_add_f32_dpp v90, v39, v90 quad_perm:[3,3,3,3] row_mask:0xf bank_mask:0xf
    v_cvt_pk_bf16_f32 v90, v90, v90
    v_and_b32 v90, 0xffff0000, v90
    v_mul_f32 v90, s92, v90
    v_cvt_pk_bf16_f32 v90, v90, v90
    v_and_b32 v90, 0xffff0000, v90
    s_and_b32 s0, s98, 0xf000f000
    s_mov_b32 s1, s0
    v_cndmask_b32 v90, v90, v98, s[0:1]
    v_max_f32 v60, v60, v90
    s_addk_i32 s7, 0x1000
    s_or_b32 s73, s7, s71
    s_waitcnt vmcnt(7)
    s_cmpk_gt_u32 s62, 117
    s_cbranch_scc1 L_go_60
    s_waitcnt vmcnt(5)
    s_cmpk_le_u32 s63, 117
    s_cbranch_scc1 L_go_60
    s_waitcnt vmcnt(4)
L_go_60:
    buffer_load_dwordx4 v[100:103], v2, s[32:35], s73 offen nt
    v_mfma_f32_16x16x32_bf16 v[32:35], v[224:227], v[20:23], v[32:35]
    s_add_u32 s73, s72, 0x04020000
    s_waitcnt vmcnt(7)
    s_cmpk_gt_u32 s62, 118
    s_cbranch_scc1 L_go_61
    s_waitcnt vmcnt(5)
    s_cmpk_le_u32 s63, 118
    s_cbranch_scc1 L_go_61
    s_waitcnt vmcnt(4)
L_go_61:
    buffer_load_dwordx4 v[104:107], v2, s[32:35], s73 offen nt
    v_mfma_f32_16x16x32_bf16 v[32:35], v[228:231], v[24:27], v[32:35]
    s_addk_i32 s7, 0x1000
    s_or_b32 s73, s7, s71
    s_waitcnt vmcnt(7)
    s_cmpk_gt_u32 s62, 119
    s_cbranch_scc1 L_go_62
    s_waitcnt vmcnt(5)
    s_cmpk_le_u32 s63, 119
    s_cbranch_scc1 L_go_62
    s_waitcnt vmcnt(4)
L_go_62:
    buffer_load_dwordx4 v[108:111], v2, s[32:35], s73 offen nt
    v_mfma_f32_16x16x32_bf16 v[32:35], v[232:235], v[28:31], v[32:35]
    s_addk_i32 s7, 0x1000
    s_waitcnt vmcnt(7)
    s_cmpk_gt_u32 s62, 120
    s_cbranch_scc1 L_go_63
    s_waitcnt vmcnt(5)
    s_cmpk_le_u32 s63, 120
    s_cbranch_scc1 L_go_63
    s_waitcnt vmcnt(4)
L_go_63:
    buffer_load_dwordx4 v[112:115], v2, s[32:35], s7 offen nt
    v_mfma_f32_16x16x32_bf16 v[36:39], v[236:239], v[16:19], 0
    s_nop 1
    v_mov_b32_dpp v91, v32 quad_perm:[0,0,0,0] row_mask:0xf bank_mask:0xf
    s_nop 1
    v_add_f32_dpp v91, v33, v91 quad_perm:[1,1,1,1] row_mask:0xf bank_mask:0xf
    s_nop 1
    v_add_f32_dpp v91, v34, v91 quad_perm:[2,2,2,2] row_mask:0xf bank_mask:0xf
    s_nop 1
    v_add_f32_dpp v91, v35, v91 quad_perm:[3,3,3,3] row_mask:0xf bank_mask:0xf
    v_cvt_pk_bf16_f32 v91, v91, v91
    v_and_b32 v91, 0xffff0000, v91
    v_mul_f32 v91, s92, v91
    v_cvt_pk_bf16_f32 v91, v91, v91
    v_and_b32 v91, 0xffff0000, v91
    v_max_f32 v60, v60, v91
    s_addk_i32 s7, 0x1000
    s_waitcnt vmcnt(7)
    s_cmpk_gt_u32 s62, 121
    s_cbranch_scc1 L_go_64
    s_waitcnt vmcnt(5)
    s_cmpk_le_u32 s63, 121
    s_cbranch_scc1 L_go_64
    s_waitcnt vmcnt(4)
L_go_64:
    buffer_load_dwordx4 v[116:119], v2, s[32:35], s7 offen nt
    v_mfma_f32_16x16x32_bf16 v[36:39], v[240:243], v[20:23], v[36:39]
    s_addk_i32 s7, 0x1000
    s_waitcnt vmcnt(7)
    s_cmpk_gt_u32 s62, 122
    s_cbranch_scc1 L_go_65
    s_waitcnt vmcnt(5)
    s_cmpk_le_u32 s63, 122
    s_cbranch_scc1 L_go_65
    s_waitcnt vmcnt(4)
L_go_65:
    buffer_load_dwordx4 v[120:123], v2, s[32:35], s7 offen nt
    s_memrealtime s[74:75]
    v_mfma_f32_16x16x32_bf16 v[36:39], v[244:247], v[24:27], v[36:39]
    s_addk_i32 s7, 0x1000
    s_waitcnt vmcnt(7)
    s_cmpk_gt_u32 s62, 123
    s_cbranch_scc1 L_go_66
    s_waitcnt vmcnt(5)
    s_cmpk_le_u32 s63, 123
    s_cbranch_scc1 L_go_66
    s_waitcnt vmcnt(4)
L_go_66:
    buffer_load_dwordx4 v[124:127], v2, s[32:35], s7 offen nt
    s_mul_i32 s96, s76, 352
    s_lshr_b32 s96, s96, 8
    s_add_u32 s96, s96, s2
    s_waitcnt lgkmcnt(0)
    s_mul_i32 s68, s74, 8
    s_sub_u32 s68, s68, s96
    s_max_i32 s69, s68, 0
    s_min_u32 s69, s69, 0x4000
    s_mul_i32 s69, s69, 1638
    s_lshr_b32 s69, s69, 16
    s_add_u32 s62, s69, 124
    s_sub_i32 s69, 0, s68
    s_max_i32 s69, s69, 0
    s_min_u32 s69, s69, 0x4000
    s_mul_i32 s69, s69, 1966
    s_lshr_b32 s69, s69, 16
    s_add_u32 s63, s69, 124
    v_mfma_f32_16x16x32_bf16 v[36:39], v[248:251], v[28:31], v[36:39]
    s_addk_i32 s7, 0x1000
    s_or_b32 s73, s7, s71
    s_waitcnt vmcnt(7)
    s_cmpk_gt_u32 s62, 124
    s_cbranch_scc1 L_go_67
    s_waitcnt vmcnt(5)
    s_cmpk_le_u32 s63, 124
    s_cbranch_scc1 L_go_67
    s_waitcnt vmcnt(4)
L_go_67:
    buffer_load_dwordx4 v[128:131], v2, s[32:35], s73 offen nt
    s_load_dwordx2 s[44:45], s[66:67], 512
    s_load_dwordx2 s[46:47], s[66:67], 4864
    s_load_dwordx2 s[48:49], s[66:67], 9216
    s_load_dwordx2 s[50:51], s[66:67], 13568
    s_load_dwordx2 s[52:53], s[66:67], 17920
    s_load_dwordx2 s[54:55], s[66:67], 22272
    s_load_dwordx2 s[56:57], s[66:67], 26624
    s_load_dwordx2 s[58:59], s[66:67], 30976
    s_add_u32 s94, s90, 0
    buffer_load_dwordx4 v[52:55], v99, s[40:43], s94 offen sc1
    v_mfma_f32_16x16x32_bf16 v[32:35], v[252:255], v[16:19], 0
    v_mov_b32_dpp v92, v36 quad_perm:[0,0,0,0] row_mask:0xf bank_mask:0xf
    s_nop 1
    v_add_f32_dpp v92, v37, v92 quad_perm:[1,1,1,1] row_mask:0xf bank_mask:0xf
    s_nop 1
    v_add_f32_dpp v92, v38, v92 quad_perm:[2,2,2,2] row_mask:0xf bank_mask:0xf
    s_nop 1
    v_add_f32_dpp v92, v39, v92 quad_perm:[3,3,3,3] row_mask:0xf bank_mask:0xf
    v_cvt_pk_bf16_f32 v92, v92, v92
    v_and_b32 v92, 0xffff0000, v92
    v_mul_f32 v92, s92, v92
    v_cvt_pk_bf16_f32 v92, v92, v92
    v_and_b32 v92, 0xffff0000, v92
    s_and_b32 s0, s98, 0x000f000f
    s_mov_b32 s1, s0
    v_cndmask_b32 v92, v92, v98, s[0:1]
    v_max_f32 v60, v60, v92
    s_addk_i32 s7, 0x1000
    s_waitcnt vmcnt(8)
    s_cmpk_gt_u32 s62, 125
    s_cbranch_scc1 L_go_68
    s_waitcnt vmcnt(6)
    s_cmpk_le_u32 s63, 125
    s_cbranch_scc1 L_go_68
    s_waitcnt vmcnt(5)
L_go_68:
    buffer_load_dwordx4 v[132:135], v2, s[32:35], s7 offen nt
    v_mfma_f32_16x16x32_bf16 v[32:35], v[100:103], v[20:23], v[32:35]
    s_addk_i32 s7, 0x1000
    s_waitcnt vmcnt(8)
    s_cmpk_gt_u32 s62, 126
    s_cbranch_scc1 L_go_69
    s_waitcnt vmcnt(6)
    s_cmpk_le_u32 s63, 126
    s_cbranch_scc1 L_go_69
    s_waitcnt vmcnt(5)
L_go_69:
    buffer_load_dwordx4 v[136:139], v2, s[32:35], s7 offen nt
    v_mfma_f32_16x16x32_bf16 v[32:35], v[104:107], v[24:27], v[32:35]
    s_addk_i32 s7, 0x1000
    s_waitcnt vmcnt(8)
    s_cmpk_gt_u32 s62, 127
    s_cbranch_scc1 L_go_70
    s_waitcnt vmcnt(6)
    s_cmpk_le_u32 s63, 127
    s_cbranch_scc1 L_go_70
    s_waitcnt vmcnt(5)
L_go_70:
    buffer_load_dwordx4 v[140:143], v2, s[32:35], s7 offen nt
    v_mfma_f32_16x16x32_bf16 v[32:35], v[108:111], v[28:31], v[32:35]
    s_addk_i32 s7, 0x1000
    s_waitcnt vmcnt(8)
    s_cmpk_gt_u32 s62, 128
    s_cbranch_scc1 L_go_71
    s_waitcnt vmcnt(6)
    s_cmpk_le_u32 s63, 128
    s_cbranch_scc1 L_go_71
    s_waitcnt vmcnt(5)
L_go_71:
    buffer_load_dwordx4 v[144:147], v2, s[32:35], s7 offen nt
    v_mfma_f32_16x16x32_bf16 v[36:39], v[112:115], v[16:19], 0
    s_nop 1
    v_mov_b32_dpp v93, v32 quad_perm:[0,0,0,0] row_mask:0xf bank_mask:0xf
    s_nop 1
    v_add_f32_dpp v93, v33, v93 quad_perm:[1,1,1,1] row_mask:0xf bank_mask:0xf
    s_nop 1
    v_add_f32_dpp v93, v34, v93 quad_perm:[2,2,2,2] row_mask:0xf bank_mask:0xf
    s_nop 1
    v_add_f32_dpp v93, v35, v93 quad_perm:[3,3,3,3] row_mask:0xf bank_mask:0xf
    v_cvt_pk_bf16_f32 v93, v93, v93
    v_and_b32 v93, 0xffff0000, v93
    v_mul_f32 v93, s92, v93
    v_cvt_pk_bf16_f32 v93, v93, v93
    v_and_b32 v93, 0xffff0000, v93
    s_and_b32 s0, s98, 0xf0f0f0f0
    s_mov_b32 s1, s0
    v_cndmask_b32 v93, v93, v98, s[0:1]
    v_max_f32 v60, v60, v93
    s_addk_i32 s7, 0x1000
    s_or_b32 s73, s7, s71
    s_waitcnt vmcnt(8)
    s_cmpk_gt_u32 s62, 129
    s_cbranch_scc1 L_go_72
    s_waitcnt vmcnt(6)
    s_cmpk_le_u32 s63, 129
    s_cbranch_scc1 L_go_72
    s_waitcnt vmcnt(5)
L_go_72:
    buffer_load_dwordx4 v[148:151], v2, s[32:35], s73 offen nt
    v_mfma_f32_16x16x32_bf16 v[36:39], v[116:119], v[20:23], v[36:39]
    s_addk_i32 s7, 0x1000
    s_waitcnt vmcnt(8)
    s_cmpk_gt_u32 s62, 130
    s_cbranch_scc1 L_go_73
    s_waitcnt vmcnt(6)
    s_cmpk_le_u32 s63, 130
    s_cbranch_scc1 L_go_73
    s_waitcnt vmcnt(4)
L_go_73:
    buffer_load_dwordx4 v[152:155], v2, s[32:35], s7 offen nt
    v_mfma_f32_16x16x32_bf16 v[36:39], v[120:123], v[24:27], v[36:39]
    s_addk_i32 s7, 0x1000
    s_waitcnt vmcnt(8)
    s_cmpk_gt_u32 s62, 131
    s_cbranch_scc1 L_go_74
    s_waitcnt vmcnt(5)
    s_cmpk_le_u32 s63, 131
    s_cbranch_scc1 L_go_74
    s_waitcnt vmcnt(4)
L_go_74:
    buffer_load_dwordx4 v[156:159], v2, s[32:35], s7 offen nt
    v_mfma_f32_16x16x32_bf16 v[36:39], v[124:127], v[28:31], v[36:39]
    s_addk_i32 s7, 0x1000
    s_waitcnt vmcnt(8)
    s_cmpk_gt_u32 s62, 132
    s_cbranch_scc1 L_go_75
    s_waitcnt vmcnt(5)
    s_cmpk_le_u32 s63, 132
    s_cbranch_scc1 L_go_75
    s_waitcnt vmcnt(4)
L_go_75:
    buffer_load_dwordx4 v[160:163], v2, s[32:35], s7 offen nt
    v_mfma_f32_16x16x32_bf16 v[32:35], v[128:131], v[16:19], 0
    s_nop 1
    v_mov_b32_dpp v94, v36 quad_perm:[0,0,0,0] row_mask:0xf bank_mask:0xf
    s_nop 1
    v_add_f32_dpp v94, v37, v94 quad_perm:[1,1,1,1] row_mask:0xf bank_mask:0xf
    s_nop 1
    v_add_f32_dpp v94, v38, v94 quad_perm:[2,2,2,2] row_mask:0xf bank_mask:0xf
    s_nop 1
    v_add_f32_dpp v94, v39, v94 quad_perm:[3,3,3,3] row_mask:0xf bank_mask:0xf
    v_cvt_pk_bf16_f32 v94, v94, v94
    v_and_b32 v94, 0xffff0000, v94
    v_mul_f32 v94, s92, v94
    v_cvt_pk_bf16_f32 v94, v94, v94
    v_and_b32 v94, 0xffff0000, v94
    v_max_f32 v60, v60, v94
    s_addk_i32 s7, 0x1000
    s_waitcnt vmcnt(7)
    s_cmpk_gt_u32 s62, 133
    s_cbranch_scc1 L_go_76
    s_waitcnt vmcnt(5)
    s_cmpk_le_u32 s63, 133
    s_cbranch_scc1 L_go_76
    s_waitcnt vmcnt(4)
L_go_76:
    buffer_load_dwordx4 v[164:167], v2, s[32:35], s7 offen nt
L_ml_77:
    v_cmp_ne_u32 vcc, s77, v53
    v_cmp_ne_u32 s[96:97], s77, v55
    s_nop 0
    s_or_b64 vcc, vcc, s[96:97]
    s_mov_b32 s30, vcc_hi
    s_mov_b32 vcc_hi, 0
    s_cmp_lg_u32 vcc_lo, 0
    s_cbranch_scc1 L_ml_77_r
L_ml_77_d:
    v_cmp_ne_u32 vcc, s78, v52
    s_nop 0
    s_or_b32 s30, s30, vcc_hi
    v_max_f32_dpp v53, v52, v52 row_ror:8 row_mask:0xf bank_mask:0xf
    s_nop 1
    v_max_f32_dpp v53, v53, v53 row_ror:4 row_mask:0xf bank_mask:0xf
    s_nop 1
    v_max_f32_dpp v53, v53, v53 row_ror:2 row_mask:0xf bank_mask:0xf
    s_nop 1
    v_max_f32_dpp v53, v53, v53 row_ror:1 row_mask:0xf bank_mask:0xf
    v_mov_b32 v8, v53
    s_nop 1
    v_permlane16_swap_b32 v53, v8
    v_max_f32 v53, v53, v8
    v_sub_f32 v8, v52, v53
    v_mul_f32 v8, s93, v8
    v_exp_f32 v8, v8
    s_nop 0
    v_mul_f32 v54, v54, v8
    s_nop 1
    v_add_f32_dpp v54, v54, v54 row_ror:8 row_mask:0xf bank_mask:0xf
    s_nop 1
    v_add_f32_dpp v54, v54, v54 row_ror:4 row_mask:0xf bank_mask:0xf
    s_nop 1
    v_add_f32_dpp v54, v54, v54 row_ror:2 row_mask:0xf bank_mask:0xf
    s_nop 1
    v_add_f32_dpp v54, v54, v54 row_ror:1 row_mask:0xf bank_mask:0xf
    v_mov_b32 v8, v54
    s_nop 1
    v_permlane16_swap_b32 v54, v8
    v_add_f32 v54, v54, v8
    v_rcp_f32 v54, v54
    v_readfirstlane_b32 s4, v53
    v_readfirstlane_b32 s5, v54
    s_nop 0
    v_subrev_f32 v64, s4, v64
    v_subrev_f32 v65, s4, v65
    v_subrev_f32 v66, s4, v66
    v_subrev_f32 v67, s4, v67
    v_mul_f32 v64, s93, v64
    v_mul_f32 v65, s93, v65
    v_mul_f32 v66, s93, v66
    v_mul_f32 v67, s93, v67
    v_exp_f32 v64, v64
    v_exp_f32 v65, v65
    v_exp_f32 v66, v66
    v_exp_f32 v67, v67
    v_mul_f32 v64, s5, v64
    v_mul_f32 v65, s5, v65
    v_mul_f32 v66, s5, v66
    v_mul_f32 v67, s5, v67
    v_cvt_pk_bf16_f32 v64, v64, v64
    v_cvt_pk_bf16_f32 v65, v65, v65
    v_cvt_pk_bf16_f32 v66, v66, v66
    v_cvt_pk_bf16_f32 v67, v67, v67
    s_addk_i32 s7, 0x1000
    s_or_b32 s73, s7, s71
    s_waitcnt vmcnt(7)
    s_cmpk_gt_u32 s62, 134
    s_cbranch_scc1 L_go_78
    s_waitcnt vmcnt(5)
    s_cmpk_le_u32 s63, 134
    s_cbranch_scc1 L_go_78
    s_waitcnt vmcnt(4)
L_go_78:
    buffer_load_dwordx4 v[168:171], v2, s[32:35], s73 offen nt
    v_subrev_f32 v68, s4, v68
    v_subrev_f32 v69, s4, v69
    v_subrev_f32 v70, s4, v70
    v_subrev_f32 v71, s4, v71
    v_mul_f32 v68, s93, v68
    v_mul_f32 v69, s93, v69
    v_mul_f32 v70, s93, v70
    v_mul_f32 v71, s93, v71
    v_exp_f32 v68, v68
    v_exp_f32 v69, v69
    v_exp_f32 v70, v70
    v_exp_f32 v71, v71
    v_mul_f32 v68, s5, v68
    v_mul_f32 v69, s5, v69
    v_mul_f32 v70, s5, v70
    v_mul_f32 v71, s5, v71
    v_cvt_pk_bf16_f32 v68, v68, v68
    v_cvt_pk_bf16_f32 v69, v69, v69
    v_cvt_pk_bf16_f32 v70, v70, v70
    v_cvt_pk_bf16_f32 v71, v71, v71
    v_subrev_f32 v72, s4, v72
    v_subrev_f32 v73, s4, v73
    v_subrev_f32 v74, s4, v74
    v_subrev_f32 v75, s4, v75
    v_mul_f32 v72, s93, v72
    v_mul_f32 v73, s93, v73
    v_mul_f32 v74, s93, v74
    v_mul_f32 v75, s93, v75
    v_exp_f32 v72, v72
    v_exp_f32 v73, v73
    v_exp_f32 v74, v74
    v_exp_f32 v75, v75
    v_mul_f32 v72, s5, v72
    v_mul_f32 v73, s5, v73
    v_mul_f32 v74, s5, v74
    v_mul_f32 v75, s5, v75
    v_cvt_pk_bf16_f32 v72, v72, v72
    v_cvt_pk_bf16_f32 v73, v73, v73
    v_cvt_pk_bf16_f32 v74, v74, v74
    v_cvt_pk_bf16_f32 v75, v75, v75
    v_subrev_f32 v76, s4, v76
    v_subrev_f32 v77, s4, v77
    v_subrev_f32 v78, s4, v78
    v_subrev_f32 v79, s4, v79
    v_mul_f32 v76, s93, v76
    v_mul_f32 v77, s93, v77
    v_mul_f32 v78, s93, v78
    v_mul_f32 v79, s93, v79
    v_exp_f32 v76, v76
    v_exp_f32 v77, v77
    v_exp_f32 v78, v78
    v_exp_f32 v79, v79
    v_mul_f32 v76, s5, v76
    v_mul_f32 v77, s5, v77
    v_mul_f32 v78, s5, v78
    v_mul_f32 v79, s5, v79
    v_cvt_pk_bf16_f32 v76, v76, v76
    v_cvt_pk_bf16_f32 v77, v77, v77
    v_cvt_pk_bf16_f32 v78, v78, v78
    v_cvt_pk_bf16_f32 v79, v79, v79
    s_add_u32 s73, s72, 0x04030000
    s_waitcnt vmcnt(7)
    s_cmpk_gt_u32 s62, 135
    s_cbranch_scc1 L_go_79
    s_waitcnt vmcnt(5)
    s_cmpk_le_u32 s63, 135
    s_cbranch_scc1 L_go_79
    s_waitcnt vmcnt(4)
L_go_79:
    buffer_load_dwordx4 v[172:175], v2, s[32:35], s73 offen nt
    s_memrealtime s[74:75]
    v_subrev_f32 v80, s4, v80
    v_mul_f32 v80, s93, v80
    v_exp_f32 v80, v80
    s_nop 0
    v_mul_f32 v80, s5, v80
    v_cvt_pk_bf16_f32 v80, v80, v80
    v_mfma_f32_16x16x32_bf16 v[32:35], v[132:135], v[20:23], v[32:35]
    v_mfma_f32_16x16x32_bf16 v[32:35], v[136:139], v[24:27], v[32:35]
    v_mfma_f32_16x16x32_bf16 v[32:35], v[140:143], v[28:31], v[32:35]
    s_add_u32 s7, s70, 0x00000000
    s_or_b32 s73, s7, s71
    s_waitcnt vmcnt(7)
    s_cmpk_gt_u32 s62, 136
    s_cbranch_scc1 L_go_80
    s_waitcnt vmcnt(5)
    s_cmpk_le_u32 s63, 136
    s_cbranch_scc1 L_go_80
    s_waitcnt vmcnt(4)
L_go_80:
    buffer_load_dwordx4 v[176:179], v3, s[36:39], s73 offen nt
    s_waitcnt lgkmcnt(0)
    s_mov_b32 s68, 0
    s_sub_u32 s69, s60, s44
    s_cmp_eq_u32 s45, s77
    s_cselect_b32 s69, s69, -154
    s_add_u32 s68, s68, s69
    s_sub_u32 s69, s60, s46
    s_cmp_eq_u32 s47, s77
    s_cselect_b32 s69, s69, -154
    s_add_u32 s68, s68, s69
    s_sub_u32 s69, s60, s48
    s_cmp_eq_u32 s49, s77
    s_cselect_b32 s69, s69, -154
    s_add_u32 s68, s68, s69
    s_sub_u32 s69, s60, s50
    s_cmp_eq_u32 s51, s77
    s_cselect_b32 s69, s69, -154
    s_add_u32 s68, s68, s69
    s_sub_u32 s69, s60, s52
    s_cmp_eq_u32 s53, s77
    s_cselect_b32 s69, s69, -154
    s_add_u32 s68, s68, s69
    s_sub_u32 s69, s60, s54
    s_cmp_eq_u32 s55, s77
    s_cselect_b32 s69, s69, -154
    s_add_u32 s68, s68, s69
    s_sub_u32 s69, s60, s56
    s_cmp_eq_u32 s57, s77
    s_cselect_b32 s69, s69, -154
    s_add_u32 s68, s68, s69
    s_sub_u32 s69, s60, s58
    s_cmp_eq_u32 s59, s77
    s_cselect_b32 s69, s69, -154
    s_add_u32 s68, s68, s69
    s_mul_i32 s69, s60, 8
    s_sub_u32 s69, s69, s68
    s_sub_u32 s76, s69, s2
    s_mov_b32 s2, s69
    s_mul_i32 s96, s76, 235
    s_lshr_b32 s96, s96, 8
    s_sub_u32 s69, s74, s60
    s_mul_i32 s69, s69, 8
    s_sub_i32 s69, s69, s96
    s_mul_i32 s69, s69, 16
    s_ashr_i32 s69, s69, 4
    s_add_i32 s68, s68, s69
    s_max_i32 s69, s68, 0
    s_min_u32 s69, s69, 0x4000
    s_mul_i32 s69, s69, 1638
    s_lshr_b32 s69, s69, 16
    s_add_u32 s62, s69, 137
    s_sub_i32 s69, 0, s68
    s_max_i32 s69, s69, 0
    s_min_u32 s69, s69, 0x4000
    s_mul_i32 s69, s69, 1966
    s_lshr_b32 s69, s69, 16
    s_add_u32 s63, s69, 137
    v_mfma_f32_16x16x32_bf16 v[36:39], v[144:147], v[16:19], 0
    v_mov_b32_dpp v95, v32 quad_perm:[0,0,0,0] row_mask:0xf bank_mask:0xf
    s_nop 1
    v_add_f32_dpp v95, v33, v95 quad_perm:[1,1,1,1] row_mask:0xf bank_mask:0xf
    s_nop 1
    v_add_f32_dpp v95, v34, v95 quad_perm:[2,2,2,2] row_mask:0xf bank_mask:0xf
    s_nop 1
    v_add_f32_dpp v95, v35, v95 quad_perm:[3,3,3,3] row_mask:0xf bank_mask:0xf
    v_cvt_pk_bf16_f32 v95, v95, v95
    v_and_b32 v95, 0xffff0000, v95
    v_mul_f32 v95, s92, v95
    v_cvt_pk_bf16_f32 v95, v95, v95
    v_and_b32 v95, 0xffff0000, v95
    s_and_b32 s0, s98, 0x000f000f
    s_mov_b32 s1, s0
    v_cndmask_b32 v95, v95, v98, s[0:1]
    v_max_f32 v60, v60, v95
    s_addk_i32 s7, 0x1000
    s_waitcnt vmcnt(7)
    s_cmpk_gt_u32 s62, 137
    s_cbranch_scc1 L_go_81
    s_waitcnt vmcnt(5)
    s_cmpk_le_u32 s63, 137
    s_cbranch_scc1 L_go_81
    s_waitcnt vmcnt(4)
L_go_81:
    buffer_load_dwordx4 v[180:183], v3, s[36:39], s7 offen nt
    s_memrealtime s[60:61]
    v_mfma_f32_16x16x32_bf16 v[36:39], v[148:151], v[20:23], v[36:39]
    s_addk_i32 s7, 0x1000
    s_waitcnt vmcnt(7)
    s_cmpk_gt_u32 s62, 138
    s_cbranch_scc1 L_go_82
    s_waitcnt vmcnt(5)
    s_cmpk_le_u32 s63, 138
    s_cbranch_scc1 L_go_82
    s_waitcnt vmcnt(4)
L_go_82:
    buffer_load_dwordx4 v[184:187], v3, s[36:39], s7 offen nt
    s_cmp_lg_u32 s64, 0
    s_cbranch_scc1 L_ref_83_r
L_ref_83:
    v_mfma_f32_16x16x32_bf16 v[36:39], v[152:155], v[24:27], v[36:39]
    s_addk_i32 s7, 0x1000
    s_waitcnt vmcnt(7)
    s_cmpk_gt_u32 s62, 139
    s_cbranch_scc1 L_go_84
    s_waitcnt vmcnt(5)
    s_cmpk_le_u32 s63, 139
    s_cbranch_scc1 L_go_84
    s_waitcnt vmcnt(4)
L_go_84:
    buffer_load_dwordx4 v[188:191], v3, s[36:39], s7 offen nt
    v_mfma_f32_16x16x32_bf16 v[36:39], v[156:159], v[28:31], v[36:39]
    s_addk_i32 s7, 0x1000
    s_waitcnt vmcnt(7)
    s_cmpk_gt_u32 s62, 140
    s_cbranch_scc1 L_go_85
    s_waitcnt vmcnt(5)
    s_cmpk_le_u32 s63, 140
    s_cbranch_scc1 L_go_85
    s_waitcnt vmcnt(4)
L_go_85:
    buffer_load_dwordx4 v[192:195], v3, s[36:39], s7 offen nt
    v_mfma_f32_16x16x32_bf16 v[32:35], v[160:163], v[16:19], 0
    s_nop 1
    v_mov_b32_dpp v96, v36 quad_perm:[0,0,0,0] row_mask:0xf bank_mask:0xf
    s_nop 1
    v_add_f32_dpp v96, v37, v96 quad_perm:[1,1,1,1] row_mask:0xf bank_mask:0xf
    s_nop 1
    v_add_f32_dpp v96, v38, v96 quad_perm:[2,2,2,2] row_mask:0xf bank_mask:0xf
    s_nop 1
    v_add_f32_dpp v96, v39, v96 quad_perm:[3,3,3,3] row_mask:0xf bank_mask:0xf
    v_cvt_pk_bf16_f32 v96, v96, v96
    v_and_b32 v96, 0xffff0000, v96
    v_mul_f32 v96, s92, v96
    v_cvt_pk_bf16_f32 v96, v96, v96
    v_and_b32 v96, 0xffff0000, v96
    s_and_b32 s0, s98, 0x00f000f0
    s_mov_b32 s1, s0
    v_cndmask_b32 v96, v96, v98, s[0:1]
    v_max_f32 v60, v60, v96
    s_addk_i32 s7, 0x1000
    s_or_b32 s73, s7, s71
    s_waitcnt vmcnt(7)
    s_cmpk_gt_u32 s62, 141
    s_cbranch_scc1 L_go_86
    s_waitcnt vmcnt(5)
    s_cmpk_le_u32 s63, 141
    s_cbranch_scc1 L_go_86
    s_waitcnt vmcnt(4)
L_go_86:
    buffer_load_dwordx4 v[196:199], v3, s[36:39], s73 offen nt
    v_mfma_f32_16x16x32_bf16 v[32:35], v[164:167], v[20:23], v[32:35]
    s_addk_i32 s7, 0x1000
    s_waitcnt vmcnt(7)
    s_cmpk_gt_u32 s62, 142
    s_cbranch_scc1 L_go_87
    s_waitcnt vmcnt(5)
    s_cmpk_le_u32 s63, 142
    s_cbranch_scc1 L_go_87
    s_waitcnt vmcnt(4)
L_go_87:
    buffer_load_dwordx4 v[200:203], v3, s[36:39], s7 offen nt
    v_mfma_f32_16x16x32_bf16 v[32:35], v[168:171], v[24:27], v[32:35]
    s_addk_i32 s7, 0x1000
    s_waitcnt vmcnt(7)
    s_cmpk_gt_u32 s62, 143
    s_cbranch_scc1 L_go_88
    s_waitcnt vmcnt(5)
    s_cmpk_le_u32 s63, 143
    s_cbranch_scc1 L_go_88
    s_waitcnt vmcnt(4)
L_go_88:
    buffer_load_dwordx4 v[204:207], v3, s[36:39], s7 offen nt
    v_mfma_f32_16x16x32_bf16 v[32:35], v[172:175], v[28:31], v[32:35]
    s_nop 7
    v_mov_b32_dpp v97, v32 quad_perm:[0,0,0,0] row_mask:0xf bank_mask:0xf
    s_nop 1
    v_add_f32_dpp v97, v33, v97 quad_perm:[1,1,1,1] row_mask:0xf bank_mask:0xf
    s_nop 1
    v_add_f32_dpp v97, v34, v97 quad_perm:[2,2,2,2] row_mask:0xf bank_mask:0xf
    s_nop 1
    v_add_f32_dpp v97, v35, v97 quad_perm:[3,3,3,3] row_mask:0xf bank_mask:0xf
    v_cvt_pk_bf16_f32 v97, v97, v97
    v_and_b32 v97, 0xffff0000, v97
    v_mul_f32 v97, s92, v97
    v_cvt_pk_bf16_f32 v97, v97, v97
    v_and_b32 v97, 0xffff0000, v97
    s_and_b32 s0, s98, 0x0f000f00
    s_mov_b32 s1, s0
    v_cndmask_b32 v97, v97, v98, s[0:1]
    v_max_f32 v60, v60, v97
    s_nop 1
    v_max_f32_dpp v60, v60, v60 row_ror:8 row_mask:0xf bank_mask:0xf
    s_nop 1
    v_max_f32_dpp v60, v60, v60 row_ror:4 row_mask:0xf bank_mask:0xf
    v_mov_b32 v44, v60
    s_nop 1
    v_permlane16_swap_b32 v60, v44
    v_max_f32 v60, v60, v44
    v_mov_b32 v44, v60
    s_nop 1
    v_permlane32_swap_b32 v60, v44
    v_max_f32 v60, v60, v44
    v_mov_b32 v56, v60
    v_mov_b32 v57, 0
    v_sub_f32 v44, v81, v56
    v_sub_f32 v45, v82, v56
    v_sub_f32 v46, v83, v56
    v_sub_f32 v47, v84, v56
    v_mul_f32 v44, s93, v44
    v_mul_f32 v45, s93, v45
    v_mul_f32 v46, s93, v46
    v_mul_f32 v47, s93, v47
    v_exp_f32 v44, v44
    v_exp_f32 v45, v45
    v_exp_f32 v46, v46
    v_exp_f32 v47, v47
    v_add_f32 v57, v57, v44
    v_add_f32 v57, v57, v45
    v_add_f32 v57, v57, v46
    v_add_f32 v57, v57, v47
    s_addk_i32 s7, 0x1000
    s_waitcnt vmcnt(7)
    s_cmpk_gt_u32 s62, 144
    s_cbranch_scc1 L_go_89
    s_waitcnt vmcnt(5)
    s_cmpk_le_u32 s63, 144
    s_cbranch_scc1 L_go_89
    s_waitcnt vmcnt(4)
L_go_89:
    buffer_load_dwordx4 v[208:211], v3, s[36:39], s7 offen nt
    v_sub_f32 v44, v85, v56
    v_sub_f32 v45, v86, v56
    v_sub_f32 v46, v87, v56
    v_sub_f32 v47, v88, v56
    v_mul_f32 v44, s93, v44
    v_mul_f32 v45, s93, v45
    v_mul_f32 v46, s93, v46
    v_mul_f32 v47, s93, v47
    v_exp_f32 v44, v44
    v_exp_f32 v45, v45
    v_exp_f32 v46, v46
    v_exp_f32 v47, v47
    v_add_f32 v57, v57, v44
    v_add_f32 v57, v57, v45
    v_add_f32 v57, v57, v46
    v_add_f32 v57, v57, v47
    v_sub_f32 v44, v89, v56
    v_sub_f32 v45, v90, v56
    v_sub_f32 v46, v91, v56
    v_sub_f32 v47, v92, v56
    v_mul_f32 v44, s93, v44
    v_mul_f32 v45, s93, v45
    v_mul_f32 v46, s93, v46
    v_mul_f32 v47, s93, v47
    v_exp_f32 v44, v44
    v_exp_f32 v45, v45
    v_exp_f32 v46, v46
    v_exp_f32 v47, v47
    v_add_f32 v57, v57, v44
    v_add_f32 v57, v57, v45
    v_add_f32 v57, v57, v46
    v_add_f32 v57, v57, v47
    v_sub_f32 v44, v93, v56
    v_sub_f32 v45, v94, v56
    v_sub_f32 v46, v95, v56
    v_sub_f32 v47, v96, v56
    v_mul_f32 v44, s93, v44
    v_mul_f32 v45, s93, v45
    v_mul_f32 v46, s93, v46
    v_mul_f32 v47, s93, v47
    v_exp_f32 v44, v44
    v_exp_f32 v45, v45
    v_exp_f32 v46, v46
    v_exp_f32 v47, v47
    v_add_f32 v57, v57, v44
    v_add_f32 v57, v57, v45
    v_add_f32 v57, v57, v46
    v_add_f32 v57, v57, v47
    s_addk_i32 s7, 0x1000
    s_waitcnt vmcnt(7)
    s_cmpk_gt_u32 s62, 145
    s_cbranch_scc1 L_go_90
    s_waitcnt vmcnt(5)
    s_cmpk_le_u32 s63, 145
    s_cbranch_scc1 L_go_90
    s_waitcnt vmcnt(4)
L_go_90:
    buffer_load_dwordx4 v[212:215], v3, s[36:39], s7 offen nt
    v_sub_f32 v44, v97, v56
    v_mul_f32 v44, s93, v44
    v_exp_f32 v44, v44
    s_nop 0
    v_add_f32 v57, v57, v44
    s_nop 1
    v_add_f32_dpp v57, v57, v57 row_ror:8 row_mask:0xf bank_mask:0xf
    s_nop 1
    v_add_f32_dpp v57, v57, v57 row_ror:4 row_mask:0xf bank_mask:0xf
    v_mov_b32 v44, v57
    s_nop 1
    v_permlane16_swap_b32 v57, v44
    v_add_f32 v57, v57, v44
    v_mov_b32 v44, v57
    s_nop 1
    v_permlane32_swap_b32 v57, v44
    v_add_f32 v57, v57, v44
    v_mov_b32 v8, s99
    s_mov_b64 exec, 1
    ds_write_b64 v8, v[56:57] offset:4704
    ds_add_rtn_u32 v8, v61, v5 offset:4620
    s_mov_b64 exec, -1
    ds_read_b64 v[44:45], v4 offset:4704
    s_waitcnt lgkmcnt(0)
    v_readfirstlane_b32 s96, v8
    s_nop 0
    s_cmp_lg_u32 s96, 2
    s_cbranch_scc1 L_mlast_91
    v_mov_b32 v8, s78
    v_cndmask_b32 v56, v8, v44, s[80:81]
    v_mov_b32 v57, s77
    v_mov_b32 v58, v45
    v_mov_b32 v59, s77
    s_add_u32 s96, s91, 32768
    s_mov_b64 exec, 0xff
    s_cmp_lg_u32 s31, 0
    s_cbranch_scc1 L_mlast_91_far
    buffer_store_dwordx4 v[56:59], v15, s[40:43], s96 offen
L_mlast_91:
    s_mov_b64 exec, -1
    s_addk_i32 s7, 0x1000
    s_or_b32 s73, s7, s71
    s_waitcnt vmcnt(7)
    s_cmpk_gt_u32 s62, 146
    s_cbranch_scc1 L_go_92
    s_waitcnt vmcnt(5)
    s_cmpk_le_u32 s63, 146
    s_cbranch_scc1 L_go_92
    s_waitcnt vmcnt(4)
L_go_92:
    buffer_load_dwordx4 v[216:219], v3, s[36:39], s73 offen nt
    s_memrealtime s[74:75]
    v_and_b32_dpp v44, v64, v10 row_newbcast:0 row_mask:0xf bank_mask:0xf
    v_and_b32_dpp v45, v64, v11 row_newbcast:0 row_mask:0xf bank_mask:0xf
    v_and_b32_dpp v46, v64, v12 row_newbcast:0 row_mask:0xf bank_mask:0xf
    v_and_b32_dpp v47, v64, v13 row_newbcast:0 row_mask:0xf bank_mask:0xf
    s_nop 1
    v_mfma_f32_16x16x32_bf16 v[40:43], v[176:179], v[44:47], 0
    v_and_b32_dpp v48, v64, v10 row_newbcast:4 row_mask:0xf bank_mask:0xf
    v_and_b32_dpp v49, v64, v11 row_newbcast:4 row_mask:0xf bank_mask:0xf
    v_and_b32_dpp v50, v64, v12 row_newbcast:4 row_mask:0xf bank_mask:0xf
    v_and_b32_dpp v51, v64, v13 row_newbcast:4 row_mask:0xf bank_mask:0xf
    s_nop 1
    v_mfma_f32_16x16x32_bf16 v[40:43], v[180:183], v[48:51], v[40:43]
    v_and_b32_dpp v44, v64, v10 row_newbcast:8 row_mask:0xf bank_mask:0xf
    v_and_b32_dpp v45, v64, v11 row_newbcast:8 row_mask:0xf bank_mask:0xf
    v_and_b32_dpp v46, v64, v12 row_newbcast:8 row_mask:0xf bank_mask:0xf
    v_and_b32_dpp v47, v64, v13 row_newbcast:8 row_mask:0xf bank_mask:0xf
    s_nop 1
    v_mfma_f32_16x16x32_bf16 v[40:43], v[184:187], v[44:47], v[40:43]
    v_and_b32_dpp v48, v64, v10 row_newbcast:12 row_mask:0xf bank_mask:0xf
    v_and_b32_dpp v49, v64, v11 row_newbcast:12 row_mask:0xf bank_mask:0xf
    v_and_b32_dpp v50, v64, v12 row_newbcast:12 row_mask:0xf bank_mask:0xf
    v_and_b32_dpp v51, v64, v13 row_newbcast:12 row_mask:0xf bank_mask:0xf
    s_addk_i32 s7, 0x1000
    s_waitcnt vmcnt(7)
    s_cmpk_gt_u32 s62, 147
    s_cbranch_scc1 L_go_93
    s_waitcnt vmcnt(5)
    s_cmpk_le_u32 s63, 147
    s_cbranch_scc1 L_go_93
    s_waitcnt vmcnt(4)
L_go_93:
    buffer_load_dwordx4 v[220:223], v3, s[36:39], s7 offen nt
    s_mul_i32 s96, s76, 352
    s_lshr_b32 s96, s96, 8
    s_add_u32 s96, s96, s2
    s_waitcnt lgkmcnt(0)
    s_mul_i32 s68, s74, 8
    s_sub_u32 s68, s68, s96
    s_max_i32 s69, s68, 0
    s_min_u32 s69, s69, 0x4000
    s_mul_i32 s69, s69, 1638
    s_lshr_b32 s69, s69, 16
    s_add_u32 s62, s69, 148
    s_sub_i32 s69, 0, s68
    s_max_i32 s69, s69, 0
    s_min_u32 s69, s69, 0x4000
    s_mul_i32 s69, s69, 1966
    s_lshr_b32 s69, s69, 16
    s_add_u32 s63, s69, 148
    v_mfma_f32_16x16x32_bf16 v[40:43], v[188:191], v[48:51], v[40:43]
    v_and_b32_dpp v44, v65, v10 row_newbcast:0 row_mask:0xf bank_mask:0xf
    v_and_b32_dpp v45, v65, v11 row_newbcast:0 row_mask:0xf bank_mask:0xf
    v_and_b32_dpp v46, v65, v12 row_newbcast:0 row_mask:0xf bank_mask:0xf
    v_and_b32_dpp v47, v65, v13 row_newbcast:0 row_mask:0xf bank_mask:0xf
    s_addk_i32 s7, 0x1000
    s_waitcnt vmcnt(7)
    s_cmpk_gt_u32 s62, 148
    s_cbranch_scc1 L_go_94
    s_waitcnt vmcnt(5)
    s_cmpk_le_u32 s63, 148
    s_cbranch_scc1 L_go_94
    s_waitcnt vmcnt(4)
L_go_94:
    buffer_load_dwordx4 v[224:227], v3, s[36:39], s7 offen nt
    s_load_dwordx2 s[44:45], s[66:67], 640
    s_load_dwordx2 s[46:47], s[66:67], 4992
    s_load_dwordx2 s[48:49], s[66:67], 9344
    s_load_dwordx2 s[50:51], s[66:67], 13696
    s_load_dwordx2 s[52:53], s[66:67], 18048
    s_load_dwordx2 s[54:55], s[66:67], 22400
    s_load_dwordx2 s[56:57], s[66:67], 26752
    s_load_dwordx2 s[58:59], s[66:67], 31104
    v_mfma_f32_16x16x32_bf16 v[40:43], v[192:195], v[44:47], v[40:43]
    v_and_b32_dpp v48, v65, v10 row_newbcast:4 row_mask:0xf bank_mask:0xf
    v_and_b32_dpp v49, v65, v11 row_newbcast:4 row_mask:0xf bank_mask:0xf
    v_and_b32_dpp v50, v65, v12 row_newbcast:4 row_mask:0xf bank_mask:0xf
    v_and_b32_dpp v51, v65, v13 row_newbcast:4 row_mask:0xf bank_mask:0xf
    s_addk_i32 s7, 0x1000
    s_waitcnt vmcnt(7)
    s_cmpk_gt_u32 s62, 149
    s_cbranch_scc1 L_go_95
    s_waitcnt vmcnt(5)
    s_cmpk_le_u32 s63, 149
    s_cbranch_scc1 L_go_95
    s_waitcnt vmcnt(4)
L_go_95:
    buffer_load_dwordx4 v[228:231], v3, s[36:39], s7 offen nt
    v_mfma_f32_16x16x32_bf16 v[40:43], v[196:199], v[48:51], v[40:43]
    v_and_b32_dpp v44, v65, v10 row_newbcast:8 row_mask:0xf bank_mask:0xf
    v_and_b32_dpp v45, v65, v11 row_newbcast:8 row_mask:0xf bank_mask:0xf
    v_and_b32_dpp v46, v65, v12 row_newbcast:8 row_mask:0xf bank_mask:0xf
    v_and_b32_dpp v47, v65, v13 row_newbcast:8 row_mask:0xf bank_mask:0xf
    s_addk_i32 s7, 0x1000
    s_waitcnt vmcnt(7)
    s_cmpk_gt_u32 s62, 150
    s_cbranch_scc1 L_go_96
    s_waitcnt vmcnt(5)
    s_cmpk_le_u32 s63, 150
    s_cbranch_scc1 L_go_96
    s_waitcnt vmcnt(4)
L_go_96:
    buffer_load_dwordx4 v[232:235], v3, s[36:39], s7 offen nt
    v_mfma_f32_16x16x32_bf16 v[40:43], v[200:203], v[44:47], v[40:43]
    v_and_b32_dpp v48, v65, v10 row_newbcast:12 row_mask:0xf bank_mask:0xf
    v_and_b32_dpp v49, v65, v11 row_newbcast:12 row_mask:0xf bank_mask:0xf
    v_and_b32_dpp v50, v65, v12 row_newbcast:12 row_mask:0xf bank_mask:0xf
    v_and_b32_dpp v51, v65, v13 row_newbcast:12 row_mask:0xf bank_mask:0xf
    s_addk_i32 s7, 0x1000
    s_or_b32 s73, s7, s71
    s_waitcnt vmcnt(7)
    s_cmpk_gt_u32 s62, 151
    s_cbranch_scc1 L_go_97
    s_waitcnt vmcnt(5)
    s_cmpk_le_u32 s63, 151
    s_cbranch_scc1 L_go_97
    s_waitcnt vmcnt(4)
L_go_97:
    buffer_load_dwordx4 v[236:239], v3, s[36:39], s73 offen nt
    v_mfma_f32_16x16x32_bf16 v[40:43], v[204:207], v[48:51], v[40:43]
    v_and_b32_dpp v44, v66, v10 row_newbcast:0 row_mask:0xf bank_mask:0xf
    v_and_b32_dpp v45, v66, v11 row_newbcast:0 row_mask:0xf bank_mask:0xf
    v_and_b32_dpp v46, v66, v12 row_newbcast:0 row_mask:0xf bank_mask:0xf
    v_and_b32_dpp v47, v66, v13 row_newbcast:0 row_mask:0xf bank_mask:0xf
    s_add_u32 s73, s72, 0x00000000
    s_waitcnt vmcnt(7)
    s_cmpk_gt_u32 s62, 152
    s_cbranch_scc1 L_go_98
    s_waitcnt vmcnt(5)
    s_cmpk_le_u32 s63, 152
    s_cbranch_scc1 L_go_98
    s_waitcnt vmcnt(4)
L_go_98:
    buffer_load_dwordx4 v[240:243], v3, s[36:39], s73 offen nt
    v_mfma_f32_16x16x32_bf16 v[40:43], v[208:211], v[44:47], v[40:43]
    v_and_b32_dpp v48, v66, v10 row_newbcast:4 row_mask:0xf bank_mask:0xf
    v_and_b32_dpp v49, v66, v11 row_newbcast:4 row_mask:0xf bank_mask:0xf
    v_and_b32_dpp v50, v66, v12 row_newbcast:4 row_mask:0xf bank_mask:0xf
    v_and_b32_dpp v51, v66, v13 row_newbcast:4 row_mask:0xf bank_mask:0xf
    s_addk_i32 s7, 0x1000
    s_or_b32 s73, s7, s71
    s_waitcnt vmcnt(7)
    s_cmpk_gt_u32 s62, 153
    s_cbranch_scc1 L_go_99
    s_waitcnt vmcnt(5)
    s_cmpk_le_u32 s63, 153
    s_cbranch_scc1 L_go_99
    s_waitcnt vmcnt(4)
L_go_99:
    buffer_load_dwordx4 v[244:247], v3, s[36:39], s73 offen nt
    v_mfma_f32_16x16x32_bf16 v[40:43], v[212:215], v[48:51], v[40:43]
    v_and_b32_dpp v44, v66, v10 row_newbcast:8 row_mask:0xf bank_mask:0xf
    v_and_b32_dpp v45, v66, v11 row_newbcast:8 row_mask:0xf bank_mask:0xf
    v_and_b32_dpp v46, v66, v12 row_newbcast:8 row_mask:0xf bank_mask:0xf
    v_and_b32_dpp v47, v66, v13 row_newbcast:8 row_mask:0xf bank_mask:0xf
    s_addk_i32 s7, 0x1000
    s_waitcnt vmcnt(7)
    s_cmpk_gt_u32 s62, 154
    s_cbranch_scc1 L_go_100
    s_waitcnt vmcnt(5)
    s_cmpk_le_u32 s63, 154
    s_cbranch_scc1 L_go_100
    s_waitcnt vmcnt(4)
L_go_100:
    buffer_load_dwordx4 v[248:251], v3, s[36:39], s7 offen nt
    v_mfma_f32_16x16x32_bf16 v[40:43], v[216:219], v[44:47], v[40:43]
    v_and_b32_dpp v48, v66, v10 row_newbcast:12 row_mask:0xf bank_mask:0xf
    v_and_b32_dpp v49, v66, v11 row_newbcast:12 row_mask:0xf bank_mask:0xf
    v_and_b32_dpp v50, v66, v12 row_newbcast:12 row_mask:0xf bank_mask:0xf
    v_and_b32_dpp v51, v66, v13 row_newbcast:12 row_mask:0xf bank_mask:0xf
    s_addk_i32 s7, 0x1000
    s_waitcnt vmcnt(7)
    s_cmpk_gt_u32 s62, 155
    s_cbranch_scc1 L_go_101
    s_waitcnt vmcnt(5)
    s_cmpk_le_u32 s63, 155
    s_cbranch_scc1 L_go_101
    s_waitcnt vmcnt(4)
L_go_101:
    buffer_load_dwordx4 v[252:255], v3, s[36:39], s7 offen nt
    v_mfma_f32_16x16x32_bf16 v[40:43], v[220:223], v[48:51], v[40:43]
    v_and_b32_dpp v44, v67, v10 row_newbcast:0 row_mask:0xf bank_mask:0xf
    v_and_b32_dpp v45, v67, v11 row_newbcast:0 row_mask:0xf bank_mask:0xf
    v_and_b32_dpp v46, v67, v12 row_newbcast:0 row_mask:0xf bank_mask:0xf
    v_and_b32_dpp v47, v67, v13 row_newbcast:0 row_mask:0xf bank_mask:0xf
    s_addk_i32 s7, 0x1000
    s_waitcnt vmcnt(7)
    s_cmpk_gt_u32 s62, 156
    s_cbranch_scc1 L_go_102
    s_waitcnt vmcnt(5)
    s_cmpk_le_u32 s63, 156
    s_cbranch_scc1 L_go_102
    s_waitcnt vmcnt(4)
L_go_102:
    buffer_load_dwordx4 v[100:103], v3, s[36:39], s7 offen nt
    v_mfma_f32_16x16x32_bf16 v[40:43], v[224:227], v[44:47], v[40:43]
    v_and_b32_dpp v48, v67, v10 row_newbcast:4 row_mask:0xf bank_mask:0xf
    v_and_b32_dpp v49, v67, v11 row_newbcast:4 row_mask:0xf bank_mask:0xf
    v_and_b32_dpp v50, v67, v12 row_newbcast:4 row_mask:0xf bank_mask:0xf
    v_and_b32_dpp v51, v67, v13 row_newbcast:4 row_mask:0xf bank_mask:0xf
    s_addk_i32 s7, 0x1000
    s_waitcnt vmcnt(7)
    s_cmpk_gt_u32 s62, 157
    s_cbranch_scc1 L_go_103
    s_waitcnt vmcnt(5)
    s_cmpk_le_u32 s63, 157
    s_cbranch_scc1 L_go_103
    s_waitcnt vmcnt(4)
L_go_103:
    buffer_load_dwordx4 v[104:107], v3, s[36:39], s7 offen nt
    v_mfma_f32_16x16x32_bf16 v[40:43], v[228:231], v[48:51], v[40:43]
    v_and_b32_dpp v44, v67, v10 row_newbcast:8 row_mask:0xf bank_mask:0xf
    v_and_b32_dpp v45, v67, v11 row_newbcast:8 row_mask:0xf bank_mask:0xf
    v_and_b32_dpp v46, v67, v12 row_newbcast:8 row_mask:0xf bank_mask:0xf
    v_and_b32_dpp v47, v67, v13 row_newbcast:8 row_mask:0xf bank_mask:0xf
    s_addk_i32 s7, 0x1000
    s_or_b32 s73, s7, s71
    s_waitcnt vmcnt(7)
    s_cmpk_gt_u32 s62, 158
    s_cbranch_scc1 L_go_104
    s_waitcnt vmcnt(5)
    s_cmpk_le_u32 s63, 158
    s_cbranch_scc1 L_go_104
    s_waitcnt vmcnt(4)
L_go_104:
    buffer_load_dwordx4 v[108:111], v3, s[36:39], s73 offen nt
    v_mfma_f32_16x16x32_bf16 v[40:43], v[232:235], v[44:47], v[40:43]
    v_and_b32_dpp v48, v67, v10 row_newbcast:12 row_mask:0xf bank_mask:0xf
    v_and_b32_dpp v49, v67, v11 row_newbcast:12 row_mask:0xf bank_mask:0xf
    v_and_b32_dpp v50, v67, v12 row_newbcast:12 row_mask:0xf bank_mask:0xf
    v_and_b32_dpp v51, v67, v13 row_newbcast:12 row_mask:0xf bank_mask:0xf
    s_addk_i32 s7, 0x1000
    s_waitcnt vmcnt(7)
    s_cmpk_gt_u32 s62, 159
    s_cbranch_scc1 L_go_105
    s_waitcnt vmcnt(5)
    s_cmpk_le_u32 s63, 159
    s_cbranch_scc1 L_go_105
    s_waitcnt vmcnt(4)
L_go_105:
    buffer_load_dwordx4 v[112:115], v3, s[36:39], s7 offen nt
    s_memrealtime s[74:75]
    v_mfma_f32_16x16x32_bf16 v[40:43], v[236:239], v[48:51], v[40:43]
    v_and_b32_dpp v44, v68, v10 row_newbcast:0 row_mask:0xf bank_mask:0xf
    v_and_b32_dpp v45, v68, v11 row_newbcast:0 row_mask:0xf bank_mask:0xf
    v_and_b32_dpp v46, v68, v12 row_newbcast:0 row_mask:0xf bank_mask:0xf
    v_and_b32_dpp v47, v68, v13 row_newbcast:0 row_mask:0xf bank_mask:0xf
    s_addk_i32 s7, 0x1000
    s_waitcnt vmcnt(7)
    s_cmpk_gt_u32 s62, 160
    s_cbranch_scc1 L_go_106
    s_waitcnt vmcnt(5)
    s_cmpk_le_u32 s63, 160
    s_cbranch_scc1 L_go_106
    s_waitcnt vmcnt(4)
L_go_106:
    buffer_load_dwordx4 v[116:119], v3, s[36:39], s7 offen nt
    s_waitcnt lgkmcnt(0)
    s_mov_b32 s68, 0
    s_sub_u32 s69, s60, s44
    s_cmp_eq_u32 s45, s77
    s_cselect_b32 s69, s69, -154
    s_add_u32 s68, s68, s69
    s_sub_u32 s69, s60, s46
    s_cmp_eq_u32 s47, s77
    s_cselect_b32 s69, s69, -154
    s_add_u32 s68, s68, s69
    s_sub_u32 s69, s60, s48
    s_cmp_eq_u32 s49, s77
    s_cselect_b32 s69, s69, -154
    s_add_u32 s68, s68, s69
    s_sub_u32 s69, s60, s50
    s_cmp_eq_u32 s51, s77
    s_cselect_b32 s69, s69, -154
    s_add_u32 s68, s68, s69
    s_sub_u32 s69, s60, s52
    s_cmp_eq_u32 s53, s77
    s_cselect_b32 s69, s69, -154
    s_add_u32 s68, s68, s69
    s_sub_u32 s69, s60, s54
    s_cmp_eq_u32 s55, s77
    s_cselect_b32 s69, s69, -154
    s_add_u32 s68, s68, s69
    s_sub_u32 s69, s60, s56
    s_cmp_eq_u32 s57, s77
    s_cselect_b32 s69, s69, -154
    s_add_u32 s68, s68, s69
    s_sub_u32 s69, s60, s58
    s_cmp_eq_u32 s59, s77
    s_cselect_b32 s69, s69, -154
    s_add_u32 s68, s68, s69
    s_mul_i32 s69, s60, 8
    s_sub_u32 s69, s69, s68
    s_sub_u32 s76, s69, s2
    s_mov_b32 s2, s69
    s_mul_i32 s96, s76, 235
    s_lshr_b32 s96, s96, 8
    s_sub_u32 s69, s74, s60
    s_mul_i32 s69, s69, 8
    s_sub_i32 s69, s69, s96
    s_mul_i32 s69, s69, 16
    s_ashr_i32 s69, s69, 4
    s_add_i32 s68, s68, s69
    s_max_i32 s69, s68, 0
    s_min_u32 s69, s69, 0x4000
    s_mul_i32 s69, s69, 1638
    s_lshr_b32 s69, s69, 16
    s_add_u32 s62, s69, 161
    s_sub_i32 s69, 0, s68
    s_max_i32 s69, s69, 0
    s_min_u32 s69, s69, 0x4000
    s_mul_i32 s69, s69, 1966
    s_lshr_b32 s69, s69, 16
    s_add_u32 s63, s69, 161
    v_mfma_f32_16x16x32_bf16 v[40:43], v[240:243], v[44:47], v[40:43]
    v_and_b32_dpp v48, v68, v10 row_newbcast:4 row_mask:0xf bank_mask:0xf
    v_and_b32_dpp v49, v68, v11 row_newbcast:4 row_mask:0xf bank_mask:0xf
    v_and_b32_dpp v50, v68, v12 row_newbcast:4 row_mask:0xf bank_mask:0xf
    v_and_b32_dpp v51, v68, v13 row_newbcast:4 row_mask:0xf bank_mask:0xf
    s_addk_i32 s7, 0x1000
    s_waitcnt vmcnt(7)
    s_cmpk_gt_u32 s62, 161
    s_cbranch_scc1 L_go_107
    s_waitcnt vmcnt(5)
    s_cmpk_le_u32 s63, 161
    s_cbranch_scc1 L_go_107
    s_waitcnt vmcnt(4)
L_go_107:
    buffer_load_dwordx4 v[120:123], v3, s[36:39], s7 offen nt
    s_memrealtime s[60:61]
    v_mfma_f32_16x16x32_bf16 v[40:43], v[244:247], v[48:51], v[40:43]
    v_and_b32_dpp v44, v68, v10 row_newbcast:8 row_mask:0xf bank_mask:0xf
    v_and_b32_dpp v45, v68, v11 row_newbcast:8 row_mask:0xf bank_mask:0xf
    v_and_b32_dpp v46, v68, v12 row_newbcast:8 row_mask:0xf bank_mask:0xf
    v_and_b32_dpp v47, v68, v13 row_newbcast:8 row_mask:0xf bank_mask:0xf
    s_addk_i32 s7, 0x1000
    s_waitcnt vmcnt(7)
    s_cmpk_gt_u32 s62, 162
    s_cbranch_scc1 L_go_108
    s_waitcnt vmcnt(5)
    s_cmpk_le_u32 s63, 162
    s_cbranch_scc1 L_go_108
    s_waitcnt vmcnt(4)
L_go_108:
    buffer_load_dwordx4 v[124:127], v3, s[36:39], s7 offen nt
    s_cmp_lg_u32 s64, 0
    s_cbranch_scc1 L_ref_109_r
L_ref_109:
    v_mfma_f32_16x16x32_bf16 v[40:43], v[248:251], v[44:47], v[40:43]
    v_and_b32_dpp v48, v68, v10 row_newbcast:12 row_mask:0xf bank_mask:0xf
    v_and_b32_dpp v49, v68, v11 row_newbcast:12 row_mask:0xf bank_mask:0xf
    v_and_b32_dpp v50, v68, v12 row_newbcast:12 row_mask:0xf bank_mask:0xf
    v_and_b32_dpp v51, v68, v13 row_newbcast:12 row_mask:0xf bank_mask:0xf
    s_addk_i32 s7, 0x1000
    s_or_b32 s73, s7, s71
    s_waitcnt vmcnt(7)
    s_cmpk_gt_u32 s62, 163
    s_cbranch_scc1 L_go_110
    s_waitcnt vmcnt(5)
    s_cmpk_le_u32 s63, 163
    s_cbranch_scc1 L_go_110
    s_waitcnt vmcnt(4)
L_go_110:
    buffer_load_dwordx4 v[128:131], v3, s[36:39], s73 offen nt
    v_mfma_f32_16x16x32_bf16 v[40:43], v[252:255], v[48:51], v[40:43]
    v_and_b32_dpp v44, v69, v10 row_newbcast:0 row_mask:0xf bank_mask:0xf
    v_and_b32_dpp v45, v69, v11 row_newbcast:0 row_mask:0xf bank_mask:0xf
    v_and_b32_dpp v46, v69, v12 row_newbcast:0 row_mask:0xf bank_mask:0xf
    v_and_b32_dpp v47, v69, v13 row_newbcast:0 row_mask:0xf bank_mask:0xf
    s_addk_i32 s7, 0x1000
    s_waitcnt vmcnt(7)
    s_cmpk_gt_u32 s62, 164
    s_cbranch_scc1 L_go_111
    s_waitcnt vmcnt(5)
    s_cmpk_le_u32 s63, 164
    s_cbranch_scc1 L_go_111
    s_waitcnt vmcnt(4)
L_go_111:
    buffer_load_dwordx4 v[132:135], v3, s[36:39], s7 offen nt
    v_mfma_f32_16x16x32_bf16 v[40:43], v[100:103], v[44:47], v[40:43]
    v_and_b32_dpp v48, v69, v10 row_newbcast:4 row_mask:0xf bank_mask:0xf
    v_and_b32_dpp v49, v69, v11 row_newbcast:4 row_mask:0xf bank_mask:0xf
    v_and_b32_dpp v50, v69, v12 row_newbcast:4 row_mask:0xf bank_mask:0xf
    v_and_b32_dpp v51, v69, v13 row_newbcast:4 row_mask:0xf bank_mask:0xf
    s_addk_i32 s7, 0x1000
    s_waitcnt vmcnt(7)
    s_cmpk_gt_u32 s62, 165
    s_cbranch_scc1 L_go_112
    s_waitcnt vmcnt(5)
    s_cmpk_le_u32 s63, 165
    s_cbranch_scc1 L_go_112
    s_waitcnt vmcnt(4)
L_go_112:
    buffer_load_dwordx4 v[136:139], v3, s[36:39], s7 offen nt
    v_mfma_f32_16x16x32_bf16 v[40:43], v[104:107], v[48:51], v[40:43]
    v_and_b32_dpp v44, v69, v10 row_newbcast:8 row_mask:0xf bank_mask:0xf
    v_and_b32_dpp v45, v69, v11 row_newbcast:8 row_mask:0xf bank_mask:0xf
    v_and_b32_dpp v46, v69, v12 row_newbcast:8 row_mask:0xf bank_mask:0xf
    v_and_b32_dpp v47, v69, v13 row_newbcast:8 row_mask:0xf bank_mask:0xf
    s_addk_i32 s7, 0x1000
    s_waitcnt vmcnt(7)
    s_cmpk_gt_u32 s62, 166
    s_cbranch_scc1 L_go_113
    s_waitcnt vmcnt(5)
    s_cmpk_le_u32 s63, 166
    s_cbranch_scc1 L_go_113
    s_waitcnt vmcnt(4)
L_go_113:
    buffer_load_dwordx4 v[140:143], v3, s[36:39], s7 offen nt
    v_mfma_f32_16x16x32_bf16 v[40:43], v[108:111], v[44:47], v[40:43]
    v_and_b32_dpp v48, v69, v10 row_newbcast:12 row_mask:0xf bank_mask:0xf
    v_and_b32_dpp v49, v69, v11 row_newbcast:12 row_mask:0xf bank_mask:0xf
    v_and_b32_dpp v50, v69, v12 row_newbcast:12 row_mask:0xf bank_mask:0xf
    v_and_b32_dpp v51, v69, v13 row_newbcast:12 row_mask:0xf bank_mask:0xf
    s_addk_i32 s7, 0x1000
    s_waitcnt vmcnt(7)
    s_cmpk_gt_u32 s62, 167
    s_cbranch_scc1 L_go_114
    s_waitcnt vmcnt(5)
    s_cmpk_le_u32 s63, 167
    s_cbranch_scc1 L_go_114
    s_waitcnt vmcnt(4)
L_go_114:
    buffer_load_dwordx4 v[144:147], v3, s[36:39], s7 offen nt
    v_mfma_f32_16x16x32_bf16 v[40:43], v[112:115], v[48:51], v[40:43]
    v_and_b32_dpp v44, v70, v10 row_newbcast:0 row_mask:0xf bank_mask:0xf
    v_and_b32_dpp v45, v70, v11 row_newbcast:0 row_mask:0xf bank_mask:0xf
    v_and_b32_dpp v46, v70, v12 row_newbcast:0 row_mask:0xf bank_mask:0xf
    v_and_b32_dpp v47, v70, v13 row_newbcast:0 row_mask:0xf bank_mask:0xf
    s_addk_i32 s7, 0x1000
    s_or_b32 s73, s7, s71
    s_waitcnt vmcnt(7)
    s_cmpk_gt_u32 s62, 168
    s_cbranch_scc1 L_go_115
    s_waitcnt vmcnt(5)
    s_cmpk_le_u32 s63, 168
    s_cbranch_scc1 L_go_115
    s_waitcnt vmcnt(4)
L_go_115:
    buffer_load_dwordx4 v[148:151], v3, s[36:39], s73 offen nt
    v_mfma_f32_16x16x32_bf16 v[40:43], v[116:119], v[44:47], v[40:43]
    v_and_b32_dpp v48, v70, v10 row_newbcast:4 row_mask:0xf bank_mask:0xf
    v_and_b32_dpp v49, v70, v11 row_newbcast:4 row_mask:0xf bank_mask:0xf
    v_and_b32_dpp v50, v70, v12 row_newbcast:4 row_mask:0xf bank_mask:0xf
    v_and_b32_dpp v51, v70, v13 row_newbcast:4 row_mask:0xf bank_mask:0xf
    s_add_u32 s73, s72, 0x00010000
    s_waitcnt vmcnt(7)
    s_cmpk_gt_u32 s62, 169
    s_cbranch_scc1 L_go_116
    s_waitcnt vmcnt(5)
    s_cmpk_le_u32 s63, 169
    s_cbranch_scc1 L_go_116
    s_waitcnt vmcnt(4)
L_go_116:
    buffer_load_dwordx4 v[152:155], v3, s[36:39], s73 offen nt
    v_mfma_f32_16x16x32_bf16 v[40:43], v[120:123], v[48:51], v[40:43]
    v_and_b32_dpp v44, v70, v10 row_newbcast:8 row_mask:0xf bank_mask:0xf
    v_and_b32_dpp v45, v70, v11 row_newbcast:8 row_mask:0xf bank_mask:0xf
    v_and_b32_dpp v46, v70, v12 row_newbcast:8 row_mask:0xf bank_mask:0xf
    v_and_b32_dpp v47, v70, v13 row_newbcast:8 row_mask:0xf bank_mask:0xf
    s_addk_i32 s7, 0x1000
    s_or_b32 s73, s7, s71
    s_waitcnt vmcnt(7)
    s_cmpk_gt_u32 s62, 170
    s_cbranch_scc1 L_go_117
    s_waitcnt vmcnt(5)
    s_cmpk_le_u32 s63, 170
    s_cbranch_scc1 L_go_117
    s_waitcnt vmcnt(4)
L_go_117:
    buffer_load_dwordx4 v[156:159], v3, s[36:39], s73 offen nt
    s_memrealtime s[74:75]
    v_mfma_f32_16x16x32_bf16 v[40:43], v[124:127], v[44:47], v[40:43]
    v_and_b32_dpp v48, v70, v10 row_newbcast:12 row_mask:0xf bank_mask:0xf
    v_and_b32_dpp v49, v70, v11 row_newbcast:12 row_mask:0xf bank_mask:0xf
    v_and_b32_dpp v50, v70, v12 row_newbcast:12 row_mask:0xf bank_mask:0xf
    v_and_b32_dpp v51, v70, v13 row_newbcast:12 row_mask:0xf bank_mask:0xf
    s_addk_i32 s7, 0x1000
    s_waitcnt vmcnt(7)
    s_cmpk_gt_u32 s62, 171
    s_cbranch_scc1 L_go_118
    s_waitcnt vmcnt(5)
    s_cmpk_le_u32 s63, 171
    s_cbranch_scc1 L_go_118
    s_waitcnt vmcnt(4)
L_go_118:
    buffer_load_dwordx4 v[160:163], v3, s[36:39], s7 offen nt
    s_mul_i32 s96, s76, 352
    s_lshr_b32 s96, s96, 8
    s_add_u32 s96, s96, s2
    s_waitcnt lgkmcnt(0)
    s_mul_i32 s68, s74, 8
    s_sub_u32 s68, s68, s96
    s_max_i32 s69, s68, 0
    s_min_u32 s69, s69, 0x4000
    s_mul_i32 s69, s69, 1638
    s_lshr_b32 s69, s69, 16
    s_add_u32 s62, s69, 172
    s_sub_i32 s69, 0, s68
    s_max_i32 s69, s69, 0
    s_min_u32 s69, s69, 0x4000
    s_mul_i32 s69, s69, 1966
    s_lshr_b32 s69, s69, 16
    s_add_u32 s63, s69, 172
    v_mfma_f32_16x16x32_bf16 v[40:43], v[128:131], v[48:51], v[40:43]
    v_and_b32_dpp v44, v71, v10 row_newbcast:0 row_mask:0xf bank_mask:0xf
    v_and_b32_dpp v45, v71, v11 row_newbcast:0 row_mask:0xf bank_mask:0xf
    v_and_b32_dpp v46, v71, v12 row_newbcast:0 row_mask:0xf bank_mask:0xf
    v_and_b32_dpp v47, v71, v13 row_newbcast:0 row_mask:0xf bank_mask:0xf
    s_addk_i32 s7, 0x1000
    s_waitcnt vmcnt(7)
    s_cmpk_gt_u32 s62, 172
    s_cbranch_scc1 L_go_119
    s_waitcnt vmcnt(5)
    s_cmpk_le_u32 s63, 172
    s_cbranch_scc1 L_go_119
    s_waitcnt vmcnt(4)
L_go_119:
    buffer_load_dwordx4 v[164:167], v3, s[36:39], s7 offen nt
    s_load_dwordx2 s[44:45], s[66:67], 768
    s_load_dwordx2 s[46:47], s[66:67], 5120
    s_load_dwordx2 s[48:49], s[66:67], 9472
    s_load_dwordx2 s[50:51], s[66:67], 13824
    s_load_dwordx2 s[52:53], s[66:67], 18176
    s_load_dwordx2 s[54:55], s[66:67], 22528
    s_load_dwordx2 s[56:57], s[66:67], 26880
    s_load_dwordx2 s[58:59], s[66:67], 31232
    v_mfma_f32_16x16x32_bf16 v[40:43], v[132:135], v[44:47], v[40:43]
    v_and_b32_dpp v48, v71, v10 row_newbcast:4 row_mask:0xf bank_mask:0xf
    v_and_b32_dpp v49, v71, v11 row_newbcast:4 row_mask:0xf bank_mask:0xf
    v_and_b32_dpp v50, v71, v12 row_newbcast:4 row_mask:0xf bank_mask:0xf
    v_and_b32_dpp v51, v71, v13 row_newbcast:4 row_mask:0xf bank_mask:0xf
    s_addk_i32 s7, 0x1000
    s_waitcnt vmcnt(7)
    s_cmpk_gt_u32 s62, 173
    s_cbranch_scc1 L_go_120
    s_waitcnt vmcnt(5)
    s_cmpk_le_u32 s63, 173
    s_cbranch_scc1 L_go_120
    s_waitcnt vmcnt(4)
L_go_120:
    buffer_load_dwordx4 v[168:171], v3, s[36:39], s7 offen nt
    v_mfma_f32_16x16x32_bf16 v[40:43], v[136:139], v[48:51], v[40:43]
    v_and_b32_dpp v44, v71, v10 row_newbcast:8 row_mask:0xf bank_mask:0xf
    v_and_b32_dpp v45, v71, v11 row_newbcast:8 row_mask:0xf bank_mask:0xf
    v_and_b32_dpp v46, v71, v12 row_newbcast:8 row_mask:0xf bank_mask:0xf
    v_and_b32_dpp v47, v71, v13 row_newbcast:8 row_mask:0xf bank_mask:0xf
    s_addk_i32 s7, 0x1000
    s_waitcnt vmcnt(7)
    s_cmpk_gt_u32 s62, 174
    s_cbranch_scc1 L_go_121
    s_waitcnt vmcnt(5)
    s_cmpk_le_u32 s63, 174
    s_cbranch_scc1 L_go_121
    s_waitcnt vmcnt(4)
L_go_121:
    buffer_load_dwordx4 v[172:175], v3, s[36:39], s7 offen nt
    v_mfma_f32_16x16x32_bf16 v[40:43], v[140:143], v[44:47], v[40:43]
    v_and_b32_dpp v48, v71, v10 row_newbcast:12 row_mask:0xf bank_mask:0xf
    v_and_b32_dpp v49, v71, v11 row_newbcast:12 row_mask:0xf bank_mask:0xf
    v_and_b32_dpp v50, v71, v12 row_newbcast:12 row_mask:0xf bank_mask:0xf
    v_and_b32_dpp v51, v71, v13 row_newbcast:12 row_mask:0xf bank_mask:0xf
    s_addk_i32 s7, 0x1000
    s_or_b32 s73, s7, s71
    s_waitcnt vmcnt(7)
    s_cmpk_gt_u32 s62, 175
    s_cbranch_scc1 L_go_122
    s_waitcnt vmcnt(5)
    s_cmpk_le_u32 s63, 175
    s_cbranch_scc1 L_go_122
    s_waitcnt vmcnt(4)
L_go_122:
    buffer_load_dwordx4 v[176:179], v3, s[36:39], s73 offen nt
    v_mfma_f32_16x16x32_bf16 v[40:43], v[144:147], v[48:51], v[40:43]
    v_and_b32_dpp v44, v72, v10 row_newbcast:0 row_mask:0xf bank_mask:0xf
    v_and_b32_dpp v45, v72, v11 row_newbcast:0 row_mask:0xf bank_mask:0xf
    v_and_b32_dpp v46, v72, v12 row_newbcast:0 row_mask:0xf bank_mask:0xf
    v_and_b32_dpp v47, v72, v13 row_newbcast:0 row_mask:0xf bank_mask:0xf
    s_addk_i32 s7, 0x1000
    s_waitcnt vmcnt(7)
    s_cmpk_gt_u32 s62, 176
    s_cbranch_scc1 L_go_123
    s_waitcnt vmcnt(5)
    s_cmpk_le_u32 s63, 176
    s_cbranch_scc1 L_go_123
    s_waitcnt vmcnt(4)
L_go_123:
    buffer_load_dwordx4 v[180:183], v3, s[36:39], s7 offen nt
    v_mfma_f32_16x16x32_bf16 v[40:43], v[148:151], v[44:47], v[40:43]
    v_and_b32_dpp v48, v72, v10 row_newbcast:4 row_mask:0xf bank_mask:0xf
    v_and_b32_dpp v49, v72, v11 row_newbcast:4 row_mask:0xf bank_mask:0xf
    v_and_b32_dpp v50, v72, v12 row_newbcast:4 row_mask:0xf bank_mask:0xf
    v_and_b32_dpp v51, v72, v13 row_newbcast:4 row_mask:0xf bank_mask:0xf
    s_addk_i32 s7, 0x1000
    s_waitcnt vmcnt(7)
    s_cmpk_gt_u32 s62, 177
    s_cbranch_scc1 L_go_124
    s_waitcnt vmcnt(5)
    s_cmpk_le_u32 s63, 177
    s_cbranch_scc1 L_go_124
    s_waitcnt vmcnt(4)
L_go_124:
    buffer_load_dwordx4 v[184:187], v3, s[36:39], s7 offen nt
    v_mfma_f32_16x16x32_bf16 v[40:43], v[152:155], v[48:51], v[40:43]
    v_and_b32_dpp v44, v72, v10 row_newbcast:8 row_mask:0xf bank_mask:0xf
    v_and_b32_dpp v45, v72, v11 row_newbcast:8 row_mask:0xf bank_mask:0xf
    v_and_b32_dpp v46, v72, v12 row_newbcast:8 row_mask:0xf bank_mask:0xf
    v_and_b32_dpp v47, v72, v13 row_newbcast:8 row_mask:0xf bank_mask:0xf
    s_addk_i32 s7, 0x1000
    s_waitcnt vmcnt(7)
    s_cmpk_gt_u32 s62, 178
    s_cbranch_scc1 L_go_125
    s_waitcnt vmcnt(5)
    s_cmpk_le_u32 s63, 178
    s_cbranch_scc1 L_go_125
    s_waitcnt vmcnt(4)
L_go_125:
    buffer_load_dwordx4 v[188:191], v3, s[36:39], s7 offen nt
    v_mfma_f32_16x16x32_bf16 v[40:43], v[156:159], v[44:47], v[40:43]
    v_and_b32_dpp v48, v72, v10 row_newbcast:12 row_mask:0xf bank_mask:0xf
    v_and_b32_dpp v49, v72, v11 row_newbcast:12 row_mask:0xf bank_mask:0xf
    v_and_b32_dpp v50, v72, v12 row_newbcast:12 row_mask:0xf bank_mask:0xf
    v_and_b32_dpp v51, v72, v13 row_newbcast:12 row_mask:0xf bank_mask:0xf
    s_addk_i32 s7, 0x1000
    s_waitcnt vmcnt(7)
    s_cmpk_gt_u32 s62, 179
    s_cbranch_scc1 L_go_126
    s_waitcnt vmcnt(5)
    s_cmpk_le_u32 s63, 179
    s_cbranch_scc1 L_go_126
    s_waitcnt vmcnt(4)
L_go_126:
    buffer_load_dwordx4 v[192:195], v3, s[36:39], s7 offen nt
    v_mfma_f32_16x16x32_bf16 v[40:43], v[160:163], v[48:51], v[40:43]
    v_and_b32_dpp v44, v73, v10 row_newbcast:0 row_mask:0xf bank_mask:0xf
    v_and_b32_dpp v45, v73, v11 row_newbcast:0 row_mask:0xf bank_mask:0xf
    v_and_b32_dpp v46, v73, v12 row_newbcast:0 row_mask:0xf bank_mask:0xf
    v_and_b32_dpp v47, v73, v13 row_newbcast:0 row_mask:0xf bank_mask:0xf
    s_addk_i32 s7, 0x1000
    s_or_b32 s73, s7, s71
    s_waitcnt vmcnt(7)
    s_cmpk_gt_u32 s62, 180
    s_cbranch_scc1 L_go_127
    s_waitcnt vmcnt(5)
    s_cmpk_le_u32 s63, 180
    s_cbranch_scc1 L_go_127
    s_waitcnt vmcnt(4)
L_go_127:
    buffer_load_dwordx4 v[196:199], v3, s[36:39], s73 offen nt
    v_mfma_f32_16x16x32_bf16 v[40:43], v[164:167], v[44:47], v[40:43]
    v_and_b32_dpp v48, v73, v10 row_newbcast:4 row_mask:0xf bank_mask:0xf
    v_and_b32_dpp v49, v73, v11 row_newbcast:4 row_mask:0xf bank_mask:0xf
    v_and_b32_dpp v50, v73, v12 row_newbcast:4 row_mask:0xf bank_mask:0xf
    v_and_b32_dpp v51, v73, v13 row_newbcast:4 row_mask:0xf bank_mask:0xf
    s_addk_i32 s7, 0x1000
    s_waitcnt vmcnt(7)
    s_cmpk_gt_u32 s62, 181
    s_cbranch_scc1 L_go_128
    s_waitcnt vmcnt(5)
    s_cmpk_le_u32 s63, 181
    s_cbranch_scc1 L_go_128
    s_waitcnt vmcnt(4)
L_go_128:
    buffer_load_dwordx4 v[200:203], v3, s[36:39], s7 offen nt
    v_mfma_f32_16x16x32_bf16 v[40:43], v[168:171], v[48:51], v[40:43]
    v_and_b32_dpp v44, v73, v10 row_newbcast:8 row_mask:0xf bank_mask:0xf
    v_and_b32_dpp v45, v73, v11 row_newbcast:8 row_mask:0xf bank_mask:0xf
    v_and_b32_dpp v46, v73, v12 row_newbcast:8 row_mask:0xf bank_mask:0xf
    v_and_b32_dpp v47, v73, v13 row_newbcast:8 row_mask:0xf bank_mask:0xf
    s_addk_i32 s7, 0x1000
    s_waitcnt vmcnt(7)
    s_cmpk_gt_u32 s62, 182
    s_cbranch_scc1 L_go_129
    s_waitcnt vmcnt(5)
    s_cmpk_le_u32 s63, 182
    s_cbranch_scc1 L_go_129
    s_waitcnt vmcnt(4)
L_go_129:
    buffer_load_dwordx4 v[204:207], v3, s[36:39], s7 offen nt
    v_mfma_f32_16x16x32_bf16 v[40:43], v[172:175], v[44:47], v[40:43]
    v_and_b32_dpp v48, v73, v10 row_newbcast:12 row_mask:0xf bank_mask:0xf
    v_and_b32_dpp v49, v73, v11 row_newbcast:12 row_mask:0xf bank_mask:0xf
    v_and_b32_dpp v50, v73, v12 row_newbcast:12 row_mask:0xf bank_mask:0xf
    v_and_b32_dpp v51, v73, v13 row_newbcast:12 row_mask:0xf bank_mask:0xf
    s_addk_i32 s7, 0x1000
    s_waitcnt vmcnt(7)
    s_cmpk_gt_u32 s62, 183
    s_cbranch_scc1 L_go_130
    s_waitcnt vmcnt(5)
    s_cmpk_le_u32 s63, 183
    s_cbranch_scc1 L_go_130
    s_waitcnt vmcnt(4)
L_go_130:
    buffer_load_dwordx4 v[208:211], v3, s[36:39], s7 offen nt
    s_memrealtime s[74:75]
    v_mfma_f32_16x16x32_bf16 v[40:43], v[176:179], v[48:51], v[40:43]
    v_and_b32_dpp v44, v74, v10 row_newbcast:0 row_mask:0xf bank_mask:0xf
    v_and_b32_dpp v45, v74, v11 row_newbcast:0 row_mask:0xf bank_mask:0xf
    v_and_b32_dpp v46, v74, v12 row_newbcast:0 row_mask:0xf bank_mask:0xf
    v_and_b32_dpp v47, v74, v13 row_newbcast:0 row_mask:0xf bank_mask:0xf
    s_addk_i32 s7, 0x1000
    s_waitcnt vmcnt(7)
    s_cmpk_gt_u32 s62, 184
    s_cbranch_scc1 L_go_131
    s_waitcnt vmcnt(5)
    s_cmpk_le_u32 s63, 184
    s_cbranch_scc1 L_go_131
    s_waitcnt vmcnt(4)
L_go_131:
    buffer_load_dwordx4 v[212:215], v3, s[36:39], s7 offen nt
    s_waitcnt lgkmcnt(0)
    s_mov_b32 s68, 0
    s_sub_u32 s69, s60, s44
    s_cmp_eq_u32 s45, s77
    s_cselect_b32 s69, s69, -154
    s_add_u32 s68, s68, s69
    s_sub_u32 s69, s60, s46
    s_cmp_eq_u32 s47, s77
    s_cselect_b32 s69, s69, -154
    s_add_u32 s68, s68, s69
    s_sub_u32 s69, s60, s48
    s_cmp_eq_u32 s49, s77
    s_cselect_b32 s69, s69, -154
    s_add_u32 s68, s68, s69
    s_sub_u32 s69, s60, s50
    s_cmp_eq_u32 s51, s77
    s_cselect_b32 s69, s69, -154
    s_add_u32 s68, s68, s69
    s_sub_u32 s69, s60, s52
    s_cmp_eq_u32 s53, s77
    s_cselect_b32 s69, s69, -154
    s_add_u32 s68, s68, s69
    s_sub_u32 s69, s60, s54
    s_cmp_eq_u32 s55, s77
    s_cselect_b32 s69, s69, -154
    s_add_u32 s68, s68, s69
    s_sub_u32 s69, s60, s56
    s_cmp_eq_u32 s57, s77
    s_cselect_b32 s69, s69, -154
    s_add_u32 s68, s68, s69
    s_sub_u32 s69, s60, s58
    s_cmp_eq_u32 s59, s77
    s_cselect_b32 s69, s69, -154
    s_add_u32 s68, s68, s69
    s_mul_i32 s69, s60, 8
    s_sub_u32 s69, s69, s68
    s_sub_u32 s76, s69, s2
    s_mov_b32 s2, s69
    s_mul_i32 s96, s76, 235
    s_lshr_b32 s96, s96, 8
    s_sub_u32 s69, s74, s60
    s_mul_i32 s69, s69, 8
    s_sub_i32 s69, s69, s96
    s_mul_i32 s69, s69, 16
    s_ashr_i32 s69, s69, 4
    s_add_i32 s68, s68, s69
    s_max_i32 s69, s68, 0
    s_min_u32 s69, s69, 0x4000
    s_mul_i32 s69, s69, 1638
    s_lshr_b32 s69, s69, 16
    s_add_u32 s62, s69, 185
    s_sub_i32 s69, 0, s68
    s_max_i32 s69, s69, 0
    s_min_u32 s69, s69, 0x4000
    s_mul_i32 s69, s69, 1966
    s_lshr_b32 s69, s69, 16
    s_add_u32 s63, s69, 185
    v_mfma_f32_16x16x32_bf16 v[40:43], v[180:183], v[44:47], v[40:43]
    v_and_b32_dpp v48, v74, v10 row_newbcast:4 row_mask:0xf bank_mask:0xf
    v_and_b32_dpp v49, v74, v11 row_newbcast:4 row_mask:0xf bank_mask:0xf
    v_and_b32_dpp v50, v74, v12 row_newbcast:4 row_mask:0xf bank_mask:0xf
    v_and_b32_dpp v51, v74, v13 row_newbcast:4 row_mask:0xf bank_mask:0xf
    s_addk_i32 s7, 0x1000
    s_or_b32 s73, s7, s71
    s_waitcnt vmcnt(7)
    s_cmpk_gt_u32 s62, 185
    s_cbranch_scc1 L_go_132
    s_waitcnt vmcnt(5)
    s_cmpk_le_u32 s63, 185
    s_cbranch_scc1 L_go_132
    s_waitcnt vmcnt(4)
L_go_132:
    buffer_load_dwordx4 v[216:219], v3, s[36:39], s73 offen nt
    s_memrealtime s[60:61]
    v_mfma_f32_16x16x32_bf16 v[40:43], v[184:187], v[48:51], v[40:43]
    v_and_b32_dpp v44, v74, v10 row_newbcast:8 row_mask:0xf bank_mask:0xf
    v_and_b32_dpp v45, v74, v11 row_newbcast:8 row_mask:0xf bank_mask:0xf
    v_and_b32_dpp v46, v74, v12 row_newbcast:8 row_mask:0xf bank_mask:0xf
    v_and_b32_dpp v47, v74, v13 row_newbcast:8 row_mask:0xf bank_mask:0xf
    s_add_u32 s73, s72, 0x00020000
    s_waitcnt vmcnt(7)
    s_cmpk_gt_u32 s62, 186
    s_cbranch_scc1 L_go_133
    s_waitcnt vmcnt(5)
    s_cmpk_le_u32 s63, 186
    s_cbranch_scc1 L_go_133
    s_waitcnt vmcnt(4)
L_go_133:
    buffer_load_dwordx4 v[220:223], v3, s[36:39], s73 offen nt
    s_cmp_lg_u32 s64, 0
    s_cbranch_scc1 L_ref_134_r
L_ref_134:
    v_mfma_f32_16x16x32_bf16 v[40:43], v[188:191], v[44:47], v[40:43]
    v_and_b32_dpp v48, v74, v10 row_newbcast:12 row_mask:0xf bank_mask:0xf
    v_and_b32_dpp v49, v74, v11 row_newbcast:12 row_mask:0xf bank_mask:0xf
    v_and_b32_dpp v50, v74, v12 row_newbcast:12 row_mask:0xf bank_mask:0xf
    v_and_b32_dpp v51, v74, v13 row_newbcast:12 row_mask:0xf bank_mask:0xf
    s_addk_i32 s7, 0x1000
    s_or_b32 s73, s7, s71
    s_waitcnt vmcnt(7)
    s_cmpk_gt_u32 s62, 187
    s_cbranch_scc1 L_go_135
    s_waitcnt vmcnt(5)
    s_cmpk_le_u32 s63, 187
    s_cbranch_scc1 L_go_135
    s_waitcnt vmcnt(4)
L_go_135:
    buffer_load_dwordx4 v[224:227], v3, s[36:39], s73 offen nt
    v_mfma_f32_16x16x32_bf16 v[40:43], v[192:195], v[48:51], v[40:43]
    v_and_b32_dpp v44, v75, v10 row_newbcast:0 row_mask:0xf bank_mask:0xf
    v_and_b32_dpp v45, v75, v11 row_newbcast:0 row_mask:0xf bank_mask:0xf
    v_and_b32_dpp v46, v75, v12 row_newbcast:0 row_mask:0xf bank_mask:0xf
    v_and_b32_dpp v47, v75, v13 row_newbcast:0 row_mask:0xf bank_mask:0xf
    s_addk_i32 s7, 0x1000
    s_waitcnt vmcnt(7)
    s_cmpk_gt_u32 s62, 188
    s_cbranch_scc1 L_go_136
    s_waitcnt vmcnt(5)
    s_cmpk_le_u32 s63, 188
    s_cbranch_scc1 L_go_136
    s_waitcnt vmcnt(4)
L_go_136:
    buffer_load_dwordx4 v[228:231], v3, s[36:39], s7 offen nt
    v_mfma_f32_16x16x32_bf16 v[40:43], v[196:199], v[44:47], v[40:43]
    v_and_b32_dpp v48, v75, v10 row_newbcast:4 row_mask:0xf bank_mask:0xf
    v_and_b32_dpp v49, v75, v11 row_newbcast:4 row_mask:0xf bank_mask:0xf
    v_and_b32_dpp v50, v75, v12 row_newbcast:4 row_mask:0xf bank_mask:0xf
    v_and_b32_dpp v51, v75, v13 row_newbcast:4 row_mask:0xf bank_mask:0xf
    s_addk_i32 s7, 0x1000
    s_waitcnt vmcnt(7)
    s_cmpk_gt_u32 s62, 189
    s_cbranch_scc1 L_go_137
    s_waitcnt vmcnt(5)
    s_cmpk_le_u32 s63, 189
    s_cbranch_scc1 L_go_137
    s_waitcnt vmcnt(4)
L_go_137:
    buffer_load_dwordx4 v[232:235], v3, s[36:39], s7 offen nt
    v_mfma_f32_16x16x32_bf16 v[40:43], v[200:203], v[48:51], v[40:43]
    v_and_b32_dpp v44, v75, v10 row_newbcast:8 row_mask:0xf bank_mask:0xf
    v_and_b32_dpp v45, v75, v11 row_newbcast:8 row_mask:0xf bank_mask:0xf
    v_and_b32_dpp v46, v75, v12 row_newbcast:8 row_mask:0xf bank_mask:0xf
    v_and_b32_dpp v47, v75, v13 row_newbcast:8 row_mask:0xf bank_mask:0xf
    s_addk_i32 s7, 0x1000
    s_waitcnt vmcnt(7)
    s_cmpk_gt_u32 s62, 190
    s_cbranch_scc1 L_go_138
    s_waitcnt vmcnt(5)
    s_cmpk_le_u32 s63, 190
    s_cbranch_scc1 L_go_138
    s_waitcnt vmcnt(4)
L_go_138:
    buffer_load_dwordx4 v[236:239], v3, s[36:39], s7 offen nt
    v_mfma_f32_16x16x32_bf16 v[40:43], v[204:207], v[44:47], v[40:43]
    v_and_b32_dpp v48, v75, v10 row_newbcast:12 row_mask:0xf bank_mask:0xf
    v_and_b32_dpp v49, v75, v11 row_newbcast:12 row_mask:0xf bank_mask:0xf
    v_and_b32_dpp v50, v75, v12 row_newbcast:12 row_mask:0xf bank_mask:0xf
    v_and_b32_dpp v51, v75, v13 row_newbcast:12 row_mask:0xf bank_mask:0xf
    s_addk_i32 s7, 0x1000
    s_waitcnt vmcnt(7)
    s_cmpk_gt_u32 s62, 191
    s_cbranch_scc1 L_go_139
    s_waitcnt vmcnt(5)
    s_cmpk_le_u32 s63, 191
    s_cbranch_scc1 L_go_139
    s_waitcnt vmcnt(4)
L_go_139:
    buffer_load_dwordx4 v[240:243], v3, s[36:39], s7 offen nt
    v_mfma_f32_16x16x32_bf16 v[40:43], v[208:211], v[48:51], v[40:43]
    v_and_b32_dpp v44, v76, v10 row_newbcast:0 row_mask:0xf bank_mask:0xf
    v_and_b32_dpp v45, v76, v11 row_newbcast:0 row_mask:0xf bank_mask:0xf
    v_and_b32_dpp v46, v76, v12 row_newbcast:0 row_mask:0xf bank_mask:0xf
    v_and_b32_dpp v47, v76, v13 row_newbcast:0 row_mask:0xf bank_mask:0xf
    s_addk_i32 s7, 0x1000
    s_or_b32 s73, s7, s71
    s_waitcnt vmcnt(7)
    s_cmpk_gt_u32 s62, 192
    s_cbranch_scc1 L_go_140
    s_waitcnt vmcnt(5)
    s_cmpk_le_u32 s63, 192
    s_cbranch_scc1 L_go_140
    s_waitcnt vmcnt(4)
L_go_140:
    buffer_load_dwordx4 v[244:247], v3, s[36:39], s73 offen nt
    v_mfma_f32_16x16x32_bf16 v[40:43], v[212:215], v[44:47], v[40:43]
    v_and_b32_dpp v48, v76, v10 row_newbcast:4 row_mask:0xf bank_mask:0xf
    v_and_b32_dpp v49, v76, v11 row_newbcast:4 row_mask:0xf bank_mask:0xf
    v_and_b32_dpp v50, v76, v12 row_newbcast:4 row_mask:0xf bank_mask:0xf
    v_and_b32_dpp v51, v76, v13 row_newbcast:4 row_mask:0xf bank_mask:0xf
    s_addk_i32 s7, 0x1000
    s_waitcnt vmcnt(7)
    s_cmpk_gt_u32 s62, 193
    s_cbranch_scc1 L_go_141
    s_waitcnt vmcnt(5)
    s_cmpk_le_u32 s63, 193
    s_cbranch_scc1 L_go_141
    s_waitcnt vmcnt(4)
L_go_141:
    buffer_load_dwordx4 v[248:251], v3, s[36:39], s7 offen nt
    v_mfma_f32_16x16x32_bf16 v[40:43], v[216:219], v[48:51], v[40:43]
    v_and_b32_dpp v44, v76, v10 row_newbcast:8 row_mask:0xf bank_mask:0xf
    v_and_b32_dpp v45, v76, v11 row_newbcast:8 row_mask:0xf bank_mask:0xf
    v_and_b32_dpp v46, v76, v12 row_newbcast:8 row_mask:0xf bank_mask:0xf
    v_and_b32_dpp v47, v76, v13 row_newbcast:8 row_mask:0xf bank_mask:0xf
    s_addk_i32 s7, 0x1000
    s_waitcnt vmcnt(7)
    s_cmpk_gt_u32 s62, 194
    s_cbranch_scc1 L_go_142
    s_waitcnt vmcnt(5)
    s_cmpk_le_u32 s63, 194
    s_cbranch_scc1 L_go_142
    s_waitcnt vmcnt(4)
L_go_142:
    buffer_load_dwordx4 v[252:255], v3, s[36:39], s7 offen nt
    s_memrealtime s[74:75]
    s_add_u32 s94, s90, 32768
    buffer_load_dwordx4 v[52:55], v0, s[40:43], s94 offen sc1
    v_mfma_f32_16x16x32_bf16 v[40:43], v[220:223], v[44:47], v[40:43]
    v_and_b32_dpp v48, v76, v10 row_newbcast:12 row_mask:0xf bank_mask:0xf
    v_and_b32_dpp v49, v76, v11 row_newbcast:12 row_mask:0xf bank_mask:0xf
    v_and_b32_dpp v50, v76, v12 row_newbcast:12 row_mask:0xf bank_mask:0xf
    v_and_b32_dpp v51, v76, v13 row_newbcast:12 row_mask:0xf bank_mask:0xf
    s_addk_i32 s7, 0x1000
    s_waitcnt vmcnt(8)
    s_cmpk_gt_u32 s62, 195
    s_cbranch_scc1 L_go_143
    s_waitcnt vmcnt(6)
    s_cmpk_le_u32 s63, 195
    s_cbranch_scc1 L_go_143
    s_waitcnt vmcnt(5)
L_go_143:
    buffer_load_dwordx4 v[100:103], v3, s[36:39], s7 offen nt
    s_mul_i32 s96, s76, 352
    s_lshr_b32 s96, s96, 8
    s_add_u32 s96, s96, s2
    s_waitcnt lgkmcnt(0)
    s_mul_i32 s68, s74, 8
    s_sub_u32 s68, s68, s96
    s_max_i32 s69, s68, 0
    s_min_u32 s69, s69, 0x4000
    s_mul_i32 s69, s69, 1638
    s_lshr_b32 s69, s69, 16
    s_add_u32 s62, s69, 196
    s_sub_i32 s69, 0, s68
    s_max_i32 s69, s69, 0
    s_min_u32 s69, s69, 0x4000
    s_mul_i32 s69, s69, 1966
    s_lshr_b32 s69, s69, 16
    s_add_u32 s63, s69, 196
    v_mfma_f32_16x16x32_bf16 v[40:43], v[224:227], v[48:51], v[40:43]
    v_and_b32_dpp v44, v77, v10 row_newbcast:0 row_mask:0xf bank_mask:0xf
    v_and_b32_dpp v45, v77, v11 row_newbcast:0 row_mask:0xf bank_mask:0xf
    v_and_b32_dpp v46, v77, v12 row_newbcast:0 row_mask:0xf bank_mask:0xf
    v_and_b32_dpp v47, v77, v13 row_newbcast:0 row_mask:0xf bank_mask:0xf
    s_addk_i32 s7, 0x1000
    s_waitcnt vmcnt(8)
    s_cmpk_gt_u32 s62, 196
    s_cbranch_scc1 L_go_144
    s_waitcnt vmcnt(6)
    s_cmpk_le_u32 s63, 196
    s_cbranch_scc1 L_go_144
    s_waitcnt vmcnt(5)
L_go_144:
    buffer_load_dwordx4 v[104:107], v3, s[36:39], s7 offen nt
    s_load_dwordx2 s[44:45], s[66:67], 896
    s_load_dwordx2 s[46:47], s[66:67], 5248
    s_load_dwordx2 s[48:49], s[66:67], 9600
    s_load_dwordx2 s[50:51], s[66:67], 13952
    s_load_dwordx2 s[52:53], s[66:67], 18304
    s_load_dwordx2 s[54:55], s[66:67], 22656
    s_load_dwordx2 s[56:57], s[66:67], 27008
    s_load_dwordx2 s[58:59], s[66:67], 31360
    v_mfma_f32_16x16x32_bf16 v[40:43], v[228:231], v[44:47], v[40:43]
    v_and_b32_dpp v48, v77, v10 row_newbcast:4 row_mask:0xf bank_mask:0xf
    v_and_b32_dpp v49, v77, v11 row_newbcast:4 row_mask:0xf bank_mask:0xf
    v_and_b32_dpp v50, v77, v12 row_newbcast:4 row_mask:0xf bank_mask:0xf
    v_and_b32_dpp v51, v77, v13 row_newbcast:4 row_mask:0xf bank_mask:0xf
    s_addk_i32 s7, 0x1000
    s_or_b32 s73, s7, s71
    s_waitcnt vmcnt(8)
    s_cmpk_gt_u32 s62, 197
    s_cbranch_scc1 L_go_145
    s_waitcnt vmcnt(6)
    s_cmpk_le_u32 s63, 197
    s_cbranch_scc1 L_go_145
    s_waitcnt vmcnt(5)
L_go_145:
    buffer_load_dwordx4 v[108:111], v3, s[36:39], s73 offen nt
    v_mfma_f32_16x16x32_bf16 v[40:43], v[232:235], v[48:51], v[40:43]
    v_and_b32_dpp v44, v77, v10 row_newbcast:8 row_mask:0xf bank_mask:0xf
    v_and_b32_dpp v45, v77, v11 row_newbcast:8 row_mask:0xf bank_mask:0xf
    v_and_b32_dpp v46, v77, v12 row_newbcast:8 row_mask:0xf bank_mask:0xf
    v_and_b32_dpp v47, v77, v13 row_newbcast:8 row_mask:0xf bank_mask:0xf
    s_addk_i32 s7, 0x1000
    s_waitcnt vmcnt(8)
    s_cmpk_gt_u32 s62, 198
    s_cbranch_scc1 L_go_146
    s_waitcnt vmcnt(6)
    s_cmpk_le_u32 s63, 198
    s_cbranch_scc1 L_go_146
    s_waitcnt vmcnt(5)
L_go_146:
    buffer_load_dwordx4 v[112:115], v3, s[36:39], s7 offen nt
    v_mfma_f32_16x16x32_bf16 v[40:43], v[236:239], v[44:47], v[40:43]
    v_and_b32_dpp v48, v77, v10 row_newbcast:12 row_mask:0xf bank_mask:0xf
    v_and_b32_dpp v49, v77, v11 row_newbcast:12 row_mask:0xf bank_mask:0xf
    v_and_b32_dpp v50, v77, v12 row_newbcast:12 row_mask:0xf bank_mask:0xf
    v_and_b32_dpp v51, v77, v13 row_newbcast:12 row_mask:0xf bank_mask:0xf
    s_addk_i32 s7, 0x1000
    s_waitcnt vmcnt(8)
    s_cmpk_gt_u32 s62, 199
    s_cbranch_scc1 L_go_147
    s_waitcnt vmcnt(6)
    s_cmpk_le_u32 s63, 199
    s_cbranch_scc1 L_go_147
    s_waitcnt vmcnt(5)
L_go_147:
    buffer_load_dwordx4 v[116:119], v3, s[36:39], s7 offen nt
    v_mfma_f32_16x16x32_bf16 v[40:43], v[240:243], v[48:51], v[40:43]
    v_and_b32_dpp v44, v78, v10 row_newbcast:0 row_mask:0xf bank_mask:0xf
    v_and_b32_dpp v45, v78, v11 row_newbcast:0 row_mask:0xf bank_mask:0xf
    v_and_b32_dpp v46, v78, v12 row_newbcast:0 row_mask:0xf bank_mask:0xf
    v_and_b32_dpp v47, v78, v13 row_newbcast:0 row_mask:0xf bank_mask:0xf
    s_addk_i32 s7, 0x1000
    s_waitcnt vmcnt(8)
    s_cmpk_gt_u32 s62, 200
    s_cbranch_scc1 L_go_148
    s_waitcnt vmcnt(6)
    s_cmpk_le_u32 s63, 200
    s_cbranch_scc1 L_go_148
    s_waitcnt vmcnt(4)
L_go_148:
    buffer_load_dwordx4 v[120:123], v3, s[36:39], s7 offen nt
    v_mfma_f32_16x16x32_bf16 v[40:43], v[244:247], v[44:47], v[40:43]
    v_and_b32_dpp v48, v78, v10 row_newbcast:4 row_mask:0xf bank_mask:0xf
    v_and_b32_dpp v49, v78, v11 row_newbcast:4 row_mask:0xf bank_mask:0xf
    v_and_b32_dpp v50, v78, v12 row_newbcast:4 row_mask:0xf bank_mask:0xf
    v_and_b32_dpp v51, v78, v13 row_newbcast:4 row_mask:0xf bank_mask:0xf
    s_addk_i32 s7, 0x1000
    s_waitcnt vmcnt(8)
    s_cmpk_gt_u32 s62, 201
    s_cbranch_scc1 L_go_149
    s_waitcnt vmcnt(5)
    s_cmpk_le_u32 s63, 201
    s_cbranch_scc1 L_go_149
    s_waitcnt vmcnt(4)
L_go_149:
    buffer_load_dwordx4 v[124:127], v3, s[36:39], s7 offen nt
    v_mfma_f32_16x16x32_bf16 v[40:43], v[248:251], v[48:51], v[40:43]
    v_and_b32_dpp v44, v78, v10 row_newbcast:8 row_mask:0xf bank_mask:0xf
    v_and_b32_dpp v45, v78, v11 row_newbcast:8 row_mask:0xf bank_mask:0xf
    v_and_b32_dpp v46, v78, v12 row_newbcast:8 row_mask:0xf bank_mask:0xf
    v_and_b32_dpp v47, v78, v13 row_newbcast:8 row_mask:0xf bank_mask:0xf
    s_addk_i32 s7, 0x1000
    s_or_b32 s73, s7, s71
    s_waitcnt vmcnt(8)
    s_cmpk_gt_u32 s62, 202
    s_cbranch_scc1 L_go_150
    s_waitcnt vmcnt(5)
    s_cmpk_le_u32 s63, 202
    s_cbranch_scc1 L_go_150
    s_waitcnt vmcnt(4)
L_go_150:
    buffer_load_dwordx4 v[128:131], v3, s[36:39], s73 offen nt
    v_mfma_f32_16x16x32_bf16 v[40:43], v[252:255], v[44:47], v[40:43]
    s_add_u32 s73, s72, 0x00030000
    s_waitcnt vmcnt(7)
    s_cmpk_gt_u32 s62, 203
    s_cbranch_scc1 L_go_151
    s_waitcnt vmcnt(5)
    s_cmpk_le_u32 s63, 203
    s_cbranch_scc1 L_go_151
    s_waitcnt vmcnt(4)
L_go_151:
    buffer_load_dwordx4 v[132:135], v3, s[36:39], s73 offen nt
L_ml_152:
    v_cmp_ne_u32 vcc, s77, v53
    v_cmp_ne_u32 s[96:97], s77, v55
    s_nop 0
    s_or_b64 vcc, vcc, s[96:97]
    s_cmp_lg_u32 vcc_lo, 0
    s_cbranch_scc1 L_ml_152_r
L_ml_152_d:
    v_max_f32_dpp v53, v52, v52 row_ror:8 row_mask:0xf bank_mask:0xf
    s_nop 1
    v_max_f32_dpp v53, v53, v53 row_ror:4 row_mask:0xf bank_mask:0xf
    s_nop 1
    v_max_f32_dpp v53, v53, v53 row_ror:2 row_mask:0xf bank_mask:0xf
    s_nop 1
    v_max_f32_dpp v53, v53, v53 row_ror:1 row_mask:0xf bank_mask:0xf
    v_mov_b32 v8, v53
    s_nop 1
    v_permlane16_swap_b32 v53, v8
    v_max_f32 v53, v53, v8
    v_sub_f32 v8, v52, v53
    v_mul_f32 v8, s93, v8
    v_exp_f32 v8, v8
    s_nop 0
    v_mul_f32 v54, v54, v8
    s_nop 1
    v_add_f32_dpp v54, v54, v54 row_ror:8 row_mask:0xf bank_mask:0xf
    s_nop 1
    v_add_f32_dpp v54, v54, v54 row_ror:4 row_mask:0xf bank_mask:0xf
    s_nop 1
    v_add_f32_dpp v54, v54, v54 row_ror:2 row_mask:0xf bank_mask:0xf
    s_nop 1
    v_add_f32_dpp v54, v54, v54 row_ror:1 row_mask:0xf bank_mask:0xf
    v_mov_b32 v8, v54
    s_nop 1
    v_permlane16_swap_b32 v54, v8
    v_add_f32 v54, v54, v8
    v_rcp_f32 v54, v54
    v_readfirstlane_b32 s4, v53
    v_readfirstlane_b32 s5, v54
    s_nop 0
    v_subrev_f32 v81, s4, v81
    v_subrev_f32 v82, s4, v82
    v_subrev_f32 v83, s4, v83
    v_subrev_f32 v84, s4, v84
    v_mul_f32 v81, s93, v81
    v_mul_f32 v82, s93, v82
    v_mul_f32 v83, s93, v83
    v_mul_f32 v84, s93, v84
    v_exp_f32 v81, v81
    v_exp_f32 v82, v82
    v_exp_f32 v83, v83
    v_exp_f32 v84, v84
    v_mul_f32 v81, s5, v81
    v_mul_f32 v82, s5, v82
    v_mul_f32 v83, s5, v83
    v_mul_f32 v84, s5, v84
    v_cvt_pk_bf16_f32 v81, v81, v81
    v_cvt_pk_bf16_f32 v82, v82, v82
    v_cvt_pk_bf16_f32 v83, v83, v83
    v_cvt_pk_bf16_f32 v84, v84, v84
    s_add_u32 s7, s70, 0x04000000
    s_or_b32 s73, s7, s71
    s_waitcnt vmcnt(7)
    s_cmpk_gt_u32 s62, 204
    s_cbranch_scc1 L_go_153
    s_waitcnt vmcnt(5)
    s_cmpk_le_u32 s63, 204
    s_cbranch_scc1 L_go_153
    s_waitcnt vmcnt(4)
L_go_153:
    buffer_load_dwordx4 v[136:139], v3, s[36:39], s73 offen nt
    v_subrev_f32 v85, s4, v85
    v_subrev_f32 v86, s4, v86
    v_subrev_f32 v87, s4, v87
    v_subrev_f32 v88, s4, v88
    v_mul_f32 v85, s93, v85
    v_mul_f32 v86, s93, v86
    v_mul_f32 v87, s93, v87
    v_mul_f32 v88, s93, v88
    v_exp_f32 v85, v85
    v_exp_f32 v86, v86
    v_exp_f32 v87, v87
    v_exp_f32 v88, v88
    v_mul_f32 v85, s5, v85
    v_mul_f32 v86, s5, v86
    v_mul_f32 v87, s5, v87
    v_mul_f32 v88, s5, v88
    v_cvt_pk_bf16_f32 v85, v85, v85
    v_cvt_pk_bf16_f32 v86, v86, v86
    v_cvt_pk_bf16_f32 v87, v87, v87
    v_cvt_pk_bf16_f32 v88, v88, v88
    v_subrev_f32 v89, s4, v89
    v_subrev_f32 v90, s4, v90
    v_subrev_f32 v91, s4, v91
    v_subrev_f32 v92, s4, v92
    v_mul_f32 v89, s93, v89
    v_mul_f32 v90, s93, v90
    v_mul_f32 v91, s93, v91
    v_mul_f32 v92, s93, v92
    v_exp_f32 v89, v89
    v_exp_f32 v90, v90
    v_exp_f32 v91, v91
    v_exp_f32 v92, v92
    v_mul_f32 v89, s5, v89
    v_mul_f32 v90, s5, v90
    v_mul_f32 v91, s5, v91
    v_mul_f32 v92, s5, v92
    v_cvt_pk_bf16_f32 v89, v89, v89
    v_cvt_pk_bf16_f32 v90, v90, v90
    v_cvt_pk_bf16_f32 v91, v91, v91
    v_cvt_pk_bf16_f32 v92, v92, v92
    v_subrev_f32 v93, s4, v93
    v_subrev_f32 v94, s4, v94
    v_subrev_f32 v95, s4, v95
    v_subrev_f32 v96, s4, v96
    v_mul_f32 v93, s93, v93
    v_mul_f32 v94, s93, v94
    v_mul_f32 v95, s93, v95
    v_mul_f32 v96, s93, v96
    v_exp_f32 v93, v93
    v_exp_f32 v94, v94
    v_exp_f32 v95, v95
    v_exp_f32 v96, v96
    v_mul_f32 v93, s5, v93
    v_mul_f32 v94, s5, v94
    v_mul_f32 v95, s5, v95
    v_mul_f32 v96, s5, v96
    v_cvt_pk_bf16_f32 v93, v93, v93
    v_cvt_pk_bf16_f32 v94, v94, v94
    v_cvt_pk_bf16_f32 v95, v95, v95
    v_cvt_pk_bf16_f32 v96, v96, v96
    s_addk_i32 s7, 0x1000
    s_waitcnt vmcnt(7)
    s_cmpk_gt_u32 s62, 205
    s_cbranch_scc1 L_go_154
    s_waitcnt vmcnt(5)
    s_cmpk_le_u32 s63, 205
    s_cbranch_scc1 L_go_154
    s_waitcnt vmcnt(4)
L_go_154:
    buffer_load_dwordx4 v[140:143], v3, s[36:39], s7 offen nt
    v_subrev_f32 v97, s4, v97
    v_mul_f32 v97, s93, v97
    v_exp_f32 v97, v97
    s_nop 0
    v_mul_f32 v97, s5, v97
    v_cvt_pk_bf16_f32 v97, v97, v97
    v_and_b32_dpp v48, v78, v10 row_newbcast:12 row_mask:0xf bank_mask:0xf
    v_and_b32_dpp v49, v78, v11 row_newbcast:12 row_mask:0xf bank_mask:0xf
    v_and_b32_dpp v50, v78, v12 row_newbcast:12 row_mask:0xf bank_mask:0xf
    v_and_b32_dpp v51, v78, v13 row_newbcast:12 row_mask:0xf bank_mask:0xf
    s_nop 1
    v_mfma_f32_16x16x32_bf16 v[40:43], v[100:103], v[48:51], v[40:43]
    v_and_b32_dpp v44, v79, v10 row_newbcast:0 row_mask:0xf bank_mask:0xf
    v_and_b32_dpp v45, v79, v11 row_newbcast:0 row_mask:0xf bank_mask:0xf
    v_and_b32_dpp v46, v79, v12 row_newbcast:0 row_mask:0xf bank_mask:0xf
    v_and_b32_dpp v47, v79, v13 row_newbcast:0 row_mask:0xf bank_mask:0xf
    s_nop 1
    v_mfma_f32_16x16x32_bf16 v[40:43], v[104:107], v[44:47], v[40:43]
    v_and_b32_dpp v48, v79, v10 row_newbcast:4 row_mask:0xf bank_mask:0xf
    v_and_b32_dpp v49, v79, v11 row_newbcast:4 row_mask:0xf bank_mask:0xf
    v_and_b32_dpp v50, v79, v12 row_newbcast:4 row_mask:0xf bank_mask:0xf
    v_and_b32_dpp v51, v79, v13 row_newbcast:4 row_mask:0xf bank_mask:0xf
    s_nop 1
    v_mfma_f32_16x16x32_bf16 v[40:43], v[108:111], v[48:51], v[40:43]
    v_and_b32_dpp v44, v79, v10 row_newbcast:8 row_mask:0xf bank_mask:0xf
    v_and_b32_dpp v45, v79, v11 row_newbcast:8 row_mask:0xf bank_mask:0xf
    v_and_b32_dpp v46, v79, v12 row_newbcast:8 row_mask:0xf bank_mask:0xf
    v_and_b32_dpp v47, v79, v13 row_newbcast:8 row_mask:0xf bank_mask:0xf
    s_addk_i32 s7, 0x1000
    s_waitcnt vmcnt(7)
    s_cmpk_gt_u32 s62, 206
    s_cbranch_scc1 L_go_155
    s_waitcnt vmcnt(5)
    s_cmpk_le_u32 s63, 206
    s_cbranch_scc1 L_go_155
    s_waitcnt vmcnt(4)
L_go_155:
    buffer_load_dwordx4 v[144:147], v3, s[36:39], s7 offen nt
    v_mfma_f32_16x16x32_bf16 v[40:43], v[112:115], v[44:47], v[40:43]
    v_and_b32_dpp v48, v79, v10 row_newbcast:12 row_mask:0xf bank_mask:0xf
    v_and_b32_dpp v49, v79, v11 row_newbcast:12 row_mask:0xf bank_mask:0xf
    v_and_b32_dpp v50, v79, v12 row_newbcast:12 row_mask:0xf bank_mask:0xf
    v_and_b32_dpp v51, v79, v13 row_newbcast:12 row_mask:0xf bank_mask:0xf
    s_addk_i32 s7, 0x1000
    s_waitcnt vmcnt(7)
    s_cmpk_gt_u32 s62, 207
    s_cbranch_scc1 L_go_156
    s_waitcnt vmcnt(5)
    s_cmpk_le_u32 s63, 207
    s_cbranch_scc1 L_go_156
    s_waitcnt vmcnt(4)
L_go_156:
    buffer_load_dwordx4 v[148:151], v3, s[36:39], s7 offen nt
    s_memrealtime s[74:75]
    v_mfma_f32_16x16x32_bf16 v[40:43], v[116:119], v[48:51], v[40:43]
    v_and_b32_dpp v44, v80, v10 row_newbcast:0 row_mask:0xf bank_mask:0xf
    v_and_b32_dpp v45, v80, v11 row_newbcast:0 row_mask:0xf bank_mask:0xf
    v_and_b32_dpp v46, v80, v12 row_newbcast:0 row_mask:0xf bank_mask:0xf
    v_and_b32_dpp v47, v80, v13 row_newbcast:0 row_mask:0xf bank_mask:0xf
    s_addk_i32 s7, 0x1000
    s_waitcnt vmcnt(7)
    s_cmpk_gt_u32 s62, 208
    s_cbranch_scc1 L_go_157
    s_waitcnt vmcnt(5)
    s_cmpk_le_u32 s63, 208
    s_cbranch_scc1 L_go_157
    s_waitcnt vmcnt(4)
L_go_157:
    buffer_load_dwordx4 v[152:155], v3, s[36:39], s7 offen nt
    s_waitcnt lgkmcnt(0)
    s_mov_b32 s68, 0
    s_sub_u32 s69, s60, s44
    s_cmp_eq_u32 s45, s77
    s_cselect_b32 s69, s69, -154
    s_add_u32 s68, s68, s69
    s_sub_u32 s69, s60, s46
    s_cmp_eq_u32 s47, s77
    s_cselect_b32 s69, s69, -154
    s_add_u32 s68, s68, s69
    s_sub_u32 s69, s60, s48
    s_cmp_eq_u32 s49, s77
    s_cselect_b32 s69, s69, -154
    s_add_u32 s68, s68, s69
    s_sub_u32 s69, s60, s50
    s_cmp_eq_u32 s51, s77
    s_cselect_b32 s69, s69, -154
    s_add_u32 s68, s68, s69
    s_sub_u32 s69, s60, s52
    s_cmp_eq_u32 s53, s77
    s_cselect_b32 s69, s69, -154
    s_add_u32 s68, s68, s69
    s_sub_u32 s69, s60, s54
    s_cmp_eq_u32 s55, s77
    s_cselect_b32 s69, s69, -154
    s_add_u32 s68, s68, s69
    s_sub_u32 s69, s60, s56
    s_cmp_eq_u32 s57, s77
    s_cselect_b32 s69, s69, -154
    s_add_u32 s68, s68, s69
    s_sub_u32 s69, s60, s58
    s_cmp_eq_u32 s59, s77
    s_cselect_b32 s69, s69, -154
    s_add_u32 s68, s68, s69
    s_mul_i32 s69, s60, 8
    s_sub_u32 s69, s69, s68
    s_sub_u32 s76, s69, s2
    s_mov_b32 s2, s69
    s_mul_i32 s96, s76, 235
    s_lshr_b32 s96, s96, 8
    s_sub_u32 s69, s74, s60
    s_mul_i32 s69, s69, 8
    s_sub_i32 s69, s69, s96
    s_mul_i32 s69, s69, 16
    s_ashr_i32 s69, s69, 4
    s_add_i32 s68, s68, s69
    s_max_i32 s69, s68, 0
    s_min_u32 s69, s69, 0x4000
    s_mul_i32 s69, s69, 1638
    s_lshr_b32 s69, s69, 16
    s_add_u32 s62, s69, 209
    s_sub_i32 s69, 0, s68
    s_max_i32 s69, s69, 0
    s_min_u32 s69, s69, 0x4000
    s_mul_i32 s69, s69, 1966
    s_lshr_b32 s69, s69, 16
    s_add_u32 s63, s69, 209
    v_mfma_f32_16x16x32_bf16 v[40:43], v[120:123], v[44:47], v[40:43]
    v_and_b32_dpp v48, v80, v10 row_newbcast:4 row_mask:0xf bank_mask:0xf
    v_and_b32_dpp v49, v80, v11 row_newbcast:4 row_mask:0xf bank_mask:0xf
    v_and_b32_dpp v50, v80, v12 row_newbcast:4 row_mask:0xf bank_mask:0xf
    v_and_b32_dpp v51, v80, v13 row_newbcast:4 row_mask:0xf bank_mask:0xf
    s_addk_i32 s7, 0x1000
    s_or_b32 s73, s7, s71
    s_waitcnt vmcnt(7)
    s_cmpk_gt_u32 s62, 209
    s_cbranch_scc1 L_go_158
    s_waitcnt vmcnt(5)
    s_cmpk_le_u32 s63, 209
    s_cbranch_scc1 L_go_158
    s_waitcnt vmcnt(4)
L_go_158:
    buffer_load_dwordx4 v[156:159], v3, s[36:39], s73 offen nt
    s_memrealtime s[60:61]
    v_mfma_f32_16x16x32_bf16 v[40:43], v[124:127], v[48:51], v[40:43]
    v_and_b32_dpp v44, v80, v10 row_newbcast:8 row_mask:0xf bank_mask:0xf
    v_and_b32_dpp v45, v80, v11 row_newbcast:8 row_mask:0xf bank_mask:0xf
    v_and_b32_dpp v46, v80, v12 row_newbcast:8 row_mask:0xf bank_mask:0xf
    v_and_b32_dpp v47, v80, v13 row_newbcast:8 row_mask:0xf bank_mask:0xf
    s_addk_i32 s7, 0x1000
    s_waitcnt vmcnt(7)
    s_cmpk_gt_u32 s62, 210
    s_cbranch_scc1 L_go_159
    s_waitcnt vmcnt(5)
    s_cmpk_le_u32 s63, 210
    s_cbranch_scc1 L_go_159
    s_waitcnt vmcnt(4)
L_go_159:
    buffer_load_dwordx4 v[160:163], v3, s[36:39], s7 offen nt
    s_cmp_lg_u32 s64, 0
    s_cbranch_scc1 L_ref_160_r
L_ref_160:
    v_mfma_f32_16x16x32_bf16 v[40:43], v[128:131], v[44:47], v[40:43]
    v_and_b32_dpp v48, v80, v10 row_newbcast:12 row_mask:0xf bank_mask:0xf
    v_and_b32_dpp v49, v80, v11 row_newbcast:12 row_mask:0xf bank_mask:0xf
    v_and_b32_dpp v50, v80, v12 row_newbcast:12 row_mask:0xf bank_mask:0xf
    v_and_b32_dpp v51, v80, v13 row_newbcast:12 row_mask:0xf bank_mask:0xf
    s_addk_i32 s7, 0x1000
    s_waitcnt vmcnt(7)
    s_cmpk_gt_u32 s62, 211
    s_cbranch_scc1 L_go_161
    s_waitcnt vmcnt(5)
    s_cmpk_le_u32 s63, 211
    s_cbranch_scc1 L_go_161
    s_waitcnt vmcnt(4)
L_go_161:
    buffer_load_dwordx4 v[164:167], v3, s[36:39], s7 offen nt
    v_mfma_f32_16x16x32_bf16 v[40:43], v[132:135], v[48:51], v[40:43]
    s_mov_b32 s95, 589824
    s_movk_i32 s97, 0xfff
    s_mov_b64 exec, s[88:89]
    s_nop 4
    ds_write_b128 v62, v[40:43] offset:8192
    s_mov_b64 exec, 1
    ds_add_rtn_u32 v8, v61, v5 offset:4608
    s_mov_b32 exec_lo, -1
    ds_read_b128 v[16:19], v15 offset:8192
    ds_read_b128 v[20:23], v15 offset:8704
    ds_read_b128 v[24:27], v15 offset:9216
    ds_read_b128 v[28:31], v15 offset:9728
    s_waitcnt lgkmcnt(0)
    v_readfirstlane_b32 s96, v8
    v_pk_add_f32 v[16:17], v[16:17], v[20:21]
    v_pk_add_f32 v[18:19], v[18:19], v[22:23]
    v_pk_add_f32 v[24:25], v[24:25], v[28:29]
    v_pk_add_f32 v[26:27], v[26:27], v[30:31]
    s_cmp_lg_u32 s96, 2
    s_cbranch_scc1 L_olast_162
    s_cmp_lg_u32 s30, 0
    v_pk_add_f32 v[16:17], v[16:17], v[24:25]
    v_pk_add_f32 v[18:19], v[18:19], v[26:27]
    v_bfi_b32 v16, s97, v1, v16
    s_cbranch_scc1 L_olast_162_far
    buffer_store_dwordx4 v[16:19], v63, s[40:43], s95 offen
L_olast_162_st:
L_olast_162:
    s_mov_b64 exec, -1
    v_and_b32_dpp v44, v81, v10 row_newbcast:0 row_mask:0xf bank_mask:0xf
    v_and_b32_dpp v45, v81, v11 row_newbcast:0 row_mask:0xf bank_mask:0xf
    v_and_b32_dpp v46, v81, v12 row_newbcast:0 row_mask:0xf bank_mask:0xf
    v_and_b32_dpp v47, v81, v13 row_newbcast:0 row_mask:0xf bank_mask:0xf
    s_addk_i32 s7, 0x1000
    s_waitcnt vmcnt(7)
    s_cmpk_gt_u32 s62, 212
    s_cbranch_scc1 L_go_163
    s_waitcnt vmcnt(5)
    s_cmpk_le_u32 s63, 212
    s_cbranch_scc1 L_go_163
    s_waitcnt vmcnt(4)
L_go_163:
    buffer_load_dwordx4 v[168:171], v3, s[36:39], s7 offen nt
    v_mfma_f32_16x16x32_bf16 v[40:43], v[136:139], v[44:47], 0
    v_and_b32_dpp v48, v81, v10 row_newbcast:4 row_mask:0xf bank_mask:0xf
    v_and_b32_dpp v49, v81, v11 row_newbcast:4 row_mask:0xf bank_mask:0xf
    v_and_b32_dpp v50, v81, v12 row_newbcast:4 row_mask:0xf bank_mask:0xf
    v_and_b32_dpp v51, v81, v13 row_newbcast:4 row_mask:0xf bank_mask:0xf
    s_addk_i32 s7, 0x1000
    s_waitcnt vmcnt(7)
    s_cmpk_gt_u32 s62, 213
    s_cbranch_scc1 L_go_164
    s_waitcnt vmcnt(5)
    s_cmpk_le_u32 s63, 213
    s_cbranch_scc1 L_go_164
    s_waitcnt vmcnt(4)
L_go_164:
    buffer_load_dwordx4 v[172:175], v3, s[36:39], s7 offen nt
    v_mfma_f32_16x16x32_bf16 v[40:43], v[140:143], v[48:51], v[40:43]
    v_and_b32_dpp v44, v81, v10 row_newbcast:8 row_mask:0xf bank_mask:0xf
    v_and_b32_dpp v45, v81, v11 row_newbcast:8 row_mask:0xf bank_mask:0xf
    v_and_b32_dpp v46, v81, v12 row_newbcast:8 row_mask:0xf bank_mask:0xf
    v_and_b32_dpp v47, v81, v13 row_newbcast:8 row_mask:0xf bank_mask:0xf
    s_addk_i32 s7, 0x1000
    s_or_b32 s73, s7, s71
    s_waitcnt vmcnt(7)
    s_cmpk_gt_u32 s62, 214
    s_cbranch_scc1 L_go_165
    s_waitcnt vmcnt(5)
    s_cmpk_le_u32 s63, 214
    s_cbranch_scc1 L_go_165
    s_waitcnt vmcnt(4)
L_go_165:
    buffer_load_dwordx4 v[176:179], v3, s[36:39], s73 offen nt
    v_mfma_f32_16x16x32_bf16 v[40:43], v[144:147], v[44:47], v[40:43]
    v_and_b32_dpp v48, v81, v10 row_newbcast:12 row_mask:0xf bank_mask:0xf
    v_and_b32_dpp v49, v81, v11 row_newbcast:12 row_mask:0xf bank_mask:0xf
    v_and_b32_dpp v50, v81, v12 row_newbcast:12 row_mask:0xf bank_mask:0xf
    v_and_b32_dpp v51, v81, v13 row_newbcast:12 row_mask:0xf bank_mask:0xf
    s_addk_i32 s7, 0x1000
    s_waitcnt vmcnt(7)
    s_cmpk_gt_u32 s62, 215
    s_cbranch_scc1 L_go_166
    s_waitcnt vmcnt(5)
    s_cmpk_le_u32 s63, 215
    s_cbranch_scc1 L_go_166
    s_waitcnt vmcnt(4)
L_go_166:
    buffer_load_dwordx4 v[180:183], v3, s[36:39], s7 offen nt
    v_mfma_f32_16x16x32_bf16 v[40:43], v[148:151], v[48:51], v[40:43]
    v_and_b32_dpp v44, v82, v10 row_newbcast:0 row_mask:0xf bank_mask:0xf
    v_and_b32_dpp v45, v82, v11 row_newbcast:0 row_mask:0xf bank_mask:0xf
    v_and_b32_dpp v46, v82, v12 row_newbcast:0 row_mask:0xf bank_mask:0xf
    v_and_b32_dpp v47, v82, v13 row_newbcast:0 row_mask:0xf bank_mask:0xf
    s_addk_i32 s7, 0x1000
    s_waitcnt vmcnt(7)
    s_cmpk_gt_u32 s62, 216
    s_cbranch_scc1 L_go_167
    s_waitcnt vmcnt(5)
    s_cmpk_le_u32 s63, 216
    s_cbranch_scc1 L_go_167
    s_waitcnt vmcnt(4)
L_go_167:
    buffer_load_dwordx4 v[184:187], v3, s[36:39], s7 offen nt
    v_mfma_f32_16x16x32_bf16 v[40:43], v[152:155], v[44:47], v[40:43]
    v_and_b32_dpp v48, v82, v10 row_newbcast:4 row_mask:0xf bank_mask:0xf
    v_and_b32_dpp v49, v82, v11 row_newbcast:4 row_mask:0xf bank_mask:0xf
    v_and_b32_dpp v50, v82, v12 row_newbcast:4 row_mask:0xf bank_mask:0xf
    v_and_b32_dpp v51, v82, v13 row_newbcast:4 row_mask:0xf bank_mask:0xf
    s_addk_i32 s7, 0x1000
    s_waitcnt vmcnt(7)
    s_cmpk_gt_u32 s62, 217
    s_cbranch_scc1 L_go_168
    s_waitcnt vmcnt(5)
    s_cmpk_le_u32 s63, 217
    s_cbranch_scc1 L_go_168
    s_waitcnt vmcnt(4)
L_go_168:
    buffer_load_dwordx4 v[188:191], v3, s[36:39], s7 offen nt
    v_mfma_f32_16x16x32_bf16 v[40:43], v[156:159], v[48:51], v[40:43]
    v_and_b32_dpp v44, v82, v10 row_newbcast:8 row_mask:0xf bank_mask:0xf
    v_and_b32_dpp v45, v82, v11 row_newbcast:8 row_mask:0xf bank_mask:0xf
    v_and_b32_dpp v46, v82, v12 row_newbcast:8 row_mask:0xf bank_mask:0xf
    v_and_b32_dpp v47, v82, v13 row_newbcast:8 row_mask:0xf bank_mask:0xf
    s_addk_i32 s7, 0x1000
    s_waitcnt vmcnt(7)
    s_cmpk_gt_u32 s62, 218
    s_cbranch_scc1 L_go_169
    s_waitcnt vmcnt(5)
    s_cmpk_le_u32 s63, 218
    s_cbranch_scc1 L_go_169
    s_waitcnt vmcnt(4)
L_go_169:
    buffer_load_dwordx4 v[192:195], v3, s[36:39], s7 offen nt
    s_memrealtime s[74:75]
    v_mfma_f32_16x16x32_bf16 v[40:43], v[160:163], v[44:47], v[40:43]
    v_and_b32_dpp v48, v82, v10 row_newbcast:12 row_mask:0xf bank_mask:0xf
    v_and_b32_dpp v49, v82, v11 row_newbcast:12 row_mask:0xf bank_mask:0xf
    v_and_b32_dpp v50, v82, v12 row_newbcast:12 row_mask:0xf bank_mask:0xf
    v_and_b32_dpp v51, v82, v13 row_newbcast:12 row_mask:0xf bank_mask:0xf
    s_addk_i32 s7, 0x1000
    s_or_b32 s73, s7, s71
    s_waitcnt vmcnt(7)
    s_cmpk_gt_u32 s62, 219
    s_cbranch_scc1 L_go_170
    s_waitcnt vmcnt(5)
    s_cmpk_le_u32 s63, 219
    s_cbranch_scc1 L_go_170
    s_waitcnt vmcnt(4)
L_go_170:
    buffer_load_dwordx4 v[196:199], v3, s[36:39], s73 offen nt
    s_mul_i32 s96, s76, 352
    s_lshr_b32 s96, s96, 8
    s_add_u32 s96, s96, s2
    s_waitcnt lgkmcnt(0)
    s_mul_i32 s68, s74, 8
    s_sub_u32 s68, s68, s96
    s_max_i32 s69, s68, 0
    s_min_u32 s69, s69, 0x4000
    s_mul_i32 s69, s69, 1638
    s_lshr_b32 s69, s69, 16
    s_add_u32 s62, s69, 220
    s_sub_i32 s69, 0, s68
    s_max_i32 s69, s69, 0
    s_min_u32 s69, s69, 0x4000
    s_mul_i32 s69, s69, 1966
    s_lshr_b32 s69, s69, 16
    s_add_u32 s63, s69, 220
    v_mfma_f32_16x16x32_bf16 v[40:43], v[164:167], v[48:51], v[40:43]
    v_and_b32_dpp v44, v83, v10 row_newbcast:0 row_mask:0xf bank_mask:0xf
    v_and_b32_dpp v45, v83, v11 row_newbcast:0 row_mask:0xf bank_mask:0xf
    v_and_b32_dpp v46, v83, v12 row_newbcast:0 row_mask:0xf bank_mask:0xf
    v_and_b32_dpp v47, v83, v13 row_newbcast:0 row_mask:0xf bank_mask:0xf
    s_add_u32 s73, s72, 0x04000000
    s_waitcnt vmcnt(7)
    s_cmpk_gt_u32 s62, 220
    s_cbranch_scc1 L_go_171
    s_waitcnt vmcnt(5)
    s_cmpk_le_u32 s63, 220
    s_cbranch_scc1 L_go_171
    s_waitcnt vmcnt(4)
L_go_171:
    buffer_load_dwordx4 v[200:203], v3, s[36:39], s73 offen nt
    s_load_dwordx2 s[44:45], s[66:67], 1024
    s_load_dwordx2 s[46:47], s[66:67], 5376
    s_load_dwordx2 s[48:49], s[66:67], 9728
    s_load_dwordx2 s[50:51], s[66:67], 14080
    s_load_dwordx2 s[52:53], s[66:67], 18432
    s_load_dwordx2 s[54:55], s[66:67], 22784
    s_load_dwordx2 s[56:57], s[66:67], 27136
    s_load_dwordx2 s[58:59], s[66:67], 31488
    v_mfma_f32_16x16x32_bf16 v[40:43], v[168:171], v[44:47], v[40:43]
    v_and_b32_dpp v48, v83, v10 row_newbcast:4 row_mask:0xf bank_mask:0xf
    v_and_b32_dpp v49, v83, v11 row_newbcast:4 row_mask:0xf bank_mask:0xf
    v_and_b32_dpp v50, v83, v12 row_newbcast:4 row_mask:0xf bank_mask:0xf
    v_and_b32_dpp v51, v83, v13 row_newbcast:4 row_mask:0xf bank_mask:0xf
    s_addk_i32 s7, 0x1000
    s_or_b32 s73, s7, s71
    s_waitcnt vmcnt(7)
    s_cmpk_gt_u32 s62, 221
    s_cbranch_scc1 L_go_172
    s_waitcnt vmcnt(5)
    s_cmpk_le_u32 s63, 221
    s_cbranch_scc1 L_go_172
    s_waitcnt vmcnt(4)
L_go_172:
    buffer_load_dwordx4 v[204:207], v3, s[36:39], s73 offen nt
    v_mfma_f32_16x16x32_bf16 v[40:43], v[172:175], v[48:51], v[40:43]
    v_and_b32_dpp v44, v83, v10 row_newbcast:8 row_mask:0xf bank_mask:0xf
    v_and_b32_dpp v45, v83, v11 row_newbcast:8 row_mask:0xf bank_mask:0xf
    v_and_b32_dpp v46, v83, v12 row_newbcast:8 row_mask:0xf bank_mask:0xf
    v_and_b32_dpp v47, v83, v13 row_newbcast:8 row_mask:0xf bank_mask:0xf
    s_addk_i32 s7, 0x1000
    s_waitcnt vmcnt(7)
    s_cmpk_gt_u32 s62, 222
    s_cbranch_scc1 L_go_173
    s_waitcnt vmcnt(5)
    s_cmpk_le_u32 s63, 222
    s_cbranch_scc1 L_go_173
    s_waitcnt vmcnt(4)
L_go_173:
    buffer_load_dwordx4 v[208:211], v3, s[36:39], s7 offen nt
    s_mov_b64 exec, 1
    ds_write_b32 v61, v5 offset:4640
    s_mov_b64 exec, -1
    v_mfma_f32_16x16x32_bf16 v[40:43], v[176:179], v[44:47], v[40:43]
    v_and_b32_dpp v48, v83, v10 row_newbcast:12 row_mask:0xf bank_mask:0xf
    v_and_b32_dpp v49, v83, v11 row_newbcast:12 row_mask:0xf bank_mask:0xf
    v_and_b32_dpp v50, v83, v12 row_newbcast:12 row_mask:0xf bank_mask:0xf
    v_and_b32_dpp v51, v83, v13 row_newbcast:12 row_mask:0xf bank_mask:0xf
    s_addk_i32 s7, 0x1000
    s_waitcnt vmcnt(7)
    s_cmpk_gt_u32 s62, 223
    s_cbranch_scc1 L_go_174
    s_waitcnt vmcnt(5)
    s_cmpk_le_u32 s63, 223
    s_cbranch_scc1 L_go_174
    s_waitcnt vmcnt(4)
L_go_174:
    buffer_load_dwordx4 v[212:215], v3, s[36:39], s7 offen nt
    v_mfma_f32_16x16x32_bf16 v[40:43], v[180:183], v[48:51], v[40:43]
    v_and_b32_dpp v44, v84, v10 row_newbcast:0 row_mask:0xf bank_mask:0xf
    v_and_b32_dpp v45, v84, v11 row_newbcast:0 row_mask:0xf bank_mask:0xf
    v_and_b32_dpp v46, v84, v12 row_newbcast:0 row_mask:0xf bank_mask:0xf
    v_and_b32_dpp v47, v84, v13 row_newbcast:0 row_mask:0xf bank_mask:0xf
    s_addk_i32 s7, 0x1000
    s_waitcnt vmcnt(7)
    s_cmpk_gt_u32 s62, 224
    s_cbranch_scc1 L_go_175
    s_waitcnt vmcnt(5)
    s_cmpk_le_u32 s63, 224
    s_cbranch_scc1 L_go_175
    s_waitcnt vmcnt(4)
L_go_175:
    buffer_load_dwordx4 v[216:219], v3, s[36:39], s7 offen nt
    v_mfma_f32_16x16x32_bf16 v[40:43], v[184:187], v[44:47], v[40:43]
    v_and_b32_dpp v48, v84, v10 row_newbcast:4 row_mask:0xf bank_mask:0xf
    v_and_b32_dpp v49, v84, v11 row_newbcast:4 row_mask:0xf bank_mask:0xf
    v_and_b32_dpp v50, v84, v12 row_newbcast:4 row_mask:0xf bank_mask:0xf
    v_and_b32_dpp v51, v84, v13 row_newbcast:4 row_mask:0xf bank_mask:0xf
    s_addk_i32 s7, 0x1000
    s_waitcnt vmcnt(7)
    s_cmpk_gt_u32 s62, 225
    s_cbranch_scc1 L_go_176
    s_waitcnt vmcnt(5)
    s_cmpk_le_u32 s63, 225
    s_cbranch_scc1 L_go_176
    s_waitcnt vmcnt(4)
L_go_176:
    buffer_load_dwordx4 v[220:223], v3, s[36:39], s7 offen nt
    v_mfma_f32_16x16x32_bf16 v[40:43], v[188:191], v[48:51], v[40:43]
    v_and_b32_dpp v44, v84, v10 row_newbcast:8 row_mask:0xf bank_mask:0xf
    v_and_b32_dpp v45, v84, v11 row_newbcast:8 row_mask:0xf bank_mask:0xf
    v_and_b32_dpp v46, v84, v12 row_newbcast:8 row_mask:0xf bank_mask:0xf
    v_and_b32_dpp v47, v84, v13 row_newbcast:8 row_mask:0xf bank_mask:0xf
    s_addk_i32 s7, 0x1000
    s_or_b32 s73, s7, s71
    s_waitcnt vmcnt(7)
    s_cmpk_gt_u32 s62, 226
    s_cbranch_scc1 L_go_177
    s_waitcnt vmcnt(5)
    s_cmpk_le_u32 s63, 226
    s_cbranch_scc1 L_go_177
    s_waitcnt vmcnt(4)
L_go_177:
    buffer_load_dwordx4 v[224:227], v3, s[36:39], s73 offen nt
    v_mfma_f32_16x16x32_bf16 v[40:43], v[192:195], v[44:47], v[40:43]
    v_and_b32_dpp v48, v84, v10 row_newbcast:12 row_mask:0xf bank_mask:0xf
    v_and_b32_dpp v49, v84, v11 row_newbcast:12 row_mask:0xf bank_mask:0xf
    v_and_b32_dpp v50, v84, v12 row_newbcast:12 row_mask:0xf bank_mask:0xf
    v_and_b32_dpp v51, v84, v13 row_newbcast:12 row_mask:0xf bank_mask:0xf
    s_addk_i32 s7, 0x1000
    s_waitcnt vmcnt(7)
    s_cmpk_gt_u32 s62, 227
    s_cbranch_scc1 L_go_178
    s_waitcnt vmcnt(5)
    s_cmpk_le_u32 s63, 227
    s_cbranch_scc1 L_go_178
    s_waitcnt vmcnt(4)
L_go_178:
    buffer_load_dwordx4 v[228:231], v3, s[36:39], s7 offen nt
    v_mfma_f32_16x16x32_bf16 v[40:43], v[196:199], v[48:51], v[40:43]
    v_and_b32_dpp v44, v85, v10 row_newbcast:0 row_mask:0xf bank_mask:0xf
    v_and_b32_dpp v45, v85, v11 row_newbcast:0 row_mask:0xf bank_mask:0xf
    v_and_b32_dpp v46, v85, v12 row_newbcast:0 row_mask:0xf bank_mask:0xf
    v_and_b32_dpp v47, v85, v13 row_newbcast:0 row_mask:0xf bank_mask:0xf
    s_addk_i32 s7, 0x1000
    s_waitcnt vmcnt(7)
    s_cmpk_gt_u32 s62, 228
    s_cbranch_scc1 L_go_179
    s_waitcnt vmcnt(5)
    s_cmpk_le_u32 s63, 228
    s_cbranch_scc1 L_go_179
    s_waitcnt vmcnt(4)
L_go_179:
    buffer_load_dwordx4 v[232:235], v3, s[36:39], s7 offen nt
    v_mfma_f32_16x16x32_bf16 v[40:43], v[200:203], v[44:47], v[40:43]
    v_and_b32_dpp v48, v85, v10 row_newbcast:4 row_mask:0xf bank_mask:0xf
    v_and_b32_dpp v49, v85, v11 row_newbcast:4 row_mask:0xf bank_mask:0xf
    v_and_b32_dpp v50, v85, v12 row_newbcast:4 row_mask:0xf bank_mask:0xf
    v_and_b32_dpp v51, v85, v13 row_newbcast:4 row_mask:0xf bank_mask:0xf
    s_addk_i32 s7, 0x1000
    s_waitcnt vmcnt(7)
    s_cmpk_gt_u32 s62, 229
    s_cbranch_scc1 L_go_180
    s_waitcnt vmcnt(5)
    s_cmpk_le_u32 s63, 229
    s_cbranch_scc1 L_go_180
    s_waitcnt vmcnt(4)
L_go_180:
    buffer_load_dwordx4 v[236:239], v3, s[36:39], s7 offen nt
    s_and_b32 s0, s6, 7
    s_sub_u32 s0, s0, 1
    s_lshl_b32 s0, s0, 2
    s_bfe_u32 s1, s6, 0x20003
    s_add_u32 s0, s0, s1
    s_and_b32 s1, s98, 240
    s_cmp_lt_u32 s0, 10
    s_cselect_b32 s0, 128, s1
    v_mfma_f32_16x16x32_bf16 v[40:43], v[204:207], v[48:51], v[40:43]
    v_and_b32_dpp v44, v85, v10 row_newbcast:8 row_mask:0xf bank_mask:0xf
    v_and_b32_dpp v45, v85, v11 row_newbcast:8 row_mask:0xf bank_mask:0xf
    v_and_b32_dpp v46, v85, v12 row_newbcast:8 row_mask:0xf bank_mask:0xf
    v_and_b32_dpp v47, v85, v13 row_newbcast:8 row_mask:0xf bank_mask:0xf
    s_addk_i32 s7, 0x1000
    s_waitcnt vmcnt(7)
    s_cmpk_gt_u32 s62, 230
    s_cbranch_scc1 L_go_181
    s_waitcnt vmcnt(5)
    s_cmpk_le_u32 s63, 230
    s_cbranch_scc1 L_go_181
    s_waitcnt vmcnt(4)
L_go_181:
    buffer_load_dwordx4 v[240:243], v3, s[36:39], s7 offen nt
    v_mfma_f32_16x16x32_bf16 v[40:43], v[208:211], v[44:47], v[40:43]
    v_and_b32_dpp v48, v85, v10 row_newbcast:12 row_mask:0xf bank_mask:0xf
    v_and_b32_dpp v49, v85, v11 row_newbcast:12 row_mask:0xf bank_mask:0xf
    v_and_b32_dpp v50, v85, v12 row_newbcast:12 row_mask:0xf bank_mask:0xf
    v_and_b32_dpp v51, v85, v13 row_newbcast:12 row_mask:0xf bank_mask:0xf
    s_addk_i32 s7, 0x1000
    s_or_b32 s73, s7, s71
    s_waitcnt vmcnt(7)
    s_cmpk_gt_u32 s62, 231
    s_cbranch_scc1 L_go_182
    s_waitcnt vmcnt(5)
    s_cmpk_le_u32 s63, 231
    s_cbranch_scc1 L_go_182
    s_waitcnt vmcnt(4)
L_go_182:
    buffer_load_dwordx4 v[244:247], v3, s[36:39], s73 offen nt
    s_memrealtime s[74:75]
    v_mfma_f32_16x16x32_bf16 v[40:43], v[212:215], v[48:51], v[40:43]
    v_and_b32_dpp v44, v86, v10 row_newbcast:0 row_mask:0xf bank_mask:0xf
    v_and_b32_dpp v45, v86, v11 row_newbcast:0 row_mask:0xf bank_mask:0xf
    v_and_b32_dpp v46, v86, v12 row_newbcast:0 row_mask:0xf bank_mask:0xf
    v_and_b32_dpp v47, v86, v13 row_newbcast:0 row_mask:0xf bank_mask:0xf
    s_addk_i32 s7, 0x1000
    s_waitcnt vmcnt(7)
    s_cmpk_gt_u32 s62, 232
    s_cbranch_scc1 L_go_183
    s_waitcnt vmcnt(5)
    s_cmpk_le_u32 s63, 232
    s_cbranch_scc1 L_go_183
    s_waitcnt vmcnt(4)
L_go_183:
    buffer_load_dwordx4 v[248:251], v3, s[36:39], s7 offen nt
    s_waitcnt lgkmcnt(0)
    s_mov_b32 s68, 0
    s_sub_u32 s69, s60, s44
    s_cmp_eq_u32 s45, s77
    s_cselect_b32 s69, s69, -154
    s_add_u32 s68, s68, s69
    s_sub_u32 s69, s60, s46
    s_cmp_eq_u32 s47, s77
    s_cselect_b32 s69, s69, -154
    s_add_u32 s68, s68, s69
    s_sub_u32 s69, s60, s48
    s_cmp_eq_u32 s49, s77
    s_cselect_b32 s69, s69, -154
    s_add_u32 s68, s68, s69
    s_sub_u32 s69, s60, s50
    s_cmp_eq_u32 s51, s77
    s_cselect_b32 s69, s69, -154
    s_add_u32 s68, s68, s69
    s_sub_u32 s69, s60, s52
    s_cmp_eq_u32 s53, s77
    s_cselect_b32 s69, s69, -154
    s_add_u32 s68, s68, s69
    s_sub_u32 s69, s60, s54
    s_cmp_eq_u32 s55, s77
    s_cselect_b32 s69, s69, -154
    s_add_u32 s68, s68, s69
    s_sub_u32 s69, s60, s56
    s_cmp_eq_u32 s57, s77
    s_cselect_b32 s69, s69, -154
    s_add_u32 s68, s68, s69
    s_sub_u32 s69, s60, s58
    s_cmp_eq_u32 s59, s77
    s_cselect_b32 s69, s69, -154
    s_add_u32 s68, s68, s69
    s_mul_i32 s69, s60, 8
    s_sub_u32 s69, s69, s68
    s_sub_u32 s76, s69, s2
    s_mov_b32 s2, s69
    s_mul_i32 s96, s76, 235
    s_lshr_b32 s96, s96, 8
    s_sub_u32 s69, s74, s60
    s_mul_i32 s69, s69, 8
    s_sub_i32 s69, s69, s96
    s_mul_i32 s69, s69, 16
    s_ashr_i32 s69, s69, 4
    s_add_i32 s68, s68, s69
    s_add_i32 s68, s68, s0
    s_max_i32 s69, s68, 0
    s_min_u32 s69, s69, 0x4000
    s_mul_i32 s69, s69, 1638
    s_lshr_b32 s69, s69, 16
    s_add_u32 s62, s69, 233
    s_sub_i32 s69, 0, s68
    s_max_i32 s69, s69, 0
    s_min_u32 s69, s69, 0x4000
    s_mul_i32 s69, s69, 1966
    s_lshr_b32 s69, s69, 16
    s_add_u32 s63, s69, 233
    v_mfma_f32_16x16x32_bf16 v[40:43], v[216:219], v[44:47], v[40:43]
    v_and_b32_dpp v48, v86, v10 row_newbcast:4 row_mask:0xf bank_mask:0xf
    v_and_b32_dpp v49, v86, v11 row_newbcast:4 row_mask:0xf bank_mask:0xf
    v_and_b32_dpp v50, v86, v12 row_newbcast:4 row_mask:0xf bank_mask:0xf
    v_and_b32_dpp v51, v86, v13 row_newbcast:4 row_mask:0xf bank_mask:0xf
    s_addk_i32 s7, 0x1000
    s_waitcnt vmcnt(7)
    s_cmpk_gt_u32 s62, 233
    s_cbranch_scc1 L_go_184
    s_waitcnt vmcnt(5)
    s_cmpk_le_u32 s63, 233
    s_cbranch_scc1 L_go_184
    s_waitcnt vmcnt(4)
L_go_184:
    buffer_load_dwordx4 v[252:255], v3, s[36:39], s7 offen nt
    s_memrealtime s[60:61]
    v_mfma_f32_16x16x32_bf16 v[40:43], v[220:223], v[48:51], v[40:43]
    v_and_b32_dpp v44, v86, v10 row_newbcast:8 row_mask:0xf bank_mask:0xf
    v_and_b32_dpp v45, v86, v11 row_newbcast:8 row_mask:0xf bank_mask:0xf
    v_and_b32_dpp v46, v86, v12 row_newbcast:8 row_mask:0xf bank_mask:0xf
    v_and_b32_dpp v47, v86, v13 row_newbcast:8 row_mask:0xf bank_mask:0xf
    s_addk_i32 s7, 0x1000
    s_waitcnt vmcnt(7)
    s_cmpk_gt_u32 s62, 234
    s_cbranch_scc1 L_go_185
    s_waitcnt vmcnt(5)
    s_cmpk_le_u32 s63, 234
    s_cbranch_scc1 L_go_185
    s_waitcnt vmcnt(4)
L_go_185:
    buffer_load_dwordx4 v[100:103], v3, s[36:39], s7 offen nt
    s_cmp_lg_u32 s64, 0
    s_cbranch_scc1 L_ref_186_r
L_ref_186:
    v_mfma_f32_16x16x32_bf16 v[40:43], v[224:227], v[44:47], v[40:43]
    v_and_b32_dpp v48, v86, v10 row_newbcast:12 row_mask:0xf bank_mask:0xf
    v_and_b32_dpp v49, v86, v11 row_newbcast:12 row_mask:0xf bank_mask:0xf
    v_and_b32_dpp v50, v86, v12 row_newbcast:12 row_mask:0xf bank_mask:0xf
    v_and_b32_dpp v51, v86, v13 row_newbcast:12 row_mask:0xf bank_mask:0xf
    s_addk_i32 s7, 0x1000
    s_waitcnt vmcnt(7)
    s_cmpk_gt_u32 s62, 235
    s_cbranch_scc1 L_go_187
    s_waitcnt vmcnt(5)
    s_cmpk_le_u32 s63, 235
    s_cbranch_scc1 L_go_187
    s_waitcnt vmcnt(4)
L_go_187:
    buffer_load_dwordx4 v[104:107], v3, s[36:39], s7 offen nt
    v_mfma_f32_16x16x32_bf16 v[40:43], v[228:231], v[48:51], v[40:43]
    v_and_b32_dpp v44, v87, v10 row_newbcast:0 row_mask:0xf bank_mask:0xf
    v_and_b32_dpp v45, v87, v11 row_newbcast:0 row_mask:0xf bank_mask:0xf
    v_and_b32_dpp v46, v87, v12 row_newbcast:0 row_mask:0xf bank_mask:0xf
    v_and_b32_dpp v47, v87, v13 row_newbcast:0 row_mask:0xf bank_mask:0xf
    s_addk_i32 s7, 0x1000
    s_or_b32 s73, s7, s71
    s_waitcnt vmcnt(7)
    s_cmpk_gt_u32 s62, 236
    s_cbranch_scc1 L_go_188
    s_waitcnt vmcnt(5)
    s_cmpk_le_u32 s63, 236
    s_cbranch_scc1 L_go_188
    s_waitcnt vmcnt(4)
L_go_188:
    buffer_load_dwordx4 v[108:111], v3, s[36:39], s73 offen nt
    v_mfma_f32_16x16x32_bf16 v[40:43], v[232:235], v[44:47], v[40:43]
    v_and_b32_dpp v48, v87, v10 row_newbcast:4 row_mask:0xf bank_mask:0xf
    v_and_b32_dpp v49, v87, v11 row_newbcast:4 row_mask:0xf bank_mask:0xf
    v_and_b32_dpp v50, v87, v12 row_newbcast:4 row_mask:0xf bank_mask:0xf
    v_and_b32_dpp v51, v87, v13 row_newbcast:4 row_mask:0xf bank_mask:0xf
    s_add_u32 s73, s72, 0x04010000
    s_waitcnt vmcnt(7)
    s_cmpk_gt_u32 s62, 237
    s_cbranch_scc1 L_go_189
    s_waitcnt vmcnt(5)
    s_cmpk_le_u32 s63, 237
    s_cbranch_scc1 L_go_189
    s_waitcnt vmcnt(4)
L_go_189:
    buffer_load_dwordx4 v[112:115], v3, s[36:39], s73 offen nt
    v_mfma_f32_16x16x32_bf16 v[40:43], v[236:239], v[48:51], v[40:43]
    v_and_b32_dpp v44, v87, v10 row_newbcast:8 row_mask:0xf bank_mask:0xf
    v_and_b32_dpp v45, v87, v11 row_newbcast:8 row_mask:0xf bank_mask:0xf
    v_and_b32_dpp v46, v87, v12 row_newbcast:8 row_mask:0xf bank_mask:0xf
    v_and_b32_dpp v47, v87, v13 row_newbcast:8 row_mask:0xf bank_mask:0xf
    s_addk_i32 s7, 0x1000
    s_or_b32 s73, s7, s71
    s_waitcnt vmcnt(7)
    s_cmpk_gt_u32 s62, 238
    s_cbranch_scc1 L_go_190
    s_waitcnt vmcnt(5)
    s_cmpk_le_u32 s63, 238
    s_cbranch_scc1 L_go_190
    s_waitcnt vmcnt(4)
L_go_190:
    buffer_load_dwordx4 v[116:119], v3, s[36:39], s73 offen nt
    v_mfma_f32_16x16x32_bf16 v[40:43], v[240:243], v[44:47], v[40:43]
    v_and_b32_dpp v48, v87, v10 row_newbcast:12 row_mask:0xf bank_mask:0xf
    v_and_b32_dpp v49, v87, v11 row_newbcast:12 row_mask:0xf bank_mask:0xf
    v_and_b32_dpp v50, v87, v12 row_newbcast:12 row_mask:0xf bank_mask:0xf
    v_and_b32_dpp v51, v87, v13 row_newbcast:12 row_mask:0xf bank_mask:0xf
    s_addk_i32 s7, 0x1000
    s_waitcnt vmcnt(7)
    s_cmpk_gt_u32 s62, 239
    s_cbranch_scc1 L_go_191
    s_waitcnt vmcnt(5)
    s_cmpk_le_u32 s63, 239
    s_cbranch_scc1 L_go_191
    s_waitcnt vmcnt(4)
L_go_191:
    buffer_load_dwordx4 v[120:123], v3, s[36:39], s7 offen nt
    v_mfma_f32_16x16x32_bf16 v[40:43], v[244:247], v[48:51], v[40:43]
    v_and_b32_dpp v44, v88, v10 row_newbcast:0 row_mask:0xf bank_mask:0xf
    v_and_b32_dpp v45, v88, v11 row_newbcast:0 row_mask:0xf bank_mask:0xf
    v_and_b32_dpp v46, v88, v12 row_newbcast:0 row_mask:0xf bank_mask:0xf
    v_and_b32_dpp v47, v88, v13 row_newbcast:0 row_mask:0xf bank_mask:0xf
    s_addk_i32 s7, 0x1000
    s_waitcnt vmcnt(7)
    s_cmpk_gt_u32 s62, 240
    s_cbranch_scc1 L_go_192
    s_waitcnt vmcnt(5)
    s_cmpk_le_u32 s63, 240
    s_cbranch_scc1 L_go_192
    s_waitcnt vmcnt(4)
L_go_192:
    buffer_load_dwordx4 v[124:127], v3, s[36:39], s7 offen nt
    v_mfma_f32_16x16x32_bf16 v[40:43], v[248:251], v[44:47], v[40:43]
    v_and_b32_dpp v48, v88, v10 row_newbcast:4 row_mask:0xf bank_mask:0xf
    v_and_b32_dpp v49, v88, v11 row_newbcast:4 row_mask:0xf bank_mask:0xf
    v_and_b32_dpp v50, v88, v12 row_newbcast:4 row_mask:0xf bank_mask:0xf
    v_and_b32_dpp v51, v88, v13 row_newbcast:4 row_mask:0xf bank_mask:0xf
    s_addk_i32 s7, 0x1000
    s_waitcnt vmcnt(7)
    s_cmpk_gt_u32 s62, 241
    s_cbranch_scc1 L_go_193
    s_waitcnt vmcnt(5)
    s_cmpk_le_u32 s63, 241
    s_cbranch_scc1 L_go_193
    s_waitcnt vmcnt(4)
L_go_193:
    buffer_load_dwordx4 v[128:131], v3, s[36:39], s7 offen nt
    v_mfma_f32_16x16x32_bf16 v[40:43], v[252:255], v[48:51], v[40:43]
    v_and_b32_dpp v44, v88, v10 row_newbcast:8 row_mask:0xf bank_mask:0xf
    v_and_b32_dpp v45, v88, v11 row_newbcast:8 row_mask:0xf bank_mask:0xf
    v_and_b32_dpp v46, v88, v12 row_newbcast:8 row_mask:0xf bank_mask:0xf
    v_and_b32_dpp v47, v88, v13 row_newbcast:8 row_mask:0xf bank_mask:0xf
    s_addk_i32 s7, 0x1000
    s_waitcnt vmcnt(7)
    s_cmpk_gt_u32 s62, 242
    s_cbranch_scc1 L_go_194
    s_waitcnt vmcnt(5)
    s_cmpk_le_u32 s63, 242
    s_cbranch_scc1 L_go_194
    s_waitcnt vmcnt(4)
L_go_194:
    buffer_load_dwordx4 v[132:135], v3, s[36:39], s7 offen nt
    s_memrealtime s[74:75]
    v_mfma_f32_16x16x32_bf16 v[40:43], v[100:103], v[44:47], v[40:43]
    v_and_b32_dpp v48, v88, v10 row_newbcast:12 row_mask:0xf bank_mask:0xf
    v_and_b32_dpp v49, v88, v11 row_newbcast:12 row_mask:0xf bank_mask:0xf
    v_and_b32_dpp v50, v88, v12 row_newbcast:12 row_mask:0xf bank_mask:0xf
    v_and_b32_dpp v51, v88, v13 row_newbcast:12 row_mask:0xf bank_mask:0xf
    s_addk_i32 s7, 0x1000
    s_or_b32 s73, s7, s71
    s_waitcnt vmcnt(7)
    s_cmpk_gt_u32 s62, 243
    s_cbranch_scc1 L_go_195
    s_waitcnt vmcnt(5)
    s_cmpk_le_u32 s63, 243
    s_cbranch_scc1 L_go_195
    s_waitcnt vmcnt(4)
L_go_195:
    buffer_load_dwordx4 v[136:139], v3, s[36:39], s73 offen nt
    s_mul_i32 s96, s76, 352
    s_lshr_b32 s96, s96, 8
    s_add_u32 s96, s96, s2
    s_waitcnt lgkmcnt(0)
    s_mul_i32 s68, s74, 8
    s_sub_u32 s68, s68, s96
    s_add_i32 s68, s68, s0
    s_max_i32 s69, s68, 0
    s_min_u32 s69, s69, 0x4000
    s_mul_i32 s69, s69, 1638
    s_lshr_b32 s69, s69, 16
    s_add_u32 s62, s69, 244
    s_sub_i32 s69, 0, s68
    s_max_i32 s69, s69, 0
    s_min_u32 s69, s69, 0x4000
    s_mul_i32 s69, s69, 1966
    s_lshr_b32 s69, s69, 16
    s_add_u32 s63, s69, 244
    v_mfma_f32_16x16x32_bf16 v[40:43], v[104:107], v[48:51], v[40:43]
    v_and_b32_dpp v44, v89, v10 row_newbcast:0 row_mask:0xf bank_mask:0xf
    v_and_b32_dpp v45, v89, v11 row_newbcast:0 row_mask:0xf bank_mask:0xf
    v_and_b32_dpp v46, v89, v12 row_newbcast:0 row_mask:0xf bank_mask:0xf
    v_and_b32_dpp v47, v89, v13 row_newbcast:0 row_mask:0xf bank_mask:0xf
    s_addk_i32 s7, 0x1000
    s_waitcnt vmcnt(7)
    s_cmpk_gt_u32 s62, 244
    s_cbranch_scc1 L_go_196
    s_waitcnt vmcnt(5)
    s_cmpk_le_u32 s63, 244
    s_cbranch_scc1 L_go_196
    s_waitcnt vmcnt(4)
L_go_196:
    buffer_load_dwordx4 v[140:143], v3, s[36:39], s7 offen nt
    s_load_dwordx2 s[44:45], s[66:67], 1152
    s_load_dwordx2 s[46:47], s[66:67], 5504
    s_load_dwordx2 s[48:49], s[66:67], 9856
    s_load_dwordx2 s[50:51], s[66:67], 14208
    s_load_dwordx2 s[52:53], s[66:67], 18560
    s_load_dwordx2 s[54:55], s[66:67], 22912
    s_load_dwordx2 s[56:57], s[66:67], 27264
    s_load_dwordx2 s[58:59], s[66:67], 31616
    v_mfma_f32_16x16x32_bf16 v[40:43], v[108:111], v[44:47], v[40:43]
    v_and_b32_dpp v48, v89, v10 row_newbcast:4 row_mask:0xf bank_mask:0xf
    v_and_b32_dpp v49, v89, v11 row_newbcast:4 row_mask:0xf bank_mask:0xf
    v_and_b32_dpp v50, v89, v12 row_newbcast:4 row_mask:0xf bank_mask:0xf
    v_and_b32_dpp v51, v89, v13 row_newbcast:4 row_mask:0xf bank_mask:0xf
    s_addk_i32 s7, 0x1000
    s_waitcnt vmcnt(7)
    s_cmpk_gt_u32 s62, 245
    s_cbranch_scc1 L_go_197
    s_waitcnt vmcnt(5)
    s_cmpk_le_u32 s63, 245
    s_cbranch_scc1 L_go_197
    s_waitcnt vmcnt(4)
L_go_197:
    buffer_load_dwordx4 v[144:147], v3, s[36:39], s7 offen nt
    v_mfma_f32_16x16x32_bf16 v[40:43], v[112:115], v[48:51], v[40:43]
    v_and_b32_dpp v44, v89, v10 row_newbcast:8 row_mask:0xf bank_mask:0xf
    v_and_b32_dpp v45, v89, v11 row_newbcast:8 row_mask:0xf bank_mask:0xf
    v_and_b32_dpp v46, v89, v12 row_newbcast:8 row_mask:0xf bank_mask:0xf
    v_and_b32_dpp v47, v89, v13 row_newbcast:8 row_mask:0xf bank_mask:0xf
    s_addk_i32 s7, 0x1000
    s_waitcnt vmcnt(7)
    s_cmpk_gt_u32 s62, 246
    s_cbranch_scc1 L_go_198
    s_waitcnt vmcnt(5)
    s_cmpk_le_u32 s63, 246
    s_cbranch_scc1 L_go_198
    s_waitcnt vmcnt(4)
L_go_198:
    buffer_load_dwordx4 v[148:151], v3, s[36:39], s7 offen nt
    v_mfma_f32_16x16x32_bf16 v[40:43], v[116:119], v[44:47], v[40:43]
    v_and_b32_dpp v48, v89, v10 row_newbcast:12 row_mask:0xf bank_mask:0xf
    v_and_b32_dpp v49, v89, v11 row_newbcast:12 row_mask:0xf bank_mask:0xf
    v_and_b32_dpp v50, v89, v12 row_newbcast:12 row_mask:0xf bank_mask:0xf
    v_and_b32_dpp v51, v89, v13 row_newbcast:12 row_mask:0xf bank_mask:0xf
    s_addk_i32 s7, 0x1000
    s_waitcnt vmcnt(7)
    s_cmpk_gt_u32 s62, 247
    s_cbranch_scc1 L_go_199
    s_waitcnt vmcnt(5)
    s_cmpk_le_u32 s63, 247
    s_cbranch_scc1 L_go_199
    s_waitcnt vmcnt(4)
L_go_199:
    buffer_load_dwordx4 v[152:155], v3, s[36:39], s7 offen nt
    v_mfma_f32_16x16x32_bf16 v[40:43], v[120:123], v[48:51], v[40:43]
    v_and_b32_dpp v44, v90, v10 row_newbcast:0 row_mask:0xf bank_mask:0xf
    v_and_b32_dpp v45, v90, v11 row_newbcast:0 row_mask:0xf bank_mask:0xf
    v_and_b32_dpp v46, v90, v12 row_newbcast:0 row_mask:0xf bank_mask:0xf
    v_and_b32_dpp v47, v90, v13 row_newbcast:0 row_mask:0xf bank_mask:0xf
    s_addk_i32 s7, 0x1000
    s_or_b32 s73, s7, s71
    s_waitcnt vmcnt(7)
    s_cmpk_gt_u32 s62, 248
    s_cbranch_scc1 L_go_200
    s_waitcnt vmcnt(5)
    s_cmpk_le_u32 s63, 248
    s_cbranch_scc1 L_go_200
    s_waitcnt vmcnt(4)
L_go_200:
    buffer_load_dwordx4 v[156:159], v3, s[36:39], s73 offen nt
    v_mfma_f32_16x16x32_bf16 v[40:43], v[124:127], v[44:47], v[40:43]
    v_and_b32_dpp v48, v90, v10 row_newbcast:4 row_mask:0xf bank_mask:0xf
    v_and_b32_dpp v49, v90, v11 row_newbcast:4 row_mask:0xf bank_mask:0xf
    v_and_b32_dpp v50, v90, v12 row_newbcast:4 row_mask:0xf bank_mask:0xf
    v_and_b32_dpp v51, v90, v13 row_newbcast:4 row_mask:0xf bank_mask:0xf
    s_addk_i32 s7, 0x1000
    s_waitcnt vmcnt(7)
    s_cmpk_gt_u32 s62, 249
    s_cbranch_scc1 L_go_201
    s_waitcnt vmcnt(5)
    s_cmpk_le_u32 s63, 249
    s_cbranch_scc1 L_go_201
    s_waitcnt vmcnt(4)
L_go_201:
    buffer_load_dwordx4 v[160:163], v3, s[36:39], s7 offen nt
    v_mfma_f32_16x16x32_bf16 v[40:43], v[128:131], v[48:51], v[40:43]
    v_and_b32_dpp v44, v90, v10 row_newbcast:8 row_mask:0xf bank_mask:0xf
    v_and_b32_dpp v45, v90, v11 row_newbcast:8 row_mask:0xf bank_mask:0xf
    v_and_b32_dpp v46, v90, v12 row_newbcast:8 row_mask:0xf bank_mask:0xf
    v_and_b32_dpp v47, v90, v13 row_newbcast:8 row_mask:0xf bank_mask:0xf
    s_addk_i32 s7, 0x1000
    s_waitcnt vmcnt(7)
    s_cmpk_gt_u32 s62, 250
    s_cbranch_scc1 L_go_202
    s_waitcnt vmcnt(5)
    s_cmpk_le_u32 s63, 250
    s_cbranch_scc1 L_go_202
    s_waitcnt vmcnt(4)
L_go_202:
    buffer_load_dwordx4 v[164:167], v3, s[36:39], s7 offen nt
    s_mov_b64 exec, 1
    ds_write_b32 v61, v5 offset:4644
    s_mov_b64 exec, -1
    v_mfma_f32_16x16x32_bf16 v[40:43], v[132:135], v[44:47], v[40:43]
    v_and_b32_dpp v48, v90, v10 row_newbcast:12 row_mask:0xf bank_mask:0xf
    v_and_b32_dpp v49, v90, v11 row_newbcast:12 row_mask:0xf bank_mask:0xf
    v_and_b32_dpp v50, v90, v12 row_newbcast:12 row_mask:0xf bank_mask:0xf
    v_and_b32_dpp v51, v90, v13 row_newbcast:12 row_mask:0xf bank_mask:0xf
    s_addk_i32 s7, 0x1000
    s_waitcnt vmcnt(7)
    s_cmpk_gt_u32 s62, 251
    s_cbranch_scc1 L_go_203
    s_waitcnt vmcnt(5)
    s_cmpk_le_u32 s63, 251
    s_cbranch_scc1 L_go_203
    s_waitcnt vmcnt(4)
L_go_203:
    buffer_load_dwordx4 v[168:171], v3, s[36:39], s7 offen nt
    v_mfma_f32_16x16x32_bf16 v[40:43], v[136:139], v[48:51], v[40:43]
    v_and_b32_dpp v44, v91, v10 row_newbcast:0 row_mask:0xf bank_mask:0xf
    v_and_b32_dpp v45, v91, v11 row_newbcast:0 row_mask:0xf bank_mask:0xf
    v_and_b32_dpp v46, v91, v12 row_newbcast:0 row_mask:0xf bank_mask:0xf
    v_and_b32_dpp v47, v91, v13 row_newbcast:0 row_mask:0xf bank_mask:0xf
    s_addk_i32 s7, 0x1000
    s_waitcnt vmcnt(7)
    s_cmpk_gt_u32 s62, 252
    s_cbranch_scc1 L_go_204
    s_waitcnt vmcnt(5)
    s_cmpk_le_u32 s63, 252
    s_cbranch_scc1 L_go_204
    s_waitcnt vmcnt(4)
L_go_204:
    buffer_load_dwordx4 v[172:175], v3, s[36:39], s7 offen nt
    v_mfma_f32_16x16x32_bf16 v[40:43], v[140:143], v[44:47], v[40:43]
    v_and_b32_dpp v48, v91, v10 row_newbcast:4 row_mask:0xf bank_mask:0xf
    v_and_b32_dpp v49, v91, v11 row_newbcast:4 row_mask:0xf bank_mask:0xf
    v_and_b32_dpp v50, v91, v12 row_newbcast:4 row_mask:0xf bank_mask:0xf
    v_and_b32_dpp v51, v91, v13 row_newbcast:4 row_mask:0xf bank_mask:0xf
    s_addk_i32 s7, 0x1000
    s_or_b32 s73, s7, s71
    s_waitcnt vmcnt(7)
    s_cmpk_gt_u32 s62, 253
    s_cbranch_scc1 L_go_205
    s_waitcnt vmcnt(5)
    s_cmpk_le_u32 s63, 253
    s_cbranch_scc1 L_go_205
    s_waitcnt vmcnt(4)
L_go_205:
    buffer_load_dwordx4 v[176:179], v3, s[36:39], s73 offen nt
    v_mfma_f32_16x16x32_bf16 v[40:43], v[144:147], v[48:51], v[40:43]
    v_and_b32_dpp v44, v91, v10 row_newbcast:8 row_mask:0xf bank_mask:0xf
    v_and_b32_dpp v45, v91, v11 row_newbcast:8 row_mask:0xf bank_mask:0xf
    v_and_b32_dpp v46, v91, v12 row_newbcast:8 row_mask:0xf bank_mask:0xf
    v_and_b32_dpp v47, v91, v13 row_newbcast:8 row_mask:0xf bank_mask:0xf
    s_add_u32 s73, s72, 0x04020000
    s_waitcnt vmcnt(7)
    s_cmpk_gt_u32 s62, 254
    s_cbranch_scc1 L_go_206
    s_waitcnt vmcnt(5)
    s_cmpk_le_u32 s63, 254
    s_cbranch_scc1 L_go_206
    s_waitcnt vmcnt(4)
L_go_206:
    buffer_load_dwordx4 v[180:183], v3, s[36:39], s73 offen nt
    v_mfma_f32_16x16x32_bf16 v[40:43], v[148:151], v[44:47], v[40:43]
    v_and_b32_dpp v48, v91, v10 row_newbcast:12 row_mask:0xf bank_mask:0xf
    v_and_b32_dpp v49, v91, v11 row_newbcast:12 row_mask:0xf bank_mask:0xf
    v_and_b32_dpp v50, v91, v12 row_newbcast:12 row_mask:0xf bank_mask:0xf
    v_and_b32_dpp v51, v91, v13 row_newbcast:12 row_mask:0xf bank_mask:0xf
    s_addk_i32 s7, 0x1000
    s_or_b32 s73, s7, s71
    s_waitcnt vmcnt(7)
    s_cmpk_gt_u32 s62, 255
    s_cbranch_scc1 L_go_207
    s_waitcnt vmcnt(5)
    s_cmpk_le_u32 s63, 255
    s_cbranch_scc1 L_go_207
    s_waitcnt vmcnt(4)
L_go_207:
    buffer_load_dwordx4 v[184:187], v3, s[36:39], s73 offen nt
    s_memrealtime s[74:75]
    v_mfma_f32_16x16x32_bf16 v[40:43], v[152:155], v[48:51], v[40:43]
    v_and_b32_dpp v44, v92, v10 row_newbcast:0 row_mask:0xf bank_mask:0xf
    v_and_b32_dpp v45, v92, v11 row_newbcast:0 row_mask:0xf bank_mask:0xf
    v_and_b32_dpp v46, v92, v12 row_newbcast:0 row_mask:0xf bank_mask:0xf
    v_and_b32_dpp v47, v92, v13 row_newbcast:0 row_mask:0xf bank_mask:0xf
    s_addk_i32 s7, 0x1000
    s_waitcnt vmcnt(7)
    s_cmpk_gt_u32 s62, 256
    s_cbranch_scc1 L_go_208
    s_waitcnt vmcnt(5)
    s_cmpk_le_u32 s63, 256
    s_cbranch_scc1 L_go_208
    s_waitcnt vmcnt(4)
L_go_208:
    buffer_load_dwordx4 v[188:191], v3, s[36:39], s7 offen nt
    s_waitcnt lgkmcnt(0)
    s_mov_b32 s68, 0
    s_sub_u32 s69, s60, s44
    s_cmp_eq_u32 s45, s77
    s_cselect_b32 s69, s69, -154
    s_add_u32 s68, s68, s69
    s_sub_u32 s69, s60, s46
    s_cmp_eq_u32 s47, s77
    s_cselect_b32 s69, s69, -154
    s_add_u32 s68, s68, s69
    s_sub_u32 s69, s60, s48
    s_cmp_eq_u32 s49, s77
    s_cselect_b32 s69, s69, -154
    s_add_u32 s68, s68, s69
    s_sub_u32 s69, s60, s50
    s_cmp_eq_u32 s51, s77
    s_cselect_b32 s69, s69, -154
    s_add_u32 s68, s68, s69
    s_sub_u32 s69, s60, s52
    s_cmp_eq_u32 s53, s77
    s_cselect_b32 s69, s69, -154
    s_add_u32 s68, s68, s69
    s_sub_u32 s69, s60, s54
    s_cmp_eq_u32 s55, s77
    s_cselect_b32 s69, s69, -154
    s_add_u32 s68, s68, s69
    s_sub_u32 s69, s60, s56
    s_cmp_eq_u32 s57, s77
    s_cselect_b32 s69, s69, -154
    s_add_u32 s68, s68, s69
    s_sub_u32 s69, s60, s58
    s_cmp_eq_u32 s59, s77
    s_cselect_b32 s69, s69, -154
    s_add_u32 s68, s68, s69
    s_mul_i32 s69, s60, 8
    s_sub_u32 s69, s69, s68
    s_sub_u32 s76, s69, s2
    s_mov_b32 s2, s69
    s_mul_i32 s96, s76, 235
    s_lshr_b32 s96, s96, 8
    s_sub_u32 s69, s74, s60
    s_mul_i32 s69, s69, 8
    s_sub_i32 s69, s69, s96
    s_mul_i32 s69, s69, 16
    s_ashr_i32 s69, s69, 4
    s_add_i32 s68, s68, s69
    s_add_i32 s68, s68, s0
    s_add_i32 s69, s68, 80
    s_max_i32 s69, s69, 0
    s_min_u32 s69, s69, 0x1000
    s_mul_i32 s69, s69, 1310
    s_lshr_b32 s69, s69, 16
    s_sub_u32 s62, 272, s69
    s_sub_i32 s69, 0, s68
    s_max_i32 s69, s69, 0
    s_min_u32 s69, s69, 0x4000
    s_mul_i32 s69, s69, 1966
    s_lshr_b32 s69, s69, 16
    s_add_u32 s63, s69, 257
    v_mfma_f32_16x16x32_bf16 v[40:43], v[156:159], v[44:47], v[40:43]
    v_and_b32_dpp v48, v92, v10 row_newbcast:4 row_mask:0xf bank_mask:0xf
    v_and_b32_dpp v49, v92, v11 row_newbcast:4 row_mask:0xf bank_mask:0xf
    v_and_b32_dpp v50, v92, v12 row_newbcast:4 row_mask:0xf bank_mask:0xf
    v_and_b32_dpp v51, v92, v13 row_newbcast:4 row_mask:0xf bank_mask:0xf
    s_addk_i32 s7, 0x1000
    s_cmpk_le_u32 s62, 257
    s_cbranch_scc1 L_go_209
    s_waitcnt vmcnt(5)
    s_cmpk_le_u32 s63, 257
    s_cbranch_scc1 L_go_209
    s_waitcnt vmcnt(4)
L_go_209:
    buffer_load_dwordx4 v[192:195], v3, s[36:39], s7 offen nt
    s_addk_i32 s7, 0x1000
    s_cmpk_le_u32 s62, 258
    s_cbranch_scc1 L_go_210
    s_waitcnt vmcnt(5)
    s_cmpk_le_u32 s63, 258
    s_cbranch_scc1 L_go_210
    s_waitcnt vmcnt(4)
L_go_210:
    buffer_load_dwordx4 v[196:199], v3, s[36:39], s7 offen nt
    s_addk_i32 s7, 0x1000
    s_cmpk_le_u32 s62, 259
    s_cbranch_scc1 L_go_211
    s_waitcnt vmcnt(5)
    s_cmpk_le_u32 s63, 259
    s_cbranch_scc1 L_go_211
    s_waitcnt vmcnt(4)
L_go_211:
    buffer_load_dwordx4 v[200:203], v3, s[36:39], s7 offen nt
    s_addk_i32 s7, 0x1000
    s_or_b32 s73, s7, s71
    s_cmpk_le_u32 s62, 260
    s_cbranch_scc1 L_go_212
    s_waitcnt vmcnt(5)
    s_cmpk_le_u32 s63, 260
    s_cbranch_scc1 L_go_212
    s_waitcnt vmcnt(4)
L_go_212:
    buffer_load_dwordx4 v[204:207], v3, s[36:39], s73 offen nt
    s_addk_i32 s7, 0x1000
    s_cmpk_le_u32 s62, 261
    s_cbranch_scc1 L_go_213
    s_waitcnt vmcnt(5)
    s_cmpk_le_u32 s63, 261
    s_cbranch_scc1 L_go_213
    s_waitcnt vmcnt(4)
L_go_213:
    buffer_load_dwordx4 v[208:211], v3, s[36:39], s7 offen nt
    s_memrealtime s[74:75]
    s_addk_i32 s7, 0x1000
    s_cmpk_le_u32 s62, 262
    s_cbranch_scc1 L_go_214
    s_waitcnt vmcnt(5)
    s_cmpk_le_u32 s63, 262
    s_cbranch_scc1 L_go_214
    s_waitcnt vmcnt(4)
L_go_214:
    buffer_load_dwordx4 v[212:215], v3, s[36:39], s7 offen nt
    s_mul_i32 s96, s76, 299
    s_lshr_b32 s96, s96, 8
    s_add_u32 s96, s96, s2
    s_waitcnt lgkmcnt(0)
    s_mul_i32 s68, s74, 8
    s_sub_u32 s68, s68, s96
    s_add_i32 s68, s68, s0
    s_add_i32 s69, s68, 80
    s_max_i32 s69, s69, 0
    s_min_u32 s69, s69, 0x1000
    s_mul_i32 s69, s69, 1310
    s_lshr_b32 s69, s69, 16
    s_sub_u32 s62, 272, s69
    s_sub_i32 s69, 0, s68
    s_max_i32 s69, s69, 0
    s_min_u32 s69, s69, 0x4000
    s_mul_i32 s69, s69, 1966
    s_lshr_b32 s69, s69, 16
    s_add_u32 s63, s69, 263
    s_addk_i32 s7, 0x1000
    s_waitcnt vmcnt(13)
    s_cmpk_le_u32 s62, 263
    s_cbranch_scc1 L_go_215
    s_waitcnt vmcnt(5)
    s_cmpk_le_u32 s63, 263
    s_cbranch_scc1 L_go_215
    s_waitcnt vmcnt(4)
L_go_215:
    buffer_load_dwordx4 v[216:219], v3, s[36:39], s7 offen nt
    v_mfma_f32_16x16x32_bf16 v[40:43], v[160:163], v[48:51], v[40:43]
    v_and_b32_dpp v44, v92, v10 row_newbcast:8 row_mask:0xf bank_mask:0xf
    v_and_b32_dpp v45, v92, v11 row_newbcast:8 row_mask:0xf bank_mask:0xf
    v_and_b32_dpp v46, v92, v12 row_newbcast:8 row_mask:0xf bank_mask:0xf
    v_and_b32_dpp v47, v92, v13 row_newbcast:8 row_mask:0xf bank_mask:0xf
    s_addk_i32 s7, 0x1000
    s_waitcnt vmcnt(13)
    s_cmpk_le_u32 s62, 264
    s_cbranch_scc1 L_go_216
    s_waitcnt vmcnt(5)
    s_cmpk_le_u32 s63, 264
    s_cbranch_scc1 L_go_216
    s_waitcnt vmcnt(4)
L_go_216:
    buffer_load_dwordx4 v[220:223], v3, s[36:39], s7 offen nt
    v_mfma_f32_16x16x32_bf16 v[40:43], v[164:167], v[44:47], v[40:43]
    v_and_b32_dpp v48, v92, v10 row_newbcast:12 row_mask:0xf bank_mask:0xf
    v_and_b32_dpp v49, v92, v11 row_newbcast:12 row_mask:0xf bank_mask:0xf
    v_and_b32_dpp v50, v92, v12 row_newbcast:12 row_mask:0xf bank_mask:0xf
    v_and_b32_dpp v51, v92, v13 row_newbcast:12 row_mask:0xf bank_mask:0xf
    s_addk_i32 s7, 0x1000
    s_or_b32 s73, s7, s71
    s_waitcnt vmcnt(13)
    s_cmpk_le_u32 s62, 265
    s_cbranch_scc1 L_go_217
    s_waitcnt vmcnt(5)
    s_cmpk_le_u32 s63, 265
    s_cbranch_scc1 L_go_217
    s_waitcnt vmcnt(4)
L_go_217:
    buffer_load_dwordx4 v[224:227], v3, s[36:39], s73 offen nt
    v_mfma_f32_16x16x32_bf16 v[40:43], v[168:171], v[48:51], v[40:43]
    v_and_b32_dpp v44, v93, v10 row_newbcast:0 row_mask:0xf bank_mask:0xf
    v_and_b32_dpp v45, v93, v11 row_newbcast:0 row_mask:0xf bank_mask:0xf
    v_and_b32_dpp v46, v93, v12 row_newbcast:0 row_mask:0xf bank_mask:0xf
    v_and_b32_dpp v47, v93, v13 row_newbcast:0 row_mask:0xf bank_mask:0xf
    s_addk_i32 s7, 0x1000
    s_waitcnt vmcnt(13)
    s_cmpk_le_u32 s62, 266
    s_cbranch_scc1 L_go_218
    s_waitcnt vmcnt(5)
    s_cmpk_le_u32 s63, 266
    s_cbranch_scc1 L_go_218
    s_waitcnt vmcnt(4)
L_go_218:
    buffer_load_dwordx4 v[228:231], v3, s[36:39], s7 offen nt
    v_mfma_f32_16x16x32_bf16 v[40:43], v[172:175], v[44:47], v[40:43]
    v_and_b32_dpp v48, v93, v10 row_newbcast:4 row_mask:0xf bank_mask:0xf
    v_and_b32_dpp v49, v93, v11 row_newbcast:4 row_mask:0xf bank_mask:0xf
    v_and_b32_dpp v50, v93, v12 row_newbcast:4 row_mask:0xf bank_mask:0xf
    v_and_b32_dpp v51, v93, v13 row_newbcast:4 row_mask:0xf bank_mask:0xf
    s_addk_i32 s7, 0x1000
    s_waitcnt vmcnt(13)
    s_cmpk_le_u32 s62, 267
    s_cbranch_scc1 L_go_219
    s_waitcnt vmcnt(5)
    s_cmpk_le_u32 s63, 267
    s_cbranch_scc1 L_go_219
    s_waitcnt vmcnt(4)
L_go_219:
    buffer_load_dwordx4 v[232:235], v3, s[36:39], s7 offen nt
    v_mfma_f32_16x16x32_bf16 v[40:43], v[176:179], v[48:51], v[40:43]
    v_and_b32_dpp v44, v93, v10 row_newbcast:8 row_mask:0xf bank_mask:0xf
    v_and_b32_dpp v45, v93, v11 row_newbcast:8 row_mask:0xf bank_mask:0xf
    v_and_b32_dpp v46, v93, v12 row_newbcast:8 row_mask:0xf bank_mask:0xf
    v_and_b32_dpp v47, v93, v13 row_newbcast:8 row_mask:0xf bank_mask:0xf
    s_addk_i32 s7, 0x1000
    s_waitcnt vmcnt(13)
    s_cmpk_le_u32 s62, 268
    s_cbranch_scc1 L_go_220
    s_waitcnt vmcnt(5)
    s_cmpk_le_u32 s63, 268
    s_cbranch_scc1 L_go_220
    s_waitcnt vmcnt(4)
L_go_220:
    buffer_load_dwordx4 v[236:239], v3, s[36:39], s7 offen nt
    v_mfma_f32_16x16x32_bf16 v[40:43], v[180:183], v[44:47], v[40:43]
    v_and_b32_dpp v48, v93, v10 row_newbcast:12 row_mask:0xf bank_mask:0xf
    v_and_b32_dpp v49, v93, v11 row_newbcast:12 row_mask:0xf bank_mask:0xf
    v_and_b32_dpp v50, v93, v12 row_newbcast:12 row_mask:0xf bank_mask:0xf
    v_and_b32_dpp v51, v93, v13 row_newbcast:12 row_mask:0xf bank_mask:0xf
    s_addk_i32 s7, 0x1000
    s_waitcnt vmcnt(13)
    s_cmpk_le_u32 s62, 269
    s_cbranch_scc1 L_go_221
    s_waitcnt vmcnt(5)
    s_cmpk_le_u32 s63, 269
    s_cbranch_scc1 L_go_221
    s_waitcnt vmcnt(4)
L_go_221:
    buffer_load_dwordx4 v[240:243], v3, s[36:39], s7 offen nt
    v_mfma_f32_16x16x32_bf16 v[40:43], v[184:187], v[48:51], v[40:43]
    v_and_b32_dpp v44, v94, v10 row_newbcast:0 row_mask:0xf bank_mask:0xf
    v_and_b32_dpp v45, v94, v11 row_newbcast:0 row_mask:0xf bank_mask:0xf
    v_and_b32_dpp v46, v94, v12 row_newbcast:0 row_mask:0xf bank_mask:0xf
    v_and_b32_dpp v47, v94, v13 row_newbcast:0 row_mask:0xf bank_mask:0xf
    s_addk_i32 s7, 0x1000
    s_or_b32 s73, s7, s71
    s_waitcnt vmcnt(13)
    s_cmpk_le_u32 s62, 270
    s_cbranch_scc1 L_go_222
    s_waitcnt vmcnt(5)
    s_cmpk_le_u32 s63, 270
    s_cbranch_scc1 L_go_222
    s_waitcnt vmcnt(4)
L_go_222:
    buffer_load_dwordx4 v[244:247], v3, s[36:39], s73 offen nt
    v_mfma_f32_16x16x32_bf16 v[40:43], v[188:191], v[44:47], v[40:43]
    v_and_b32_dpp v48, v94, v10 row_newbcast:4 row_mask:0xf bank_mask:0xf
    v_and_b32_dpp v49, v94, v11 row_newbcast:4 row_mask:0xf bank_mask:0xf
    v_and_b32_dpp v50, v94, v12 row_newbcast:4 row_mask:0xf bank_mask:0xf
    v_and_b32_dpp v51, v94, v13 row_newbcast:4 row_mask:0xf bank_mask:0xf
    s_add_u32 s73, s72, 0x04030000
    s_waitcnt vmcnt(13)
    s_cmpk_le_u32 s62, 271
    s_cbranch_scc1 L_go_223
    s_waitcnt vmcnt(5)
    s_cmpk_le_u32 s63, 271
    s_cbranch_scc1 L_go_223
    s_waitcnt vmcnt(4)
L_go_223:
    buffer_load_dwordx4 v[248:251], v3, s[36:39], s73 offen nt
    v_mfma_f32_16x16x32_bf16 v[40:43], v[192:195], v[48:51], v[40:43]
    v_and_b32_dpp v44, v94, v10 row_newbcast:8 row_mask:0xf bank_mask:0xf
    v_and_b32_dpp v45, v94, v11 row_newbcast:8 row_mask:0xf bank_mask:0xf
    v_and_b32_dpp v46, v94, v12 row_newbcast:8 row_mask:0xf bank_mask:0xf
    v_and_b32_dpp v47, v94, v13 row_newbcast:8 row_mask:0xf bank_mask:0xf
    s_waitcnt vmcnt(13)
    s_nop 0
    v_mfma_f32_16x16x32_bf16 v[40:43], v[196:199], v[44:47], v[40:43]
    v_and_b32_dpp v48, v94, v10 row_newbcast:12 row_mask:0xf bank_mask:0xf
    v_and_b32_dpp v49, v94, v11 row_newbcast:12 row_mask:0xf bank_mask:0xf
    v_and_b32_dpp v50, v94, v12 row_newbcast:12 row_mask:0xf bank_mask:0xf
    v_and_b32_dpp v51, v94, v13 row_newbcast:12 row_mask:0xf bank_mask:0xf
    s_waitcnt vmcnt(12)
    s_nop 0
    v_mfma_f32_16x16x32_bf16 v[40:43], v[200:203], v[48:51], v[40:43]
    v_and_b32_dpp v44, v95, v10 row_newbcast:0 row_mask:0xf bank_mask:0xf
    v_and_b32_dpp v45, v95, v11 row_newbcast:0 row_mask:0xf bank_mask:0xf
    v_and_b32_dpp v46, v95, v12 row_newbcast:0 row_mask:0xf bank_mask:0xf
    v_and_b32_dpp v47, v95, v13 row_newbcast:0 row_mask:0xf bank_mask:0xf
    s_waitcnt vmcnt(11)
    s_nop 0
    v_mfma_f32_16x16x32_bf16 v[40:43], v[204:207], v[44:47], v[40:43]
    v_and_b32_dpp v48, v95, v10 row_newbcast:4 row_mask:0xf bank_mask:0xf
    v_and_b32_dpp v49, v95, v11 row_newbcast:4 row_mask:0xf bank_mask:0xf
    v_and_b32_dpp v50, v95, v12 row_newbcast:4 row_mask:0xf bank_mask:0xf
    v_and_b32_dpp v51, v95, v13 row_newbcast:4 row_mask:0xf bank_mask:0xf
    s_waitcnt vmcnt(10)
    s_nop 0
    v_mfma_f32_16x16x32_bf16 v[40:43], v[208:211], v[48:51], v[40:43]
    v_and_b32_dpp v44, v95, v10 row_newbcast:8 row_mask:0xf bank_mask:0xf
    v_and_b32_dpp v45, v95, v11 row_newbcast:8 row_mask:0xf bank_mask:0xf
    v_and_b32_dpp v46, v95, v12 row_newbcast:8 row_mask:0xf bank_mask:0xf
    v_and_b32_dpp v47, v95, v13 row_newbcast:8 row_mask:0xf bank_mask:0xf
    s_waitcnt vmcnt(9)
    s_nop 0
    v_mfma_f32_16x16x32_bf16 v[40:43], v[212:215], v[44:47], v[40:43]
    v_and_b32_dpp v48, v95, v10 row_newbcast:12 row_mask:0xf bank_mask:0xf
    v_and_b32_dpp v49, v95, v11 row_newbcast:12 row_mask:0xf bank_mask:0xf
    v_and_b32_dpp v50, v95, v12 row_newbcast:12 row_mask:0xf bank_mask:0xf
    v_and_b32_dpp v51, v95, v13 row_newbcast:12 row_mask:0xf bank_mask:0xf
    s_waitcnt vmcnt(8)
    s_nop 0
    v_mfma_f32_16x16x32_bf16 v[40:43], v[216:219], v[48:51], v[40:43]
    v_and_b32_dpp v44, v96, v10 row_newbcast:0 row_mask:0xf bank_mask:0xf
    v_and_b32_dpp v45, v96, v11 row_newbcast:0 row_mask:0xf bank_mask:0xf
    v_and_b32_dpp v46, v96, v12 row_newbcast:0 row_mask:0xf bank_mask:0xf
    v_and_b32_dpp v47, v96, v13 row_newbcast:0 row_mask:0xf bank_mask:0xf
    s_waitcnt vmcnt(7)
    s_nop 0
    v_mfma_f32_16x16x32_bf16 v[40:43], v[220:223], v[44:47], v[40:43]
    v_and_b32_dpp v48, v96, v10 row_newbcast:4 row_mask:0xf bank_mask:0xf
    v_and_b32_dpp v49, v96, v11 row_newbcast:4 row_mask:0xf bank_mask:0xf
    v_and_b32_dpp v50, v96, v12 row_newbcast:4 row_mask:0xf bank_mask:0xf
    v_and_b32_dpp v51, v96, v13 row_newbcast:4 row_mask:0xf bank_mask:0xf
    s_waitcnt vmcnt(6)
    s_nop 0
    v_mfma_f32_16x16x32_bf16 v[40:43], v[224:227], v[48:51], v[40:43]
    v_and_b32_dpp v44, v96, v10 row_newbcast:8 row_mask:0xf bank_mask:0xf
    v_and_b32_dpp v45, v96, v11 row_newbcast:8 row_mask:0xf bank_mask:0xf
    v_and_b32_dpp v46, v96, v12 row_newbcast:8 row_mask:0xf bank_mask:0xf
    v_and_b32_dpp v47, v96, v13 row_newbcast:8 row_mask:0xf bank_mask:0xf
    s_waitcnt vmcnt(5)
    s_nop 0
    v_mfma_f32_16x16x32_bf16 v[40:43], v[228:231], v[44:47], v[40:43]
    v_and_b32_dpp v48, v96, v10 row_newbcast:12 row_mask:0xf bank_mask:0xf
    v_and_b32_dpp v49, v96, v11 row_newbcast:12 row_mask:0xf bank_mask:0xf
    v_and_b32_dpp v50, v96, v12 row_newbcast:12 row_mask:0xf bank_mask:0xf
    v_and_b32_dpp v51, v96, v13 row_newbcast:12 row_mask:0xf bank_mask:0xf
    s_waitcnt vmcnt(4)
    s_nop 0
    v_mfma_f32_16x16x32_bf16 v[40:43], v[232:235], v[48:51], v[40:43]
    v_and_b32_dpp v44, v97, v10 row_newbcast:0 row_mask:0xf bank_mask:0xf
    v_and_b32_dpp v45, v97, v11 row_newbcast:0 row_mask:0xf bank_mask:0xf
    v_and_b32_dpp v46, v97, v12 row_newbcast:0 row_mask:0xf bank_mask:0xf
    v_and_b32_dpp v47, v97, v13 row_newbcast:0 row_mask:0xf bank_mask:0xf
    s_waitcnt vmcnt(3)
    s_nop 0
    v_mfma_f32_16x16x32_bf16 v[40:43], v[236:239], v[44:47], v[40:43]
    v_and_b32_dpp v48, v97, v10 row_newbcast:4 row_mask:0xf bank_mask:0xf
    v_and_b32_dpp v49, v97, v11 row_newbcast:4 row_mask:0xf bank_mask:0xf
    v_and_b32_dpp v50, v97, v12 row_newbcast:4 row_mask:0xf bank_mask:0xf
    v_and_b32_dpp v51, v97, v13 row_newbcast:4 row_mask:0xf bank_mask:0xf
    s_waitcnt vmcnt(2)
    s_nop 0
    v_mfma_f32_16x16x32_bf16 v[40:43], v[240:243], v[48:51], v[40:43]
    v_and_b32_dpp v44, v97, v10 row_newbcast:8 row_mask:0xf bank_mask:0xf
    v_and_b32_dpp v45, v97, v11 row_newbcast:8 row_mask:0xf bank_mask:0xf
    v_and_b32_dpp v46, v97, v12 row_newbcast:8 row_mask:0xf bank_mask:0xf
    v_and_b32_dpp v47, v97, v13 row_newbcast:8 row_mask:0xf bank_mask:0xf
    s_waitcnt vmcnt(1)
    s_nop 0
    v_mfma_f32_16x16x32_bf16 v[40:43], v[244:247], v[44:47], v[40:43]
    v_and_b32_dpp v48, v97, v10 row_newbcast:12 row_mask:0xf bank_mask:0xf
    v_and_b32_dpp v49, v97, v11 row_newbcast:12 row_mask:0xf bank_mask:0xf
    v_and_b32_dpp v50, v97, v12 row_newbcast:12 row_mask:0xf bank_mask:0xf
    v_and_b32_dpp v51, v97, v13 row_newbcast:12 row_mask:0xf bank_mask:0xf
    s_waitcnt vmcnt(0)
    s_nop 0
    v_mfma_f32_16x16x32_bf16 v[40:43], v[248:251], v[48:51], v[40:43]
    s_mov_b32 s95, 720896
    s_movk_i32 s97, 0xfff
    s_mov_b64 exec, s[88:89]
    s_nop 4
    ds_write_b128 v62, v[40:43] offset:10240
    s_mov_b64 exec, 1
    ds_add_rtn_u32 v8, v61, v5 offset:4612
    s_mov_b32 exec_lo, -1
    ds_read_b128 v[16:19], v15 offset:10240
    ds_read_b128 v[20:23], v15 offset:10752
    ds_read_b128 v[24:27], v15 offset:11264
    ds_read_b128 v[28:31], v15 offset:11776
    s_waitcnt lgkmcnt(0)
    v_readfirstlane_b32 s96, v8
    v_pk_add_f32 v[16:17], v[16:17], v[20:21]
    v_pk_add_f32 v[18:19], v[18:19], v[22:23]
    v_pk_add_f32 v[24:25], v[24:25], v[28:29]
    v_pk_add_f32 v[26:27], v[26:27], v[30:31]
    s_cmp_lg_u32 s96, 2
    s_cbranch_scc1 L_olast_224
    s_cmp_lg_u32 s30, 0
    v_pk_add_f32 v[16:17], v[16:17], v[24:25]
    v_pk_add_f32 v[18:19], v[18:19], v[26:27]
    v_bfi_b32 v16, s97, v1, v16
    s_cbranch_scc1 L_olast_224_far
    buffer_store_dwordx4 v[16:19], v63, s[40:43], s95 offen
L_olast_224_st:
    ds_write_b32 v61, v5 offset:4648
L_olast_224:
    s_mov_b64 exec, -1
    s_cmp_eq_u32 s71, 0
    s_cbranch_scc1 L_sdone
    s_cmp_ge_u32 s99, 16
    s_cbranch_scc1 L_sdone
    s_lshr_b32 s96, s6, 5
    s_bfe_u32 s97, s6, 0x20003
    s_lshl_b32 s97, s97, 3
    s_add_u32 s97, s97, s96
    s_cmp_ge_u32 s97, 27
    s_cbranch_scc1 L_sdone
    s_and_b32 s97, s96, 3
    s_lshl_b32 s97, s97, 10
    s_lshr_b32 s96, s96, 2
    s_mul_i32 s96, s96, 24576
    s_add_u32 s96, s96, s97
    s_bfe_u32 s97, s99, 65539
    s_mul_i32 s97, s97, 12288
    s_add_u32 s96, s96, s97
    s_add_u32 s96, s96, 1507328
    s_add_u32 s66, s40, s96
    s_addc_u32 s67, s41, 0
L_sb:
    s_load_dword s44, s[66:67], 0 glc
    s_load_dword s46, s[66:67], 128 glc
    s_load_dword s48, s[66:67], 256 glc
    s_load_dword s50, s[66:67], 384 glc
    s_load_dword s52, s[66:67], 512 glc
    s_load_dword s54, s[66:67], 640 glc
    s_load_dword s56, s[66:67], 768 glc
    s_load_dword s58, s[66:67], 896 glc
    s_sub_u32 s79, s79, 1
    s_cbranch_scc1 L_sdone
    s_waitcnt lgkmcnt(0)
    s_cmp_lg_u32 s44, s77
    s_cbranch_scc1 L_sb
    s_cmp_lg_u32 s46, s77
    s_cbranch_scc1 L_sb
    s_cmp_lg_u32 s48, s77
    s_cbranch_scc1 L_sb
    s_cmp_lg_u32 s50, s77
    s_cbranch_scc1 L_sb
    s_cmp_lg_u32 s52, s77
    s_cbranch_scc1 L_sb
    s_cmp_lg_u32 s54, s77
    s_cbranch_scc1 L_sb
    s_cmp_lg_u32 s56, s77
    s_cbranch_scc1 L_sb
    s_cmp_lg_u32 s58, s77
    s_cbranch_scc1 L_sb
    ds_write_b32 v61, v5 offset:4632
L_sdone:
    s_endpgm
L_q_1_r:
    s_sleep 1
    s_sub_u32 s79, s79, 1
    s_cbranch_scc0 L_q_1
    s_mov_b32 s79, 0
    s_branch L_q_1_d
L_ref_2_r:
    s_waitcnt lgkmcnt(0)
    v_mov_b32 v6, s60
    v_mov_b32 v7, s77
    v_mov_b32 v8, s60
    v_mov_b32 v9, s77
    s_mov_b64 exec, 0xff
    buffer_store_dwordx4 v[6:9], v15, s[40:43], s65 offen offset:128 sc0 sc1
    s_mov_b64 exec, -1
    s_branch L_ref_2
L_ref_5_r:
    s_waitcnt lgkmcnt(0)
    v_mov_b32 v6, s60
    v_mov_b32 v7, s77
    v_mov_b32 v8, s60
    v_mov_b32 v9, s77
    s_mov_b64 exec, 0xff
    buffer_store_dwordx4 v[6:9], v15, s[40:43], s65 offen offset:256 sc0 sc1
    s_mov_b64 exec, -1
    s_branch L_ref_5
L_mlast_17_far:
    buffer_store_dwordx4 v[56:59], v15, s[40:43], s96 offen sc0 sc1
    s_branch L_mlast_17
L_q_19_r:
    s_sleep 1
    s_sub_u32 s79, s79, 1
    s_cbranch_scc0 L_q_19
    s_mov_b32 s79, 0
    s_branch L_q_19_d
L_ref_32_r:
    s_waitcnt lgkmcnt(0)
    v_mov_b32 v6, s60
    v_mov_b32 v7, s77
    v_mov_b32 v8, s60
    v_mov_b32 v9, s77
    s_mov_b64 exec, 0xff
    buffer_store_dwordx4 v[6:9], v15, s[40:43], s65 offen offset:384 sc0 sc1
    s_mov_b64 exec, -1
    s_branch L_ref_32
L_ref_57_r:
    s_waitcnt lgkmcnt(0)
    v_mov_b32 v6, s60
    v_mov_b32 v7, s77
    v_mov_b32 v8, s60
    v_mov_b32 v9, s77
    s_mov_b64 exec, 0xff
    buffer_store_dwordx4 v[6:9], v15, s[40:43], s65 offen offset:512 sc0 sc1
    s_mov_b64 exec, -1
    s_branch L_ref_57
L_ml_77_r:
    s_sleep 4
    buffer_load_dwordx4 v[52:55], v99, s[40:43], s94 offen sc1
    s_waitcnt vmcnt(0)
    s_sub_u32 s79, s79, 1
    s_cbranch_scc0 L_ml_77
    s_mov_b32 s79, 0
    s_branch L_ml_77_d
L_ref_83_r:
    s_waitcnt lgkmcnt(0)
    v_mov_b32 v6, s60
    v_mov_b32 v7, s77
    v_mov_b32 v8, s60
    v_mov_b32 v9, s77
    s_mov_b64 exec, 0xff
    buffer_store_dwordx4 v[6:9], v15, s[40:43], s65 offen offset:640 sc0 sc1
    s_mov_b64 exec, -1
    s_branch L_ref_83
L_mlast_91_far:
    buffer_store_dwordx4 v[56:59], v15, s[40:43], s96 offen sc0 sc1
    s_branch L_mlast_91
L_ref_109_r:
    s_waitcnt lgkmcnt(0)
    v_mov_b32 v6, s60
    v_mov_b32 v7, s77
    v_mov_b32 v8, s60
    v_mov_b32 v9, s77
    s_mov_b64 exec, 0xff
    buffer_store_dwordx4 v[6:9], v15, s[40:43], s65 offen offset:768 sc0 sc1
    s_mov_b64 exec, -1
    s_branch L_ref_109
L_ref_134_r:
    s_waitcnt lgkmcnt(0)
    v_mov_b32 v6, s60
    v_mov_b32 v7, s77
    v_mov_b32 v8, s60
    v_mov_b32 v9, s77
    s_mov_b64 exec, 0xff
    buffer_store_dwordx4 v[6:9], v15, s[40:43], s65 offen offset:896 sc0 sc1
    s_mov_b64 exec, -1
    s_branch L_ref_134
L_ml_152_r:
    s_sleep 4
    buffer_load_dwordx4 v[52:55], v0, s[40:43], s94 offen sc1
    s_waitcnt vmcnt(0)
    s_sub_u32 s79, s79, 1
    s_cbranch_scc0 L_ml_152
    s_mov_b32 s79, 0
    s_branch L_ml_152_d
L_ref_160_r:
    s_waitcnt lgkmcnt(0)
    v_mov_b32 v6, s60
    v_mov_b32 v7, s77
    v_mov_b32 v8, s60
    v_mov_b32 v9, s77
    s_mov_b64 exec, 0xff
    buffer_store_dwordx4 v[6:9], v15, s[40:43], s65 offen offset:1024 sc0 sc1
    s_mov_b64 exec, -1
    s_branch L_ref_160
L_olast_162_far:
    buffer_store_dwordx4 v[16:19], v63, s[40:43], s95 offen sc0 sc1
    s_branch L_olast_162_st
L_ref_186_r:
    s_waitcnt lgkmcnt(0)
    v_mov_b32 v6, s60
    v_mov_b32 v7, s77
    v_mov_b32 v8, s60
    v_mov_b32 v9, s77
    s_mov_b64 exec, 0xff
    buffer_store_dwordx4 v[6:9], v15, s[40:43], s65 offen offset:1152 sc0 sc1
    s_mov_b64 exec, -1
    s_branch L_ref_186
L_olast_224_far:
    buffer_store_dwordx4 v[16:19], v63, s[40:43], s95 offen sc0 sc1
    s_branch L_olast_224_st
L_aux:
    s_getreg_b32 s78, hwreg(HW_REG_XCC_ID, 0, 4)
    s_mov_b32 s54, 0x00500000
    s_mov_b32 s55, 0x20000
    s_mov_b32 s58, 0x0021c000
    s_mov_b32 s59, 0x20000
    s_mov_b32 s62, 0x0021c000
    s_mov_b32 s63, 0x20000
    s_mov_b32 s66, 0x0021c000
    s_mov_b32 s67, 0x20000
    s_mov_b32 s70, 0x00000a00
    s_mov_b32 s71, 0x20000
    v_and_b32 v68, 7, v1
    v_and_b32 v69, 1, v68
    v_lshlrev_b32 v69, 4, v69
    v_mov_b32 v70, 0xffff
    v_lshlrev_b32 v69, v69, v70
    v_lshrrev_b32 v70, 1, v68
    v_cmp_eq_u32 vcc, 0, v70
    s_nop 1
    v_cndmask_b32 v64, 0, v69, vcc
    v_cmp_eq_u32 vcc, 1, v70
    s_nop 1
    v_cndmask_b32 v65, 0, v69, vcc
    v_cmp_eq_u32 vcc, 2, v70
    s_nop 1
    v_cndmask_b32 v66, 0, v69, vcc
    v_cmp_eq_u32 vcc, 3, v70
    s_nop 1
    v_cndmask_b32 v67, 0, v69, vcc
    s_mov_b32 s88, 0xff00ff00
    s_mov_b32 s89, 0xff00ff00
    s_mov_b32 s92, 0x3acccccd
    s_mov_b32 s93, 0x3727c5ac
    s_lshl_b32 s7, s76, 8
    v_lshl_add_u32 v97, v6, 4, s7
    v_lshl_add_u32 v101, v7, 11, v97
    s_lshl_b32 s84, s6, 10
    s_add_u32 s84, s84, 65536
    s_lshl_b32 s85, s74, 13
    s_add_u32 s85, s85, 65536
    v_add_u32 v102, 2031616, v101
    v_bfe_u32 v103, v1, 3, 1
    v_lshlrev_b32 v103, 7, v103
    v_and_b32 v70, 22, v1
    v_or_b32 v103, v103, v70
    v_lshrrev_b32 v70, 5, v1
    v_lshl_or_b32 v103, v70, 3, v103
    s_lshl_b32 s7, s76, 5
    v_add_lshl_u32 v103, v103, s7, 1
    v_and_b32 v98, 3, v1
    v_lshlrev_b32 v98, 3, v98
    s_waitcnt lgkmcnt(0)
    s_mov_b64 s[52:53], s[16:17]
    s_mov_b64 s[56:57], s[20:21]
    s_mov_b64 s[60:61], s[22:23]
    s_mov_b64 s[64:65], s[24:25]
    s_mov_b64 s[68:69], s[26:27]
    s_mov_b64 s[40:41], s[30:31]
    s_load_dword s77, s[40:41], 0
    s_lshr_b32 s7, s73, 3
    s_and_b32 s39, s75, 3
    s_cbranch_scc0 L_role2
    s_sub_u32 s39, s75, 1
    s_lshl_b32 s39, s39, 2
    s_add_u32 s39, s39, s7
    s_cmp_lt_u32 s39, 10
    s_cselect_b32 s38, 1, 0
    s_branch L_role
L_role2:
    s_lshl_b32 s39, s7, 3
    s_add_u32 s39, s39, s72
    s_cmp_lt_u32 s39, 27
    s_cselect_b32 s38, 2, 0
    s_lshl_b32 s39, s39, 1
    s_lshr_b32 s7, s75, 2
    s_add_u32 s39, s39, s7
L_role:
    s_waitcnt vmcnt(10)
    v_lshlrev_b32 v44, 16, v8
    v_and_b32 v45, 0xffff0000, v8
    v_lshlrev_b32 v46, 16, v9
    v_and_b32 v47, 0xffff0000, v9
    v_lshlrev_b32 v48, 16, v10
    v_and_b32 v49, 0xffff0000, v10
    v_lshlrev_b32 v50, 16, v11
    v_and_b32 v51, 0xffff0000, v11
    v_lshlrev_b32 v52, 16, v12
    v_and_b32 v53, 0xffff0000, v12
    v_lshlrev_b32 v54, 16, v13
    v_and_b32 v55, 0xffff0000, v13
    v_lshlrev_b32 v56, 16, v14
    v_and_b32 v57, 0xffff0000, v14
    v_lshlrev_b32 v58, 16, v15
    v_and_b32 v59, 0xffff0000, v15
    v_lshlrev_b32 v60, 16, v16
    v_and_b32 v61, 0xffff0000, v16
    v_lshlrev_b32 v62, 16, v17
    v_and_b32 v63, 0xffff0000, v17
    v_pk_add_f32 v[8:9], v[44:45], v[46:47]
    v_pk_add_f32 v[8:9], v[8:9], v[48:49]
    v_pk_add_f32 v[8:9], v[8:9], v[50:51]
    v_pk_add_f32 v[8:9], v[8:9], v[52:53]
    v_pk_add_f32 v[8:9], v[8:9], v[54:55]
    v_pk_add_f32 v[8:9], v[8:9], v[56:57]
    v_pk_add_f32 v[8:9], v[8:9], v[58:59]
    v_pk_add_f32 v[8:9], v[8:9], v[60:61]
    v_pk_add_f32 v[8:9], v[8:9], v[62:63]
    v_add_f32 v8, v8, v9
    s_nop 1
    v_add_f32_dpp v8, v8, v8 row_ror:8 row_mask:0xf bank_mask:0xf
    s_nop 1
    v_add_f32_dpp v8, v8, v8 row_ror:4 row_mask:0xf bank_mask:0xf
    s_nop 1
    v_add_f32_dpp v8, v8, v8 row_ror:2 row_mask:0xf bank_mask:0xf
    s_nop 1
    v_add_f32_dpp v8, v8, v8 row_ror:1 row_mask:0xf bank_mask:0xf
    v_mov_b32 v71, v8
    s_nop 1
    v_permlane16_swap_b32 v8, v71
    v_add_f32 v8, v8, v71
    v_mul_f32 v8, s92, v8
    v_pk_add_f32 v[44:45], v[44:45], v[8:9] op_sel_hi:[1,0] neg_lo:[0,1] neg_hi:[0,1]
    v_pk_add_f32 v[46:47], v[46:47], v[8:9] op_sel_hi:[1,0] neg_lo:[0,1] neg_hi:[0,1]
    v_pk_add_f32 v[48:49], v[48:49], v[8:9] op_sel_hi:[1,0] neg_lo:[0,1] neg_hi:[0,1]
    v_pk_add_f32 v[50:51], v[50:51], v[8:9] op_sel_hi:[1,0] neg_lo:[0,1] neg_hi:[0,1]
    v_pk_add_f32 v[52:53], v[52:53], v[8:9] op_sel_hi:[1,0] neg_lo:[0,1] neg_hi:[0,1]
    v_pk_add_f32 v[54:55], v[54:55], v[8:9] op_sel_hi:[1,0] neg_lo:[0,1] neg_hi:[0,1]
    v_pk_add_f32 v[56:57], v[56:57], v[8:9] op_sel_hi:[1,0] neg_lo:[0,1] neg_hi:[0,1]
    v_pk_add_f32 v[58:59], v[58:59], v[8:9] op_sel_hi:[1,0] neg_lo:[0,1] neg_hi:[0,1]
    v_pk_add_f32 v[60:61], v[60:61], v[8:9] op_sel_hi:[1,0] neg_lo:[0,1] neg_hi:[0,1]
    v_pk_add_f32 v[62:63], v[62:63], v[8:9] op_sel_hi:[1,0] neg_lo:[0,1] neg_hi:[0,1]
    v_pk_mul_f32 v[10:11], v[44:45], v[44:45]
    v_pk_fma_f32 v[10:11], v[46:47], v[46:47], v[10:11]
    v_pk_fma_f32 v[10:11], v[48:49], v[48:49], v[10:11]
    v_pk_fma_f32 v[10:11], v[50:51], v[50:51], v[10:11]
    v_pk_fma_f32 v[10:11], v[52:53], v[52:53], v[10:11]
    v_pk_fma_f32 v[10:11], v[54:55], v[54:55], v[10:11]
    v_pk_fma_f32 v[10:11], v[56:57], v[56:57], v[10:11]
    v_pk_fma_f32 v[10:11], v[58:59], v[58:59], v[10:11]
    v_pk_fma_f32 v[10:11], v[60:61], v[60:61], v[10:11]
    v_pk_fma_f32 v[10:11], v[62:63], v[62:63], v[10:11]
    v_add_f32 v10, v10, v11
    s_nop 1
    v_add_f32_dpp v10, v10, v10 row_ror:8 row_mask:0xf bank_mask:0xf
    s_nop 1
    v_add_f32_dpp v10, v10, v10 row_ror:4 row_mask:0xf bank_mask:0xf
    s_nop 1
    v_add_f32_dpp v10, v10, v10 row_ror:2 row_mask:0xf bank_mask:0xf
    s_nop 1
    v_add_f32_dpp v10, v10, v10 row_ror:1 row_mask:0xf bank_mask:0xf
    v_mov_b32 v71, v10
    s_nop 1
    v_permlane16_swap_b32 v10, v71
    v_add_f32 v10, v10, v71
    v_mul_f32 v10, s92, v10
    v_cvt_pk_bf16_f32 v10, v10, v10
    v_and_b32 v10, 0xffff0000, v10
    v_cvt_pk_bf16_f32 v8, v8, v8
    v_and_b32 v8, 0xffff0000, v8
    v_add_f32 v10, s93, v10
    v_cvt_pk_bf16_f32 v10, v10, v10
    v_and_b32 v10, 0xffff0000, v10
    v_sqrt_f32 v10, v10
    s_nop 0
    v_cvt_pk_bf16_f32 v10, v10, v10
    v_and_b32 v10, 0xffff0000, v10
    v_rcp_f32 v10, v10
    v_readlane_b32 s80, v8, 0
    v_readlane_b32 s81, v8, 32
    v_readlane_b32 s82, v10, 0
    v_readlane_b32 s83, v10, 32
    v_mov_b32 v8, s80
    v_mov_b32 v9, s81
    v_mov_b32 v10, s82
    v_mov_b32 v11, s83
    v_cndmask_b32 v8, v8, v9, s[88:89]
    v_cndmask_b32 v10, v10, v11, s[88:89]
    s_waitcnt vmcnt(5)
    v_lshlrev_b32 v18, 16, v18
    v_sub_f32 v18, v18, v8
    v_lshlrev_b32 v19, 16, v19
    v_sub_f32 v19, v19, v8
    v_lshlrev_b32 v20, 16, v20
    v_sub_f32 v20, v20, v8
    v_lshlrev_b32 v21, 16, v21
    v_sub_f32 v21, v21, v8
    v_lshlrev_b32 v22, 16, v22
    v_sub_f32 v22, v22, v8
    v_cvt_pk_bf16_f32 v18, v18, v18
    v_and_b32 v18, 0xffff0000, v18
    v_cvt_pk_bf16_f32 v19, v19, v19
    v_and_b32 v19, 0xffff0000, v19
    v_cvt_pk_bf16_f32 v20, v20, v20
    v_and_b32 v20, 0xffff0000, v20
    v_cvt_pk_bf16_f32 v21, v21, v21
    v_and_b32 v21, 0xffff0000, v21
    v_cvt_pk_bf16_f32 v22, v22, v22
    v_and_b32 v22, 0xffff0000, v22
    v_mul_f32 v18, v18, v10
    v_cvt_pk_bf16_f32 v18, v18, v18
    v_mul_f32 v19, v19, v10
    v_cvt_pk_bf16_f32 v19, v19, v19
    v_mul_f32 v20, v20, v10
    v_cvt_pk_bf16_f32 v20, v20, v20
    v_mul_f32 v21, v21, v10
    v_cvt_pk_bf16_f32 v21, v21, v21
    v_mul_f32 v22, v22, v10
    v_cvt_pk_bf16_f32 v22, v22, v22
    v_and_b32 v44, v18, v64
    v_and_b32 v45, v18, v65
    v_and_b32 v46, v18, v66
    v_and_b32 v47, v18, v67
    v_and_b32 v48, v19, v64
    v_and_b32 v49, v19, v65
    v_and_b32 v50, v19, v66
    v_and_b32 v51, v19, v67
    s_waitcnt vmcnt(4)
    v_mfma_f32_16x16x32_bf16 v[72:75], v[24:27], v[44:47], 0
    v_and_b32 v52, v20, v64
    v_and_b32 v53, v20, v65
    v_and_b32 v54, v20, v66
    v_and_b32 v55, v20, v67
    s_waitcnt vmcnt(3)
    v_mfma_f32_16x16x32_bf16 v[72:75], v[28:31], v[48:51], v[72:75]
    v_and_b32 v56, v21, v64
    v_and_b32 v57, v21, v65
    v_and_b32 v58, v21, v66
    v_and_b32 v59, v21, v67
    s_waitcnt vmcnt(2)
    v_mfma_f32_16x16x32_bf16 v[72:75], v[32:35], v[52:55], v[72:75]
    v_and_b32 v60, v22, v64
    v_and_b32 v61, v22, v65
    v_and_b32 v62, v22, v66
    v_and_b32 v63, v22, v67
    s_waitcnt vmcnt(1)
    v_mfma_f32_16x16x32_bf16 v[72:75], v[36:39], v[56:59], v[72:75]
    s_waitcnt vmcnt(0)
    v_mfma_f32_16x16x32_bf16 v[72:75], v[40:43], v[60:63], v[72:75]
    v_mov_b32 v61, 0
    s_waitcnt lgkmcnt(0)
    s_mul_i32 s77, s77, 1664525
    s_add_u32 s77, s77, 1013904223
    s_add_u32 s83, s77, s78
    s_add_u32 s83, s83, 1
    s_nop 1
    ds_write_b128 v96, v[72:75] offset:0
    v_lshrrev_b32 v99, v98, s83
    v_bfe_u32 v104, v99, 0, 2
    v_bfe_u32 v105, v99, 2, 2
    v_bfe_u32 v106, v99, 4, 2
    v_bfe_u32 v107, v99, 6, 2
L_qred_225:
    ds_read_b128 v[76:79], v97 offset:0
    ds_read_b128 v[80:83], v97 offset:1024
    ds_read_b128 v[84:87], v97 offset:2048
    ds_read_b128 v[88:91], v97 offset:3072
    s_waitcnt lgkmcnt(0)
    v_pk_add_f32 v[76:77], v[76:77], v[80:81]
    v_pk_add_f32 v[78:79], v[78:79], v[82:83]
    v_pk_add_f32 v[84:85], v[84:85], v[88:89]
    v_pk_add_f32 v[86:87], v[86:87], v[90:91]
    v_pk_add_f32 v[76:77], v[76:77], v[84:85]
    v_pk_add_f32 v[78:79], v[78:79], v[86:87]
    v_pk_add_f32 v[80:81], v[76:77], v[78:79]
    v_cmp_u_f32 vcc, v80, v81
    s_nop 0
    s_cbranch_vccnz L_qred_225_r
L_qred_225_d:
    v_bfi_b32 v76, 3, v104, v76
    v_bfi_b32 v77, 3, v105, v77
    v_bfi_b32 v78, 3, v106, v78
    v_bfi_b32 v79, 3, v107, v79
    s_mov_b64 exec, 0xffff
    buffer_store_dwordx4 v[76:79], v97, s[40:43], s84 offen
    s_mov_b64 exec, -1
    s_add_u32 s84, s84, 2031616
    s_mov_b32 s87, 0
    s_sleep 24
    v_mov_b32 v15, v101
    s_mov_b32 s7, s83
L_qg_226:
    buffer_load_dwordx4 v[80:83], v15, s[40:43], s85 offen offset:0 sc1
    buffer_load_dwordx4 v[84:87], v15, s[40:43], s85 offen offset:1024 sc1
    s_waitcnt vmcnt(0)
    v_xor_b32 v80, v80, v104
    v_xor_b32 v81, v81, v105
    v_xor_b32 v82, v82, v106
    v_xor_b32 v83, v83, v107
    v_xor_b32 v84, v84, v104
    v_xor_b32 v85, v85, v105
    v_xor_b32 v86, v86, v106
    v_xor_b32 v87, v87, v107
    v_or3_b32 v88, v80, v81, v82
    v_or3_b32 v88, v88, v83, v84
    v_or3_b32 v88, v88, v85, v86
    v_or_b32 v88, v88, v87
    v_and_b32 v88, 3, v88
    v_cmp_ne_u32 vcc, 0, v88
    s_nop 0
    s_cbranch_vccnz L_qg_226_r
L_qg_226_d:
    s_cmp_lg_u32 s7, s83
    s_cselect_b32 s7, 1, 0
    v_mov_b32 v8, s7
    ds_write_b32 v61, v8 offset:4624
    v_pk_add_f32 v[80:81], v[80:81], v[84:85]
    v_pk_add_f32 v[82:83], v[82:83], v[86:87]
    s_nop 0
    v_permlane32_swap_b32 v80, v81
    v_permlane32_swap_b32 v82, v83
    v_add_f32 v80, v80, v81
    v_add_f32 v82, v82, v83
    s_nop 1
    v_permlane16_swap_b32 v80, v82
    v_add_f32 v80, v80, v82
    s_nop 1
    v_mov_b32_dpp v81, v80 quad_perm:[1,1,3,3] row_mask:0xf bank_mask:0xf
    v_mov_b32_dpp v82, v80 quad_perm:[0,0,2,2] row_mask:0xf bank_mask:0xf
    v_cvt_pk_bf16_f32 v80, v82, v81
    v_min_u32 v80, -2, v80
    ds_write_b32 v103, v80 offset:4096
    s_mov_b32 s84, s38
    s_mov_b32 s85, s39
    s_cmp_lg_u32 s76, 0
    s_cbranch_scc1 L_noclr
    v_lshlrev_b32 v8, 4, v1
    s_lshl_b32 s7, s6, 9
    s_add_u32 s7, s7, 720896
    s_mov_b32 exec_hi, 0
    buffer_load_dwordx4 v[116:119], v8, s[40:43], s7 offen
    s_mov_b64 exec, -1
    s_cmp_lg_u32 s84, 2
    s_cbranch_scc1 L_clr3
    s_mul_i32 s7, s85, 2560
    s_add_u32 s7, s7, 917504
    buffer_store_dwordx4 v[112:115], v8, s[40:43], s7 offen offset:0 sc0 sc1
    buffer_store_dwordx4 v[112:115], v8, s[40:43], s7 offen offset:1024 sc0 sc1
    s_mov_b32 exec_hi, 0
    buffer_store_dwordx4 v[112:115], v8, s[40:43], s7 offen offset:2048 sc0 sc1
    v_mov_b32 v120, s77
    v_mov_b32 v121, s77
    v_mov_b32 v122, s77
    v_mov_b32 v123, s77
    s_lshl_b32 s7, s85, 7
    s_add_u32 s7, s7, 1572864
    s_mov_b64 exec, 0xff
    s_waitcnt vmcnt(0)
    buffer_store_dwordx4 v[120:123], v8, s[40:43], s7 offen sc0 sc1
    s_mov_b64 exec, -1
L_clr3:
    s_waitcnt vmcnt(0)
L_noclr:
    s_mov_b32 s90, 0x05040100
    s_mov_b32 s91, 0x07060302
    s_mov_b32 s98, 0
    s_mov_b64 s[30:31], -1
    v_and_b32 v8, 1, v1
    v_mul_u32_u24 v8, 0xaaaa, v8
    v_or_b32 v60, 0x4444, v8
    s_cmp_eq_u32 s84, 2
    s_cbranch_scc1 L_ffn
    s_cmp_eq_u32 s84, 1
    s_cbranch_scc1 L_wo
    s_cmp_lg_u32 s73, 27
    s_cbranch_scc1 L_done
    s_cmp_lg_u32 s76, 1
    s_cbranch_scc1 L_done
    v_and_b32 v2, 31, v1
    v_lshlrev_b32 v2, 9, v2
    s_lshl_b32 s94, s72, 14
    s_add_u32 s94, s94, 720896
    v_bfe_u32 v3, v1, 3, 2
    v_lshlrev_b32 v3, 10, v3
    v_lshrrev_b32 v9, 5, v1
    v_mul_u32_u24 v9, 24576, v9
    v_add_u32 v3, v3, v9
    v_and_b32 v9, 7, v1
    v_lshl_add_u32 v3, v9, 4, v3
    s_lshl_b32 s80, s72, 7
    s_add_u32 s80, s80, 1507328
    s_lshl_b32 s81, s72, 7
    s_add_u32 s81, s81, 1519616
    v_mov_b32 v12, s77
    v_mov_b32 v13, s77
    v_mov_b32 v14, s77
    v_mov_b32 v15, s77
L_lds_227:
    ds_read_b32 v8, v61 offset:4612
    s_waitcnt lgkmcnt(0)
    v_cmp_ne_u32 vcc, 3, v8
    s_nop 0
    s_cbranch_vccnz L_lds_227_r
L_lds_227_d:
    s_mov_b32 exec_hi, 0
L_bw_228:
    buffer_load_dword v9, v2, s[40:43], s94 offen sc1
    s_sub_u32 s79, s79, 1
    s_cbranch_scc1 L_bw_228_x
L_bw_228_y:
    s_waitcnt vmcnt(0)
    v_xor_b32 v9, s77, v9
    v_and_b32 v9, 0xfff, v9
    v_cmp_ne_u32 vcc, 0, v9
    s_nop 0
    s_and_b64 vcc, vcc, s[30:31]
    s_cbranch_vccnz L_bw_228
    s_sleep 1
    s_mov_b64 exec, -1
    buffer_store_dwordx4 v[12:15], v3, s[40:43], s80 offen sc0 sc1
    buffer_store_dwordx4 v[12:15], v3, s[40:43], s81 offen sc0 sc1
L_done:
    s_endpgm
L_qred_225_r:
    s_sub_u32 s79, s79, 1
    s_cbranch_scc0 L_qred_225
    s_mov_b32 s79, 0
    s_branch L_qred_225_d
L_qg_226_r:
    s_sleep 2
    s_add_u32 s87, s87, 1
    s_cmp_lg_u32 s87, 6
    s_cbranch_scc1 L_qg_226_s
    v_lshrrev_b32 v99, v98, s77
    v_bfe_u32 v104, v99, 0, 2
    v_bfe_u32 v105, v99, 2, 2
    v_bfe_u32 v106, v99, 4, 2
    v_bfe_u32 v107, v99, 6, 2
    v_bfi_b32 v76, 3, v104, v76
    v_bfi_b32 v77, 3, v105, v77
    v_bfi_b32 v78, 3, v106, v78
    v_bfi_b32 v79, 3, v107, v79
    s_mov_b64 exec, 0xffff
    buffer_store_dwordx4 v[76:79], v97, s[40:43], s84 offen sc0 sc1
    s_mov_b64 exec, -1
L_qg_226_s:
    s_cmp_gt_u32 s87, 6
    s_cselect_b32 s7, s87, 0
    s_bitcmp1_b32 s7, 0
    s_cselect_b64 vcc, -1, 0
    s_cselect_b32 s7, s77, s83
    v_cndmask_b32 v15, v101, v102, vcc
    v_lshrrev_b32 v99, v98, s7
    v_bfe_u32 v104, v99, 0, 2
    v_bfe_u32 v105, v99, 2, 2
    v_bfe_u32 v106, v99, 4, 2
    v_bfe_u32 v107, v99, 6, 2
    s_sub_u32 s79, s79, 1
    s_cbranch_scc0 L_qg_226
    s_mov_b32 s79, 0
    s_branch L_qg_226_d
L_lds_227_r:
    s_sleep 4
    s_sub_u32 s79, s79, 1
    s_cbranch_scc0 L_lds_227
    s_mov_b32 s79, 0
    s_branch L_lds_227_d
L_bw_228_x:
    s_mov_b32 s79, 0
    s_mov_b64 s[30:31], 0
    s_branch L_bw_228_y
L_wo:
    s_lshl_b32 s80, s72, 2
    s_add_u32 s80, s80, s76
    s_lshl_b32 s7, s80, 7
    v_lshrrev_b32 v8, 5, v1
    v_lshl_add_u32 v8, v8, 4, s7
    v_bfe_u32 v9, v1, 4, 1
    v_lshl_add_u32 v8, v9, 1, v8
    v_mul_u32_u24 v8, 1280, v8
    s_lshl_b32 s7, s85, 7
    v_lshl_add_u32 v9, v6, 3, s7
    v_add_u32 v2, v8, v9
    s_mov_b32 s7, 0
    buffer_load_dwordx2 v[64:65], v2, s[52:55], s7 offen nt
    s_mov_b32 s7, 10240
    buffer_load_dwordx2 v[66:67], v2, s[52:55], s7 offen nt
    s_waitcnt vmcnt(1)
    s_mov_b32 s7, 1280
    buffer_load_dwordx2 v[68:69], v2, s[52:55], s7 offen nt
    s_waitcnt vmcnt(1)
    s_mov_b32 s7, 11520
    buffer_load_dwordx2 v[70:71], v2, s[52:55], s7 offen nt
    s_waitcnt vmcnt(1)
    s_mov_b32 s7, 81920
    buffer_load_dwordx2 v[72:73], v2, s[52:55], s7 offen nt
    s_waitcnt vmcnt(1)
    v_perm_b32 v128, v66, v64, s90
    v_perm_b32 v129, v66, v64, s91
    v_perm_b32 v136, v67, v65, s90
    v_perm_b32 v137, v67, v65, s91
    v_perm_b32 v130, v70, v68, s90
    v_perm_b32 v131, v70, v68, s91
    v_perm_b32 v138, v71, v69, s90
    v_perm_b32 v139, v71, v69, s91
    s_mov_b32 s7, 92160
    buffer_load_dwordx2 v[74:75], v2, s[52:55], s7 offen nt
    s_waitcnt vmcnt(1)
    s_mov_b32 s7, 83200
    buffer_load_dwordx2 v[76:77], v2, s[52:55], s7 offen nt
    s_waitcnt vmcnt(1)
    s_mov_b32 s7, 93440
    buffer_load_dwordx2 v[78:79], v2, s[52:55], s7 offen nt
    s_waitcnt vmcnt(1)
    s_mov_b32 s7, 5120
    buffer_load_dwordx2 v[64:65], v2, s[52:55], s7 offen nt
    s_waitcnt vmcnt(1)
    v_perm_b32 v132, v74, v72, s90
    v_perm_b32 v133, v74, v72, s91
    v_perm_b32 v140, v75, v73, s90
    v_perm_b32 v141, v75, v73, s91
    v_perm_b32 v134, v78, v76, s90
    v_perm_b32 v135, v78, v76, s91
    v_perm_b32 v142, v79, v77, s90
    v_perm_b32 v143, v79, v77, s91
    s_mov_b32 s7, 15360
    buffer_load_dwordx2 v[66:67], v2, s[52:55], s7 offen nt
    s_waitcnt vmcnt(1)
    s_mov_b32 s7, 6400
    buffer_load_dwordx2 v[68:69], v2, s[52:55], s7 offen nt
    s_waitcnt vmcnt(1)
    s_mov_b32 s7, 16640
    buffer_load_dwordx2 v[70:71], v2, s[52:55], s7 offen nt
    s_waitcnt vmcnt(1)
    s_mov_b32 s7, 87040
    buffer_load_dwordx2 v[72:73], v2, s[52:55], s7 offen nt
    s_waitcnt vmcnt(1)
    v_perm_b32 v144, v66, v64, s90
    v_perm_b32 v145, v66, v64, s91
    v_perm_b32 v152, v67, v65, s90
    v_perm_b32 v153, v67, v65, s91
    v_perm_b32 v146, v70, v68, s90
    v_perm_b32 v147, v70, v68, s91
    v_perm_b32 v154, v71, v69, s90
    v_perm_b32 v155, v71, v69, s91
    s_mov_b32 s7, 97280
    buffer_load_dwordx2 v[74:75], v2, s[52:55], s7 offen nt
    s_waitcnt vmcnt(1)
    s_mov_b32 s7, 88320
    buffer_load_dwordx2 v[76:77], v2, s[52:55], s7 offen nt
    s_waitcnt vmcnt(1)
    s_mov_b32 s7, 98560
    buffer_load_dwordx2 v[78:79], v2, s[52:55], s7 offen nt
    s_waitcnt vmcnt(1)
    s_mov_b32 s7, 40960
    buffer_load_dwordx2 v[64:65], v2, s[52:55], s7 offen nt
    s_waitcnt vmcnt(1)
    v_perm_b32 v148, v74, v72, s90
    v_perm_b32 v149, v74, v72, s91
    v_perm_b32 v156, v75, v73, s90
    v_perm_b32 v157, v75, v73, s91
    v_perm_b32 v150, v78, v76, s90
    v_perm_b32 v151, v78, v76, s91
    v_perm_b32 v158, v79, v77, s90
    v_perm_b32 v159, v79, v77, s91
    s_mov_b32 s7, 51200
    buffer_load_dwordx2 v[66:67], v2, s[52:55], s7 offen nt
    s_waitcnt vmcnt(1)
    s_mov_b32 s7, 42240
    buffer_load_dwordx2 v[68:69], v2, s[52:55], s7 offen nt
    s_waitcnt vmcnt(1)
    s_mov_b32 s7, 52480
    buffer_load_dwordx2 v[70:71], v2, s[52:55], s7 offen nt
    s_waitcnt vmcnt(1)
    s_mov_b32 s7, 122880
    buffer_load_dwordx2 v[72:73], v2, s[52:55], s7 offen nt
    s_waitcnt vmcnt(1)
    v_perm_b32 v160, v66, v64, s90
    v_perm_b32 v161, v66, v64, s91
    v_perm_b32 v168, v67, v65, s90
    v_perm_b32 v169, v67, v65, s91
    v_perm_b32 v162, v70, v68, s90
    v_perm_b32 v163, v70, v68, s91
    v_perm_b32 v170, v71, v69, s90
    v_perm_b32 v171, v71, v69, s91
    s_mov_b32 s7, 133120
    buffer_load_dwordx2 v[74:75], v2, s[52:55], s7 offen nt
    s_waitcnt vmcnt(1)
    s_mov_b32 s7, 124160
    buffer_load_dwordx2 v[76:77], v2, s[52:55], s7 offen nt
    s_waitcnt vmcnt(1)
    s_mov_b32 s7, 134400
    buffer_load_dwordx2 v[78:79], v2, s[52:55], s7 offen nt
    s_waitcnt vmcnt(1)
    s_mov_b32 s7, 46080
    buffer_load_dwordx2 v[64:65], v2, s[52:55], s7 offen nt
    s_waitcnt vmcnt(1)
    v_perm_b32 v164, v74, v72, s90
    v_perm_b32 v165, v74, v72, s91
    v_perm_b32 v172, v75, v73, s90
    v_perm_b32 v173, v75, v73, s91
    v_perm_b32 v166, v78, v76, s90
    v_perm_b32 v167, v78, v76, s91
    v_perm_b32 v174, v79, v77, s90
    v_perm_b32 v175, v79, v77, s91
    s_mov_b32 s7, 56320
    buffer_load_dwordx2 v[66:67], v2, s[52:55], s7 offen nt
    s_waitcnt vmcnt(1)
    s_mov_b32 s7, 47360
    buffer_load_dwordx2 v[68:69], v2, s[52:55], s7 offen nt
    s_waitcnt vmcnt(1)
    s_mov_b32 s7, 57600
    buffer_load_dwordx2 v[70:71], v2, s[52:55], s7 offen nt
    s_waitcnt vmcnt(1)
    s_mov_b32 s7, 128000
    buffer_load_dwordx2 v[72:73], v2, s[52:55], s7 offen nt
    s_waitcnt vmcnt(1)
    v_perm_b32 v176, v66, v64, s90
    v_perm_b32 v177, v66, v64, s91
    v_perm_b32 v184, v67, v65, s90
    v_perm_b32 v185, v67, v65, s91
    v_perm_b32 v178, v70, v68, s90
    v_perm_b32 v179, v70, v68, s91
    v_perm_b32 v186, v71, v69, s90
    v_perm_b32 v187, v71, v69, s91
    s_mov_b32 s7, 138240
    buffer_load_dwordx2 v[74:75], v2, s[52:55], s7 offen nt
    s_waitcnt vmcnt(1)
    s_mov_b32 s7, 129280
    buffer_load_dwordx2 v[76:77], v2, s[52:55], s7 offen nt
    s_waitcnt vmcnt(1)
    s_mov_b32 s7, 139520
    buffer_load_dwordx2 v[78:79], v2, s[52:55], s7 offen nt
    s_waitcnt vmcnt(1)
    s_waitcnt vmcnt(0)
    v_perm_b32 v180, v74, v72, s90
    v_perm_b32 v181, v74, v72, s91
    v_perm_b32 v188, v75, v73, s90
    v_perm_b32 v189, v75, v73, s91
    v_perm_b32 v182, v78, v76, s90
    v_perm_b32 v183, v78, v76, s91
    v_perm_b32 v190, v79, v77, s90
    v_perm_b32 v191, v79, v77, s91
    v_and_b32 v58, 3, v1
    v_mul_u32_u24 v58, 7, v58
    v_lshrrev_b32 v58, v58, s77
    v_and_b32 v58, 0xffe, v58
    v_and_or_b32 v58, s77, 1, v58
    s_movk_i32 s97, 0xfff
    s_lshl_b32 s94, s80, 12
    s_add_u32 s94, s94, 589824
    v_lshlrev_b32 v59, 4, v6
    v_lshl_or_b32 v2, v7, 10, v59
    v_add_u32 v5, 5120, v59
    s_lshl_b32 s7, s76, 8
    v_add_u32 v3, s7, v5
    s_mul_i32 s95, s72, 2560
    s_lshl_b32 s7, s85, 8
    s_add_u32 s95, s95, s7
    s_add_u32 s95, s95, 1310720
L_lds_229:
    ds_read_b32 v8, v61 offset:4640
    s_waitcnt lgkmcnt(0)
    v_cmp_ne_u32 vcc, 1, v8
    s_nop 0
    s_cbranch_vccnz L_lds_229_r
L_lds_229_d:
L_wo_b:
    v_mov_b64 v[96:97], 0
    v_mov_b64 v[98:99], 0
    v_mov_b64 v[100:101], 0
    v_mov_b64 v[102:103], 0
L_h1_230:
    buffer_load_dwordx4 v[64:67], v2, s[40:43], s94 offen offset:0 sc1
    buffer_load_dwordx4 v[68:71], v2, s[40:43], s94 offen offset:512 sc1
    buffer_load_dwordx4 v[72:75], v2, s[40:43], s94 offen offset:256 sc1
    buffer_load_dwordx4 v[76:79], v2, s[40:43], s94 offen offset:768 sc1
    s_sub_u32 s79, s79, 1
    s_cbranch_scc1 L_h1_230_x
L_h1_230_y:
    s_waitcnt vmcnt(2)
    v_xor_b32 v64, v64, v58
    v_xor_b32 v68, v68, v58
    v_or_b32 v80, v64, v68
    v_pk_add_f32 v[64:65], v[64:65], v[68:69]
    v_pk_add_f32 v[66:67], v[66:67], v[70:71]
    s_waitcnt vmcnt(1)
    v_xor_b32 v72, v72, v58
    s_waitcnt vmcnt(0)
    v_xor_b32 v76, v76, v58
    v_or3_b32 v80, v80, v72, v76
    v_and_b32 v80, 0xfff, v80
    v_cmp_ne_u32 vcc, 0, v80
    v_pk_add_f32 v[68:69], v[72:73], v[76:77]
    v_pk_add_f32 v[70:71], v[74:75], v[78:79]
    s_and_b64 vcc, vcc, s[30:31]
    s_wqm_b64 exec, vcc
    s_cbranch_scc1 L_h1_230
    s_mov_b64 exec, -1
    v_permlane32_swap_b32 v64, v68
    v_permlane32_swap_b32 v65, v69
    v_permlane32_swap_b32 v66, v70
    v_permlane32_swap_b32 v67, v71
    v_pk_add_f32 v[64:65], v[64:65], v[68:69]
    v_pk_add_f32 v[66:67], v[66:67], v[70:71]
    s_nop 1
    v_permlane16_swap_b32 v64, v66
    v_permlane16_swap_b32 v65, v67
    v_pk_add_f32 v[64:65], v[64:65], v[66:67]
    v_cvt_pk_bf16_f32 v72, v64, v65
    s_nop 1
    v_mov_b32_dpp v80, v72 row_newbcast:0 row_mask:0xf bank_mask:0xf
    v_mov_b32_dpp v81, v72 row_newbcast:1 row_mask:0xf bank_mask:0xf
    v_mov_b32_dpp v82, v72 row_newbcast:2 row_mask:0xf bank_mask:0xf
    v_mov_b32_dpp v83, v72 row_newbcast:3 row_mask:0xf bank_mask:0xf
    v_mov_b32_dpp v84, v72 row_newbcast:4 row_mask:0xf bank_mask:0xf
    v_mov_b32_dpp v85, v72 row_newbcast:5 row_mask:0xf bank_mask:0xf
    v_smfmac_f32_16x16x64_bf16 v[96:99], v[80:83], v[128:135], v60
    v_mov_b32_dpp v86, v72 row_newbcast:6 row_mask:0xf bank_mask:0xf
    v_mov_b32_dpp v87, v72 row_newbcast:7 row_mask:0xf bank_mask:0xf
    v_smfmac_f32_16x16x64_bf16 v[100:103], v[80:83], v[136:143], v60
    v_mov_b32_dpp v88, v72 row_newbcast:8 row_mask:0xf bank_mask:0xf
    v_mov_b32_dpp v89, v72 row_newbcast:9 row_mask:0xf bank_mask:0xf
    v_smfmac_f32_16x16x64_bf16 v[96:99], v[84:87], v[144:151], v60
    v_mov_b32_dpp v90, v72 row_newbcast:10 row_mask:0xf bank_mask:0xf
    v_mov_b32_dpp v91, v72 row_newbcast:11 row_mask:0xf bank_mask:0xf
    v_smfmac_f32_16x16x64_bf16 v[100:103], v[84:87], v[152:159], v60
    v_mov_b32_dpp v92, v72 row_newbcast:12 row_mask:0xf bank_mask:0xf
    v_mov_b32_dpp v93, v72 row_newbcast:13 row_mask:0xf bank_mask:0xf
    v_smfmac_f32_16x16x64_bf16 v[96:99], v[88:91], v[160:167], v60
    v_mov_b32_dpp v94, v72 row_newbcast:14 row_mask:0xf bank_mask:0xf
    v_mov_b32_dpp v95, v72 row_newbcast:15 row_mask:0xf bank_mask:0xf
    v_smfmac_f32_16x16x64_bf16 v[100:103], v[88:91], v[168:175], v60
    s_nop 0
    v_smfmac_f32_16x16x64_bf16 v[96:99], v[92:95], v[176:183], v60
    v_smfmac_f32_16x16x64_bf16 v[100:103], v[92:95], v[184:191], v60
    s_cmp_lg_u32 s76, 0
    s_mov_b64 exec, 0xffff
    s_nop 4
    ds_write_b64 v3, v[96:97]
    ds_write_b64 v3, v[100:101] offset:8
    s_cbranch_scc1 L_wo_next
L_yr_231:
    ds_read_b128 v[64:67], v5 offset:0
    ds_read_b128 v[68:71], v5 offset:256
    ds_read_b128 v[72:75], v5 offset:512
    ds_read_b128 v[76:79], v5 offset:768
    s_sub_u32 s79, s79, 1
    s_cbranch_scc1 L_yr_231_x
L_yr_231_y:
    s_waitcnt lgkmcnt(2)
    v_pk_add_f32 v[64:65], v[64:65], v[68:69]
    v_pk_add_f32 v[66:67], v[66:67], v[70:71]
    s_waitcnt lgkmcnt(1)
    v_pk_add_f32 v[64:65], v[64:65], v[72:73]
    v_pk_add_f32 v[66:67], v[66:67], v[74:75]
    s_waitcnt lgkmcnt(0)
    v_pk_add_f32 v[64:65], v[64:65], v[76:77]
    v_pk_add_f32 v[66:67], v[66:67], v[78:79]
    v_pk_add_f32 v[68:69], v[64:65], v[66:67]
    v_cmp_u_f32 vcc, v68, v69
    v_bfi_b32 v64, s97, v58, v64
    s_and_b64 vcc, vcc, s[30:31]
    s_cbranch_vccnz L_yr_231
    buffer_store_dwordx4 v[64:67], v59, s[40:43], s95 offen sc0 sc1
L_wo_next:
    s_mov_b64 exec, -1
    s_cmp_lg_u32 s98, 0
    s_cbranch_scc1 L_wo_end
    s_add_u32 s94, s94, 0x20000
    s_add_u32 s95, s95, 20480
    v_add_u32 v3, 1024, v3
    v_add_u32 v5, 1024, v5
    s_mov_b32 s98, 1
    s_waitcnt vmcnt(0)
L_lds_232:
    ds_read_b32 v8, v61 offset:4612
    s_waitcnt lgkmcnt(0)
    v_cmp_ne_u32 vcc, 3, v8
    s_nop 0
    s_cbranch_vccnz L_lds_232_r
L_lds_232_d:
    s_branch L_wo_b
L_wo_end:
    s_endpgm
L_lds_229_r:
    s_sleep 8
    s_sub_u32 s79, s79, 1
    s_cbranch_scc0 L_lds_229
    s_mov_b32 s79, 0
    s_branch L_lds_229_d
L_h1_230_x:
    s_mov_b32 s79, 0
    s_mov_b64 s[30:31], 0
    s_branch L_h1_230_y
L_yr_231_x:
    s_mov_b32 s79, 0
    s_mov_b64 s[30:31], 0
    s_branch L_yr_231_y
L_lds_232_r:
    s_sleep 2
    s_sub_u32 s79, s79, 1
    s_cbranch_scc0 L_lds_232
    s_mov_b32 s79, 0
    s_branch L_lds_232_d
L_ffn:
    s_lshl_b32 s7, s85, 5
    v_lshl_add_u32 v8, v7, 2, s7
    v_mul_u32_u24 v8, 1280, v8
    s_lshl_b32 s7, s76, 8
    v_lshl_add_u32 v9, v6, 4, s7
    v_add_u32 v49, v8, v9
    s_cmp_lg_u32 s76, 0
    s_cbranch_scc1 L_dn2
    s_mov_b32 s7, 1024
    buffer_load_dwordx4 v[64:67], v49, s[64:67], s7 offen nt
    s_mov_b32 s7, 2304
    buffer_load_dwordx4 v[68:71], v49, s[64:67], s7 offen nt
    s_waitcnt vmcnt(1)
    s_mov_b32 s7, 3584
    buffer_load_dwordx4 v[72:75], v49, s[64:67], s7 offen nt
    s_waitcnt vmcnt(1)
    v_perm_b32 v224, v68, v64, s90
    v_perm_b32 v225, v68, v64, s91
    v_perm_b32 v232, v69, v65, s90
    v_perm_b32 v233, v69, v65, s91
    v_perm_b32 v240, v70, v66, s90
    v_perm_b32 v241, v70, v66, s91
    v_perm_b32 v248, v71, v67, s90
    v_perm_b32 v249, v71, v67, s91
    s_mov_b32 s7, 4864
    buffer_load_dwordx4 v[76:79], v49, s[64:67], s7 offen nt
    s_waitcnt vmcnt(1)
    s_mov_b32 s7, 21504
    buffer_load_dwordx4 v[64:67], v49, s[64:67], s7 offen nt
    s_waitcnt vmcnt(1)
    v_perm_b32 v226, v76, v72, s90
    v_perm_b32 v227, v76, v72, s91
    v_perm_b32 v234, v77, v73, s90
    v_perm_b32 v235, v77, v73, s91
    v_perm_b32 v242, v78, v74, s90
    v_perm_b32 v243, v78, v74, s91
    v_perm_b32 v250, v79, v75, s90
    v_perm_b32 v251, v79, v75, s91
    s_mov_b32 s7, 22784
    buffer_load_dwordx4 v[68:71], v49, s[64:67], s7 offen nt
    s_waitcnt vmcnt(1)
    s_mov_b32 s7, 24064
    buffer_load_dwordx4 v[72:75], v49, s[64:67], s7 offen nt
    s_waitcnt vmcnt(1)
    v_perm_b32 v228, v68, v64, s90
    v_perm_b32 v229, v68, v64, s91
    v_perm_b32 v236, v69, v65, s90
    v_perm_b32 v237, v69, v65, s91
    v_perm_b32 v244, v70, v66, s90
    v_perm_b32 v245, v70, v66, s91
    v_perm_b32 v252, v71, v67, s90
    v_perm_b32 v253, v71, v67, s91
    s_mov_b32 s7, 25344
    buffer_load_dwordx4 v[76:79], v49, s[64:67], s7 offen nt
    s_waitcnt vmcnt(1)
    s_waitcnt vmcnt(0)
    v_perm_b32 v230, v76, v72, s90
    v_perm_b32 v231, v76, v72, s91
    v_perm_b32 v238, v77, v73, s90
    v_perm_b32 v239, v77, v73, s91
    v_perm_b32 v246, v78, v74, s90
    v_perm_b32 v247, v78, v74, s91
    v_perm_b32 v254, v79, v75, s90
    v_perm_b32 v255, v79, v75, s91
L_dn2:
    s_mul_i32 s7, s76, 160
    v_lshrrev_b32 v10, 5, v1
    v_mul_u32_u24 v8, 40, v10
    v_bfe_u32 v9, v1, 4, 1
    v_lshl_add_u32 v8, v9, 2, v8
    v_add_u32 v8, s7, v8
    v_mul_u32_u24 v8, 3456, v8
    s_lshl_b32 s7, s85, 6
    v_lshl_add_u32 v9, v6, 2, s7
    v_add_u32 v2, v8, v9
    s_mov_b32 s7, 0
    buffer_load_dword v64, v2, s[56:59], s7 offen offset:0 nt
    buffer_load_dword v65, v2, s[56:59], s7 offen offset:3456 nt
    s_mov_b32 s7, 6912
    buffer_load_dword v66, v2, s[56:59], s7 offen offset:0 nt
    buffer_load_dword v67, v2, s[56:59], s7 offen offset:3456 nt
    s_waitcnt vmcnt(3)
    s_mov_b32 s7, 276480
    buffer_load_dword v68, v2, s[56:59], s7 offen offset:0 nt
    s_waitcnt vmcnt(3)
    buffer_load_dword v69, v2, s[56:59], s7 offen offset:3456 nt
    s_waitcnt vmcnt(3)
    s_mov_b32 s7, 283392
    buffer_load_dword v70, v2, s[56:59], s7 offen offset:0 nt
    s_waitcnt vmcnt(3)
    buffer_load_dword v71, v2, s[56:59], s7 offen offset:3456 nt
    s_waitcnt vmcnt(3)
    s_mov_b32 s7, 27648
    buffer_load_dword v72, v2, s[56:59], s7 offen offset:0 nt
    s_waitcnt vmcnt(3)
    buffer_load_dword v73, v2, s[56:59], s7 offen offset:3456 nt
    s_waitcnt vmcnt(3)
    s_mov_b32 s7, 34560
    buffer_load_dword v74, v2, s[56:59], s7 offen offset:0 nt
    s_waitcnt vmcnt(3)
    v_perm_b32 v112, v65, v64, s90
    v_perm_b32 v120, v65, v64, s91
    v_perm_b32 v114, v67, v66, s90
    v_perm_b32 v122, v67, v66, s91
    v_perm_b32 v116, v69, v68, s90
    v_perm_b32 v124, v69, v68, s91
    v_perm_b32 v118, v71, v70, s90
    v_perm_b32 v126, v71, v70, s91
    buffer_load_dword v75, v2, s[56:59], s7 offen offset:3456 nt
    s_waitcnt vmcnt(3)
    s_mov_b32 s7, 304128
    buffer_load_dword v76, v2, s[56:59], s7 offen offset:0 nt
    s_waitcnt vmcnt(3)
    buffer_load_dword v77, v2, s[56:59], s7 offen offset:3456 nt
    s_waitcnt vmcnt(3)
    s_mov_b32 s7, 311040
    buffer_load_dword v78, v2, s[56:59], s7 offen offset:0 nt
    s_waitcnt vmcnt(3)
    buffer_load_dword v79, v2, s[56:59], s7 offen offset:3456 nt
    s_waitcnt vmcnt(3)
    s_mov_b32 s7, 55296
    buffer_load_dword v64, v2, s[56:59], s7 offen offset:0 nt
    s_waitcnt vmcnt(3)
    buffer_load_dword v65, v2, s[56:59], s7 offen offset:3456 nt
    s_waitcnt vmcnt(3)
    s_mov_b32 s7, 62208
    buffer_load_dword v66, v2, s[56:59], s7 offen offset:0 nt
    s_waitcnt vmcnt(3)
    v_perm_b32 v128, v73, v72, s90
    v_perm_b32 v136, v73, v72, s91
    v_perm_b32 v130, v75, v74, s90
    v_perm_b32 v138, v75, v74, s91
    v_perm_b32 v132, v77, v76, s90
    v_perm_b32 v140, v77, v76, s91
    v_perm_b32 v134, v79, v78, s90
    v_perm_b32 v142, v79, v78, s91
    buffer_load_dword v67, v2, s[56:59], s7 offen offset:3456 nt
    s_waitcnt vmcnt(3)
    s_mov_b32 s7, 331776
    buffer_load_dword v68, v2, s[56:59], s7 offen offset:0 nt
    s_waitcnt vmcnt(3)
    buffer_load_dword v69, v2, s[56:59], s7 offen offset:3456 nt
    s_waitcnt vmcnt(3)
    s_mov_b32 s7, 338688
    buffer_load_dword v70, v2, s[56:59], s7 offen offset:0 nt
    s_waitcnt vmcnt(3)
    buffer_load_dword v71, v2, s[56:59], s7 offen offset:3456 nt
    s_waitcnt vmcnt(3)
    s_mov_b32 s7, 82944
    buffer_load_dword v72, v2, s[56:59], s7 offen offset:0 nt
    s_waitcnt vmcnt(3)
    buffer_load_dword v73, v2, s[56:59], s7 offen offset:3456 nt
    s_waitcnt vmcnt(3)
    s_mov_b32 s7, 89856
    buffer_load_dword v74, v2, s[56:59], s7 offen offset:0 nt
    s_waitcnt vmcnt(3)
    v_perm_b32 v144, v65, v64, s90
    v_perm_b32 v152, v65, v64, s91
    v_perm_b32 v146, v67, v66, s90
    v_perm_b32 v154, v67, v66, s91
    v_perm_b32 v148, v69, v68, s90
    v_perm_b32 v156, v69, v68, s91
    v_perm_b32 v150, v71, v70, s90
    v_perm_b32 v158, v71, v70, s91
    buffer_load_dword v75, v2, s[56:59], s7 offen offset:3456 nt
    s_waitcnt vmcnt(3)
    s_mov_b32 s7, 359424
    buffer_load_dword v76, v2, s[56:59], s7 offen offset:0 nt
    s_waitcnt vmcnt(3)
    buffer_load_dword v77, v2, s[56:59], s7 offen offset:3456 nt
    s_waitcnt vmcnt(3)
    s_mov_b32 s7, 366336
    buffer_load_dword v78, v2, s[56:59], s7 offen offset:0 nt
    s_waitcnt vmcnt(3)
    buffer_load_dword v79, v2, s[56:59], s7 offen offset:3456 nt
    s_waitcnt vmcnt(3)
    s_mov_b32 s7, 110592
    buffer_load_dword v64, v2, s[56:59], s7 offen offset:0 nt
    s_waitcnt vmcnt(3)
    buffer_load_dword v65, v2, s[56:59], s7 offen offset:3456 nt
    s_waitcnt vmcnt(3)
    s_mov_b32 s7, 117504
    buffer_load_dword v66, v2, s[56:59], s7 offen offset:0 nt
    s_waitcnt vmcnt(3)
    v_perm_b32 v160, v73, v72, s90
    v_perm_b32 v168, v73, v72, s91
    v_perm_b32 v162, v75, v74, s90
    v_perm_b32 v170, v75, v74, s91
    v_perm_b32 v164, v77, v76, s90
    v_perm_b32 v172, v77, v76, s91
    v_perm_b32 v166, v79, v78, s90
    v_perm_b32 v174, v79, v78, s91
    buffer_load_dword v67, v2, s[56:59], s7 offen offset:3456 nt
    s_waitcnt vmcnt(3)
    s_mov_b32 s7, 387072
    buffer_load_dword v68, v2, s[56:59], s7 offen offset:0 nt
    s_waitcnt vmcnt(3)
    buffer_load_dword v69, v2, s[56:59], s7 offen offset:3456 nt
    s_waitcnt vmcnt(3)
    s_mov_b32 s7, 393984
    buffer_load_dword v70, v2, s[56:59], s7 offen offset:0 nt
    s_waitcnt vmcnt(3)
    buffer_load_dword v71, v2, s[56:59], s7 offen offset:3456 nt
    s_waitcnt vmcnt(3)
    s_mov_b32 s7, 0
    buffer_load_dword v72, v2, s[60:63], s7 offen offset:0 nt
    s_waitcnt vmcnt(3)
    buffer_load_dword v73, v2, s[60:63], s7 offen offset:3456 nt
    s_waitcnt vmcnt(3)
    s_mov_b32 s7, 6912
    buffer_load_dword v74, v2, s[60:63], s7 offen offset:0 nt
    s_waitcnt vmcnt(3)
    v_perm_b32 v176, v65, v64, s90
    v_perm_b32 v184, v65, v64, s91
    v_perm_b32 v178, v67, v66, s90
    v_perm_b32 v186, v67, v66, s91
    v_perm_b32 v180, v69, v68, s90
    v_perm_b32 v188, v69, v68, s91
    v_perm_b32 v182, v71, v70, s90
    v_perm_b32 v190, v71, v70, s91
    buffer_load_dword v75, v2, s[60:63], s7 offen offset:3456 nt
    s_waitcnt vmcnt(3)
    s_mov_b32 s7, 276480
    buffer_load_dword v76, v2, s[60:63], s7 offen offset:0 nt
    s_waitcnt vmcnt(3)
    buffer_load_dword v77, v2, s[60:63], s7 offen offset:3456 nt
    s_waitcnt vmcnt(3)
    s_mov_b32 s7, 283392
    buffer_load_dword v78, v2, s[60:63], s7 offen offset:0 nt
    s_waitcnt vmcnt(3)
    buffer_load_dword v79, v2, s[60:63], s7 offen offset:3456 nt
    s_waitcnt vmcnt(3)
    s_mov_b32 s7, 27648
    buffer_load_dword v64, v2, s[60:63], s7 offen offset:0 nt
    s_waitcnt vmcnt(3)
    buffer_load_dword v65, v2, s[60:63], s7 offen offset:3456 nt
    s_waitcnt vmcnt(3)
    s_mov_b32 s7, 34560
    buffer_load_dword v66, v2, s[60:63], s7 offen offset:0 nt
    s_waitcnt vmcnt(3)
    v_perm_b32 v113, v73, v72, s90
    v_perm_b32 v121, v73, v72, s91
    v_perm_b32 v115, v75, v74, s90
    v_perm_b32 v123, v75, v74, s91
    v_perm_b32 v117, v77, v76, s90
    v_perm_b32 v125, v77, v76, s91
    v_perm_b32 v119, v79, v78, s90
    v_perm_b32 v127, v79, v78, s91
    buffer_load_dword v67, v2, s[60:63], s7 offen offset:3456 nt
    s_waitcnt vmcnt(3)
    s_mov_b32 s7, 304128
    buffer_load_dword v68, v2, s[60:63], s7 offen offset:0 nt
    s_waitcnt vmcnt(3)
    buffer_load_dword v69, v2, s[60:63], s7 offen offset:3456 nt
    s_waitcnt vmcnt(3)
    s_mov_b32 s7, 311040
    buffer_load_dword v70, v2, s[60:63], s7 offen offset:0 nt
    s_waitcnt vmcnt(3)
    buffer_load_dword v71, v2, s[60:63], s7 offen offset:3456 nt
    s_waitcnt vmcnt(3)
    s_mov_b32 s7, 55296
    buffer_load_dword v72, v2, s[60:63], s7 offen offset:0 nt
    s_waitcnt vmcnt(3)
    buffer_load_dword v73, v2, s[60:63], s7 offen offset:3456 nt
    s_waitcnt vmcnt(3)
    s_mov_b32 s7, 62208
    buffer_load_dword v74, v2, s[60:63], s7 offen offset:0 nt
    s_waitcnt vmcnt(3)
    v_perm_b32 v129, v65, v64, s90
    v_perm_b32 v137, v65, v64, s91
    v_perm_b32 v131, v67, v66, s90
    v_perm_b32 v139, v67, v66, s91
    v_perm_b32 v133, v69, v68, s90
    v_perm_b32 v141, v69, v68, s91
    v_perm_b32 v135, v71, v70, s90
    v_perm_b32 v143, v71, v70, s91
    buffer_load_dword v75, v2, s[60:63], s7 offen offset:3456 nt
    s_waitcnt vmcnt(3)
    s_mov_b32 s7, 331776
    buffer_load_dword v76, v2, s[60:63], s7 offen offset:0 nt
    s_waitcnt vmcnt(3)
    buffer_load_dword v77, v2, s[60:63], s7 offen offset:3456 nt
    s_waitcnt vmcnt(3)
    s_mov_b32 s7, 338688
    buffer_load_dword v78, v2, s[60:63], s7 offen offset:0 nt
    s_waitcnt vmcnt(3)
    buffer_load_dword v79, v2, s[60:63], s7 offen offset:3456 nt
    s_waitcnt vmcnt(3)
    s_mov_b32 s7, 82944
    buffer_load_dword v64, v2, s[60:63], s7 offen offset:0 nt
    s_waitcnt vmcnt(3)
    buffer_load_dword v65, v2, s[60:63], s7 offen offset:3456 nt
    s_waitcnt vmcnt(3)
    s_mov_b32 s7, 89856
    buffer_load_dword v66, v2, s[60:63], s7 offen offset:0 nt
    s_waitcnt vmcnt(3)
    v_perm_b32 v145, v73, v72, s90
    v_perm_b32 v153, v73, v72, s91
    v_perm_b32 v147, v75, v74, s90
    v_perm_b32 v155, v75, v74, s91
    v_perm_b32 v149, v77, v76, s90
    v_perm_b32 v157, v77, v76, s91
    v_perm_b32 v151, v79, v78, s90
    v_perm_b32 v159, v79, v78, s91
    buffer_load_dword v67, v2, s[60:63], s7 offen offset:3456 nt
    s_waitcnt vmcnt(3)
    s_mov_b32 s7, 359424
    buffer_load_dword v68, v2, s[60:63], s7 offen offset:0 nt
    s_waitcnt vmcnt(3)
    buffer_load_dword v69, v2, s[60:63], s7 offen offset:3456 nt
    s_waitcnt vmcnt(3)
    s_mov_b32 s7, 366336
    buffer_load_dword v70, v2, s[60:63], s7 offen offset:0 nt
    s_waitcnt vmcnt(3)
    buffer_load_dword v71, v2, s[60:63], s7 offen offset:3456 nt
    s_waitcnt vmcnt(3)
    s_mov_b32 s7, 110592
    buffer_load_dword v72, v2, s[60:63], s7 offen offset:0 nt
    s_waitcnt vmcnt(3)
    buffer_load_dword v73, v2, s[60:63], s7 offen offset:3456 nt
    s_waitcnt vmcnt(3)
    s_mov_b32 s7, 117504
    buffer_load_dword v74, v2, s[60:63], s7 offen offset:0 nt
    s_waitcnt vmcnt(3)
    v_perm_b32 v161, v65, v64, s90
    v_perm_b32 v169, v65, v64, s91
    v_perm_b32 v163, v67, v66, s90
    v_perm_b32 v171, v67, v66, s91
    v_perm_b32 v165, v69, v68, s90
    v_perm_b32 v173, v69, v68, s91
    v_perm_b32 v167, v71, v70, s90
    v_perm_b32 v175, v71, v70, s91
    buffer_load_dword v75, v2, s[60:63], s7 offen offset:3456 nt
    s_waitcnt vmcnt(3)
    s_mov_b32 s7, 387072
    buffer_load_dword v76, v2, s[60:63], s7 offen offset:0 nt
    s_waitcnt vmcnt(3)
    buffer_load_dword v77, v2, s[60:63], s7 offen offset:3456 nt
    s_waitcnt vmcnt(3)
    s_mov_b32 s7, 393984
    buffer_load_dword v78, v2, s[60:63], s7 offen offset:0 nt
    s_waitcnt vmcnt(3)
    buffer_load_dword v79, v2, s[60:63], s7 offen offset:3456 nt
    s_waitcnt vmcnt(3)
    s_waitcnt vmcnt(2)
    s_waitcnt vmcnt(1)
    s_waitcnt vmcnt(0)
    v_perm_b32 v177, v73, v72, s90
    v_perm_b32 v185, v73, v72, s91
    v_perm_b32 v179, v75, v74, s90
    v_perm_b32 v187, v75, v74, s91
    v_perm_b32 v181, v77, v76, s90
    v_perm_b32 v189, v77, v76, s91
    v_perm_b32 v183, v79, v78, s90
    v_perm_b32 v191, v79, v78, s91
    s_cmp_lt_u32 s85, 40
    s_cselect_b32 s87, s76, 0
    s_cmp_lg_u32 s87, 3
    s_cbranch_scc1 L_pf2
    v_min_u32 v9, 53, v1
    v_lshlrev_b32 v9, 7, v9
    s_mov_b32 s7, 1572864
L_pf_233:
    buffer_load_dword v8, v9, s[40:43], s7 offen sc1
    s_waitcnt vmcnt(0)
    v_cmp_ne_u32 vcc, s77, v8
    s_nop 0
    s_cbranch_vccnz L_pf_233_r
L_pf_233_d:
L_pf2:
    s_mul_i32 s7, s76, 40
    v_mul_u32_u24 v8, 10, v7
    v_add3_u32 v8, v8, v6, s7
    v_and_b32 v4, 3, v8
    v_mul_u32_u24 v4, 7, v4
    v_lshrrev_b32 v4, v4, s77
    v_and_b32 v4, 0xffe, v4
    v_and_or_b32 v4, s77, 1, v4
    v_lshlrev_b32 v2, 4, v8
    v_lshlrev_b32 v3, 3, v8
    v_cmp_gt_u32 vcc, 10, v6
    v_add_u32 v5, 12288, v2
    v_mov_b32 v11, 19456
    v_cndmask_b32 v5, v11, v5, vcc
    buffer_load_dwordx2 v[46:47], v3, s[44:47], 0 offen
    buffer_load_dwordx2 v[44:45], v3, s[44:47], 0 offen offset:1280
    s_lshl_b32 s7, s76, 3
    s_add_u32 s7, s7, 4868
    v_and_b32 v8, 4, v1
    v_sub_u32 v50, s7, v8
    v_cmp_gt_u32 vcc, 16, v1
    s_nop 1
    v_cndmask_b32 v50, v11, v50, vcc
    v_mov_b32 v51, 4864
    s_lshl_b32 s7, s76, 8
    s_add_u32 s7, s7, 5120
    v_lshl_add_u32 v52, v6, 4, s7
    v_lshl_add_u32 v52, v7, 11, v52
    v_and_b32 v11, 7, v1
    v_lshl_add_u32 v8, v7, 3, v11
    v_lshlrev_b32 v8, 3, v8
    v_add_u32 v53, 5120, v8
    s_lshl_b32 s7, s76, 8
    s_add_u32 s7, s7, 1280
    v_lshl_add_u32 v54, v6, 4, s7
    v_mul_u32_u24 v8, 1280, v7
    v_sub_u32 v54, v54, v8
    v_and_b32 v8, 1, v11
    v_lshlrev_b32 v8, 4, v8
    v_mov_b32 v9, 0xffff
    v_lshlrev_b32 v8, v8, v9
    v_lshrrev_b32 v9, 1, v11
    v_cmp_eq_u32 vcc, 0, v9
    s_nop 1
    v_cndmask_b32 v12, 0, v8, vcc
    v_cmp_eq_u32 vcc, 1, v9
    s_nop 1
    v_cndmask_b32 v13, 0, v8, vcc
    v_cmp_eq_u32 vcc, 2, v9
    s_nop 1
    v_cndmask_b32 v14, 0, v8, vcc
    v_cmp_eq_u32 vcc, 3, v9
    s_nop 1
    v_cndmask_b32 v15, 0, v8, vcc
    v_and_b32 v12, 0x3f803f80, v12
    v_and_b32 v13, 0x3f803f80, v13
    v_and_b32 v14, 0x3f803f80, v14
    v_and_b32 v15, 0x3f803f80, v15
    v_mov_b32 v16, 0x3f803f80
    v_mov_b32 v17, 0x3f803f80
    v_mov_b32 v18, 0x3f803f80
    v_mov_b32 v19, 0x3f803f80
    v_mov_b32 v20, 0x3f803f80
    v_mov_b32 v21, 0x3f803f80
    v_mov_b32 v22, 0x3f803f80
    v_mov_b32 v23, 0x3f803f80
    v_mov_b32 v24, 0x3f803f80
    v_mov_b32 v25, 0x3f803f80
    v_mov_b32 v26, 0x3f803f80
    v_mov_b32 v27, 0x3f803f80
    v_mov_b32 v28, 0x3f803f80
    v_mov_b32 v29, 0x3f803f80
    v_mov_b32 v30, 0x3f803f80
    v_mov_b32 v31, 0x3f803f80
    v_mov_b32 v32, 0x3f803f80
    v_mov_b32 v33, 0x3f803f80
    v_mov_b32 v34, 0x3f803f80
    v_mov_b32 v35, 0x3f803f80
    v_lshrrev_b32 v8, 2, v1
    v_mul_u32_u24 v9, 2560, v8
    v_and_b32 v10, 3, v1
    v_lshl_add_u32 v55, v10, 4, v9
    s_lshl_b32 s7, s85, 6
    v_add_u32 v55, s7, v55
    v_cmp_gt_u32 vcc, 6, v8
    v_mov_b32 v10, 0x7ff00000
    s_nop 0
    v_cndmask_b32 v56, v10, v55, vcc
    v_and_b32 v8, 16, v1
    v_or_b32 v8, v8, v11
    v_lshrrev_b32 v9, 5, v1
    v_lshl_or_b32 v8, v9, 3, v8
    s_lshl_b32 s7, s85, 5
    v_add_u32 v8, s7, v8
    v_lshlrev_b32 v57, 1, v8
    v_lshlrev_b32 v58, 2, v8
    v_add_u32 v58, 12288, v58
    s_mov_b32 s80, 1310720
    s_mov_b32 s81, 1315840
    s_mov_b32 s82, 1320960
    s_mov_b32 s83, 1326080
    s_mov_b32 s50, 0x03ff03ff
    s_mov_b32 s51, 0x03ff03ff
    s_mov_b32 s4, 0x00ff00ff
    s_mov_b32 s5, 0x00ff00ff
    s_mov_b32 s88, 0xffffffff
    s_mov_b32 s89, 0x00000000
    s_mov_b32 s32, 0x7ff00000
    s_mov_b32 s33, 0x7ff00000
    s_mov_b32 s34, 0x7ff00000
    s_mov_b32 s35, 0x7ff00000
    s_mov_b32 s95, 0x7ff00000
    s_mov_b32 s97, 0x7ff00000
    s_mov_b32 s96, 0xbdd2d3e8
    v_mov_b32 v59, 0xc0135761
    s_waitcnt vmcnt(0)
    v_lshlrev_b32 v40, 16, v46
    v_and_b32 v41, 0xffff0000, v46
    v_lshlrev_b32 v42, 16, v47
    v_and_b32 v43, 0xffff0000, v47
    v_mov_b64 v[96:97], 0
    v_mov_b64 v[98:99], 0
    v_mov_b64 v[100:101], 0
    v_mov_b64 v[102:103], 0
L_lds_234:
    ds_read_b32 v8, v61 offset:4644
    s_waitcnt lgkmcnt(0)
    v_cmp_ne_u32 vcc, 1, v8
    s_nop 0
    s_cbranch_vccnz L_lds_234_r
L_lds_234_d:
    v_mov_b32 v0, 4644
L_ffn_b:
    ds_read_b32 v8, v0
    s_sub_u32 s79, s79, 1
    s_cbranch_scc1 L_ffn_b_x
L_ffn_b_y:
    s_waitcnt lgkmcnt(0)
    v_cmp_ne_u32 vcc, 1, v8
    s_nop 0
    s_and_b64 vcc, vcc, s[30:31]
    s_cbranch_vccnz L_ffn_b
L_h2_235:
    s_mov_b64 exec, s[50:51]
    buffer_load_dwordx4 v[64:67], v2, s[40:43], s80 offen offset:0 sc1
    buffer_load_dwordx4 v[68:71], v2, s[40:43], s80 offen offset:2560 sc1
    buffer_load_dwordx4 v[72:75], v2, s[40:43], s81 offen offset:0 sc1
    buffer_load_dwordx4 v[76:79], v2, s[40:43], s81 offen offset:2560 sc1
    buffer_load_dwordx4 v[80:83], v2, s[40:43], s82 offen offset:0 sc1
    buffer_load_dwordx4 v[84:87], v2, s[40:43], s82 offen offset:2560 sc1
    buffer_load_dwordx4 v[88:91], v2, s[40:43], s83 offen offset:0 sc1
    buffer_load_dwordx4 v[92:95], v2, s[40:43], s83 offen offset:2560 sc1
    s_waitcnt vmcnt(7)
    v_xor_b32 v64, v64, v4
    v_pk_add_f32 v[108:109], v[40:41], v[64:65]
    v_pk_add_f32 v[110:111], v[42:43], v[66:67]
    s_waitcnt vmcnt(6)
    v_xor_b32 v68, v68, v4
    v_pk_add_f32 v[108:109], v[108:109], v[68:69]
    v_pk_add_f32 v[110:111], v[110:111], v[70:71]
    v_or_b32 v8, v64, v68
    s_waitcnt vmcnt(5)
    v_xor_b32 v72, v72, v4
    v_pk_add_f32 v[108:109], v[108:109], v[72:73]
    v_pk_add_f32 v[110:111], v[110:111], v[74:75]
    s_waitcnt vmcnt(4)
    v_xor_b32 v76, v76, v4
    v_pk_add_f32 v[108:109], v[108:109], v[76:77]
    v_pk_add_f32 v[110:111], v[110:111], v[78:79]
    v_or3_b32 v8, v8, v72, v76
    s_waitcnt vmcnt(3)
    v_xor_b32 v80, v80, v4
    v_pk_add_f32 v[108:109], v[108:109], v[80:81]
    v_pk_add_f32 v[110:111], v[110:111], v[82:83]
    s_waitcnt vmcnt(2)
    v_xor_b32 v84, v84, v4
    v_pk_add_f32 v[108:109], v[108:109], v[84:85]
    v_pk_add_f32 v[110:111], v[110:111], v[86:87]
    v_or3_b32 v8, v8, v80, v84
    s_waitcnt vmcnt(1)
    v_xor_b32 v88, v88, v4
    v_pk_add_f32 v[108:109], v[108:109], v[88:89]
    v_pk_add_f32 v[110:111], v[110:111], v[90:91]
    s_waitcnt vmcnt(0)
    v_xor_b32 v92, v92, v4
    v_pk_add_f32 v[108:109], v[108:109], v[92:93]
    v_pk_add_f32 v[110:111], v[110:111], v[94:95]
    v_or3_b32 v8, v8, v88, v92
    v_and_b32 v8, 0xfff, v8
    v_cmp_ne_u32 vcc, 0, v8
    v_cvt_pk_bf16_f32 v10, v108, v109
    v_cvt_pk_bf16_f32 v11, v110, v111
    s_mov_b64 exec, -1
    v_mov_b32_dpp v16, v10 row_newbcast:0 row_mask:0xf bank_mask:0x5
    v_mov_b32_dpp v17, v11 row_newbcast:0 row_mask:0xf bank_mask:0x5
    v_mov_b32_dpp v18, v10 row_newbcast:1 row_mask:0xf bank_mask:0x5
    v_mov_b32_dpp v19, v11 row_newbcast:1 row_mask:0xf bank_mask:0x5
    s_cbranch_vccnz L_h2_235_r
L_h2_235_d:
    v_mov_b32_dpp v20, v10 row_newbcast:2 row_mask:0xf bank_mask:0x5
    v_mov_b32_dpp v21, v11 row_newbcast:2 row_mask:0xf bank_mask:0x5
    v_mfma_f32_16x16x32_bf16 v[104:107], v[16:19], v[16:19], 0
    v_mov_b32_dpp v22, v10 row_newbcast:3 row_mask:0xf bank_mask:0x5
    v_mov_b32_dpp v23, v11 row_newbcast:3 row_mask:0xf bank_mask:0x5
    v_smfmac_f32_16x16x64_bf16 v[96:99], v[16:19], v[112:119], v60
    v_mov_b32_dpp v24, v10 row_newbcast:4 row_mask:0xf bank_mask:0x5
    v_mov_b32_dpp v25, v11 row_newbcast:4 row_mask:0xf bank_mask:0x5
    v_smfmac_f32_16x16x64_bf16 v[100:103], v[16:19], v[120:127], v60
    v_mov_b32_dpp v26, v10 row_newbcast:5 row_mask:0xf bank_mask:0x5
    v_mov_b32_dpp v27, v11 row_newbcast:5 row_mask:0xf bank_mask:0x5
    v_mfma_f32_16x16x32_bf16 v[104:107], v[20:23], v[20:23], v[104:107]
    v_mov_b32_dpp v28, v10 row_newbcast:6 row_mask:0xf bank_mask:0x5
    v_mov_b32_dpp v29, v11 row_newbcast:6 row_mask:0xf bank_mask:0x5
    v_smfmac_f32_16x16x64_bf16 v[96:99], v[20:23], v[128:135], v60
    v_mov_b32_dpp v30, v10 row_newbcast:7 row_mask:0xf bank_mask:0x5
    v_mov_b32_dpp v31, v11 row_newbcast:7 row_mask:0xf bank_mask:0x5
    v_smfmac_f32_16x16x64_bf16 v[100:103], v[20:23], v[136:143], v60
    v_mov_b32_dpp v32, v10 row_newbcast:8 row_mask:0xf bank_mask:0x5
    v_mov_b32_dpp v33, v11 row_newbcast:8 row_mask:0xf bank_mask:0x5
    v_mfma_f32_16x16x32_bf16 v[104:107], v[24:27], v[24:27], v[104:107]
    v_mov_b32_dpp v34, v10 row_newbcast:9 row_mask:0xf bank_mask:0x5
    v_mov_b32_dpp v35, v11 row_newbcast:9 row_mask:0xf bank_mask:0x5
    v_smfmac_f32_16x16x64_bf16 v[96:99], v[24:27], v[144:151], v60
    ds_write_b128 v5, v[108:111]
    v_smfmac_f32_16x16x64_bf16 v[100:103], v[24:27], v[152:159], v60
    v_mov_b64 v[64:65], 0
    v_mov_b64 v[68:69], 0
    v_mfma_f32_16x16x32_bf16 v[104:107], v[28:31], v[28:31], v[104:107]
    v_mov_b64 v[72:73], 0
    v_mov_b64 v[76:77], 0
    v_smfmac_f32_16x16x64_bf16 v[96:99], v[28:31], v[160:167], v60
    v_mov_b64 v[80:81], 0
    v_mov_b64 v[84:85], 0
    v_smfmac_f32_16x16x64_bf16 v[100:103], v[28:31], v[168:175], v60
    v_mov_b64 v[88:89], 0
    v_mov_b64 v[92:93], 0
    v_mfma_f32_16x16x32_bf16 v[104:107], v[32:35], v[32:35], v[104:107]
    v_smfmac_f32_16x16x64_bf16 v[96:99], v[32:35], v[176:183], v60
    v_smfmac_f32_16x16x64_bf16 v[100:103], v[32:35], v[184:191], v60
    s_mov_b64 exec, s[88:89]
    s_nop 4
    ds_write_b32 v50, v104
    ds_write_b64 v52, v[96:97]
    ds_write_b64 v52, v[100:101] offset:8
    s_mov_b64 exec, -1
L_gr_236:
    ds_read_b128 v[104:107], v51
    ds_read_b128 v[108:111], v51 offset:16
    ds_read2_b64 v[96:99], v53 offset0:0 offset1:32
    ds_read2_b64 v[100:103], v53 offset0:64 offset1:96
    s_sub_u32 s79, s79, 1
    s_cbranch_scc1 L_gr_236_x
L_gr_236_y:
    s_cmp_eq_u32 s98, 0
    s_cbranch_scc1 L_cs
L_csd:
    s_waitcnt lgkmcnt(2)
    v_pk_add_f32 v[104:105], v[104:105], v[108:109]
    v_pk_add_f32 v[106:107], v[106:107], v[110:111]
    v_pk_add_f32 v[104:105], v[104:105], v[106:107]
    v_mul_f32 v104, s92, v104
    v_mul_f32 v105, s92, v105
    v_fma_f32 v105, -v104, v104, v105
    v_max_f32 v106, 0, v105
    v_add_f32 v106, s93, v106
    v_rsq_f32 v106, v106
    s_waitcnt lgkmcnt(0)
    v_pk_add_f32 v[96:97], v[96:97], v[100:101]
    v_pk_add_f32 v[98:99], v[98:99], v[102:103]
    v_pk_add_f32 v[96:97], v[96:97], v[98:99]
    v_pk_fma_f32 v[96:97], v[62:63], v[104:105], v[96:97] op_sel_hi:[1,0,1] neg_lo:[0,1,0] neg_hi:[0,1,0]
    v_add_f32 v105, v105, v96
    v_cmp_u_f32 vcc, v105, v97
    v_pk_mul_f32 v[96:97], v[96:97], v[106:107] op_sel_hi:[1,0]
    v_mul_f32 v98, v96, v96
    v_fma_f32 v98, v98, s96, v59
    v_mul_f32 v98, v98, v96
    v_exp_f32 v98, v98
    v_mul_f32 v96, v96, v97
    s_and_b64 vcc, vcc, s[30:31]
    s_cbranch_vccnz L_gr_236
    v_add_f32 v98, 1.0, v98
    v_rcp_f32 v98, v98
    ds_read_b32 v48, v58
    v_mul_f32 v96, v96, v98
    s_cmp_eq_u32 s98, 0
    s_nop 0
    v_mov_b32_dpp v97, v96 quad_perm:[1,1,3,3] row_mask:0xf bank_mask:0xf
    v_cvt_pk_bf16_f32 v96, v96, v97
    s_cbranch_scc1 L_keep
L_kept:
    s_cmp_lg_u32 s76, 0
    v_mov_b32_dpp v36, v96 row_newbcast:0 row_mask:0xf bank_mask:0x5
    v_mov_b32_dpp v37, v96 row_newbcast:2 row_mask:0xf bank_mask:0x5
    v_mov_b32_dpp v38, v96 row_newbcast:4 row_mask:0xf bank_mask:0x5
    v_mov_b32_dpp v39, v96 row_newbcast:6 row_mask:0xf bank_mask:0x5
    s_nop 1
    v_smfmac_f32_16x16x64_bf16 v[64:67], v[36:39], v[192:199], v60
    v_smfmac_f32_16x16x64_bf16 v[68:71], v[36:39], v[200:207], v60
    v_smfmac_f32_16x16x64_bf16 v[72:75], v[36:39], v[208:215], v60
    v_smfmac_f32_16x16x64_bf16 v[76:79], v[36:39], v[216:223], v60
    s_cbranch_scc1 L_dn3
    v_smfmac_f32_16x16x64_bf16 v[80:83], v[36:39], v[224:231], v60
    v_smfmac_f32_16x16x64_bf16 v[84:87], v[36:39], v[232:239], v60
    v_smfmac_f32_16x16x64_bf16 v[88:91], v[36:39], v[240:247], v60
    v_smfmac_f32_16x16x64_bf16 v[92:95], v[36:39], v[248:255], v60
L_dn3:
    s_mov_b32 exec_hi, 0
    s_nop 2
    v_cvt_pk_bf16_f32 v96, v64, v65
    v_cvt_pk_bf16_f32 v97, v68, v69
    v_cvt_pk_bf16_f32 v98, v72, v73
    v_cvt_pk_bf16_f32 v99, v76, v77
    buffer_store_dwordx4 v[96:99], v54, s[40:43], s95 offen offset:0 sc0 sc1
    s_cbranch_scc1 L_dn4
    v_cvt_pk_bf16_f32 v100, v80, v81
    v_cvt_pk_bf16_f32 v101, v84, v85
    v_cvt_pk_bf16_f32 v102, v88, v89
    v_cvt_pk_bf16_f32 v103, v92, v93
    buffer_store_dwordx4 v[100:103], v54, s[40:43], s95 offen offset:1024 sc0 sc1
L_dn4:
    s_mov_b64 exec, -1
    s_cmp_lg_u32 s87, 3
    s_cbranch_scc1 L_ffn_next
    s_sleep 12
L_h3_237:
    buffer_load_dwordx4 v[64:67], v55, s[40:43], s32 offen sc1
    buffer_load_dwordx4 v[68:71], v55, s[40:43], s33 offen sc1
    buffer_load_dwordx4 v[72:75], v55, s[40:43], s34 offen sc1
    buffer_load_dwordx4 v[76:79], v56, s[40:43], s35 offen sc1
    s_waitcnt vmcnt(3) lgkmcnt(0)
    v_mfma_f32_16x16x32_bf16 v[80:83], v[64:67], v[12:15], 0
    s_waitcnt vmcnt(2)
    v_mfma_f32_16x16x32_bf16 v[80:83], v[68:71], v[12:15], v[80:83]
    s_waitcnt vmcnt(1)
    v_mfma_f32_16x16x32_bf16 v[80:83], v[72:75], v[12:15], v[80:83]
    s_waitcnt vmcnt(0)
    v_mfma_f32_16x16x32_bf16 v[80:83], v[76:79], v[12:15], v[80:83]
    s_nop 7
    v_permlane32_swap_b32 v80, v81
    v_permlane32_swap_b32 v82, v83
    v_add_f32 v80, v80, v81
    v_add_f32 v82, v82, v83
    v_cmp_u_f32 vcc, v80, v82
    s_nop 0
    v_permlane16_swap_b32 v80, v82
    v_add_f32 v80, v80, v48
    v_add_f32 v80, v80, v82
    v_cvt_pk_bf16_f32 v80, v80, v80
    s_cbranch_vccnz L_h3_237_r
L_h3_237_d:
    s_mov_b64 exec, s[4:5]
    buffer_store_short v80, v57, s[68:71], s97 offen
    s_mov_b64 exec, -1
    s_cmp_lg_u32 s85, 0
    s_cbranch_scc1 L_ffn_next
    v_mov_b32 v8, s77
    s_mov_b64 exec, 1
    buffer_store_dword v8, v61, s[40:43], s97 offen
    s_mov_b64 exec, -1
L_ffn_next:
    s_cmp_lg_u32 s98, 0
    s_cbranch_scc1 L_ffn_end
    s_add_u32 s80, s80, 20480
    s_mov_b32 s32, 917504
    s_add_u32 s81, s81, 20480
    s_mov_b32 s33, 958464
    s_add_u32 s82, s82, 20480
    s_mov_b32 s34, 999424
    s_add_u32 s83, s83, 20480
    s_mov_b32 s35, 1040384
    s_mul_i32 s95, s85, 2560
    s_add_u32 s95, s95, 917504
    s_mov_b32 s97, 0
    s_mov_b32 s98, 1
    s_mov_b32 s88, 0xffff
    v_add_u32 v5, 2560, v5
    v_add_u32 v50, 128, v50
    v_add_u32 v51, 128, v51
    v_add_u32 v52, 1024, v52
    v_add_u32 v53, 1024, v53
    v_lshlrev_b32 v40, 16, v44
    v_and_b32 v41, 0xffff0000, v44
    v_lshlrev_b32 v42, 16, v45
    v_and_b32 v43, 0xffff0000, v45
    v_mov_b64 v[96:97], 0
    v_mov_b64 v[98:99], 0
    v_mov_b64 v[100:101], 0
    v_mov_b64 v[102:103], 0
L_lds_238:
    ds_read_b32 v8, v61 offset:4648
    s_waitcnt lgkmcnt(0)
    v_cmp_ne_u32 vcc, 1, v8
    s_nop 0
    s_cbranch_vccnz L_lds_238_r
L_lds_238_d:
    s_waitcnt vmcnt(0)
    s_mov_b32 s7, 0
    buffer_load_dwordx4 v[64:67], v49, s[64:67], s7 offen nt
    s_mov_b32 s7, 1280
    buffer_load_dwordx4 v[68:71], v49, s[64:67], s7 offen nt
    s_mov_b32 s7, 2560
    buffer_load_dwordx4 v[72:75], v49, s[64:67], s7 offen nt
    s_mov_b32 s7, 3840
    buffer_load_dwordx4 v[76:79], v49, s[64:67], s7 offen nt
    s_mov_b32 s7, 20480
    buffer_load_dwordx4 v[80:83], v49, s[64:67], s7 offen nt
    s_mov_b32 s7, 21760
    buffer_load_dwordx4 v[84:87], v49, s[64:67], s7 offen nt
    s_mov_b32 s7, 23040
    buffer_load_dwordx4 v[88:91], v49, s[64:67], s7 offen nt
    s_mov_b32 s7, 24320
    buffer_load_dwordx4 v[92:95], v49, s[64:67], s7 offen nt
    s_waitcnt vmcnt(6)
    v_perm_b32 v192, v68, v64, s90
    v_perm_b32 v193, v68, v64, s91
    v_perm_b32 v200, v69, v65, s90
    v_perm_b32 v201, v69, v65, s91
    v_perm_b32 v208, v70, v66, s90
    v_perm_b32 v209, v70, v66, s91
    v_perm_b32 v216, v71, v67, s90
    v_perm_b32 v217, v71, v67, s91
    s_waitcnt vmcnt(4)
    v_perm_b32 v194, v76, v72, s90
    v_perm_b32 v195, v76, v72, s91
    v_perm_b32 v202, v77, v73, s90
    v_perm_b32 v203, v77, v73, s91
    v_perm_b32 v210, v78, v74, s90
    v_perm_b32 v211, v78, v74, s91
    v_perm_b32 v218, v79, v75, s90
    v_perm_b32 v219, v79, v75, s91
    s_waitcnt vmcnt(2)
    v_perm_b32 v196, v84, v80, s90
    v_perm_b32 v197, v84, v80, s91
    v_perm_b32 v204, v85, v81, s90
    v_perm_b32 v205, v85, v81, s91
    v_perm_b32 v212, v86, v82, s90
    v_perm_b32 v213, v86, v82, s91
    v_perm_b32 v220, v87, v83, s90
    v_perm_b32 v221, v87, v83, s91
    s_waitcnt vmcnt(0)
    v_perm_b32 v198, v92, v88, s90
    v_perm_b32 v199, v92, v88, s91
    v_perm_b32 v206, v93, v89, s90
    v_perm_b32 v207, v93, v89, s91
    v_perm_b32 v214, v94, v90, s90
    v_perm_b32 v215, v94, v90, s91
    v_perm_b32 v222, v95, v91, s90
    v_perm_b32 v223, v95, v91, s91
    v_mov_b32 v0, 4632
    s_branch L_ffn_b
L_ffn_end:
L_exit:
    s_endpgm
L_pf_233_r:
    s_sleep 16
    s_sub_u32 s79, s79, 1
    s_cbranch_scc0 L_pf_233
    s_mov_b32 s79, 0
    s_branch L_pf_233_d
L_lds_234_r:
    s_sleep 8
    s_sub_u32 s79, s79, 1
    s_cbranch_scc0 L_lds_234
    s_mov_b32 s79, 0
    s_branch L_lds_234_d
L_ffn_b_x:
    s_mov_b32 s79, 0
    s_mov_b64 s[30:31], 0
    s_branch L_ffn_b_y
L_h2_235_r:
    s_cmp_lg_u32 s98, 0
    s_cbranch_scc1 L_h2_235_n
    s_sleep 16
L_h2_235_n:
    s_sub_u32 s79, s79, 1
    s_cbranch_scc0 L_h2_235
    s_mov_b32 s79, 0
    s_branch L_h2_235_d
L_gr_236_x:
    s_mov_b32 s79, 0
    s_mov_b64 s[30:31], 0
    s_branch L_gr_236_y
L_cs:
    v_add_u32 v8, 2048, v53
    ds_read2_b64 v[40:43], v8 offset0:0 offset1:32
    ds_read2_b64 v[8:11], v8 offset0:64 offset1:96
    s_waitcnt lgkmcnt(0)
    v_pk_add_f32 v[40:41], v[40:41], v[42:43]
    v_pk_add_f32 v[8:9], v[8:9], v[10:11]
    v_pk_add_f32 v[62:63], v[40:41], v[8:9]
    s_branch L_csd
L_keep:
    s_nop 0
    v_mov_b32_dpp v36, v96 row_newbcast:0 row_mask:0xf bank_mask:0xa
    v_mov_b32_dpp v37, v96 row_newbcast:2 row_mask:0xf bank_mask:0xa
    v_mov_b32_dpp v38, v96 row_newbcast:4 row_mask:0xf bank_mask:0xa
    v_mov_b32_dpp v39, v96 row_newbcast:6 row_mask:0xf bank_mask:0xa
    s_branch L_kept
L_h3_237_r:
    s_sub_u32 s79, s79, 1
    s_cbranch_scc0 L_h3_237
    s_mov_b32 s79, 0
    s_branch L_h3_237_d
L_lds_238_r:
    s_sleep 1
    s_sub_u32 s79, s79, 1
    s_cbranch_scc0 L_lds_238
    s_mov_b32 s79, 0
    s_branch L_lds_238_d
L_code_end:
.section .rodata,"a"
.p2align 6
.amdhsa_kernel sequential_preLN__mha_block_cached__geglu_ffn__decode_kernel
  .amdhsa_next_free_vgpr 256
  .amdhsa_next_free_sgpr 102
  .amdhsa_accum_offset 256
  .amdhsa_group_segment_fixed_size 0
  .amdhsa_kernarg_size 96
  .amdhsa_user_sgpr_count 2
  .amdhsa_user_sgpr_kernarg_segment_ptr 1
  .amdhsa_system_sgpr_workgroup_id_x 1
  .amdhsa_float_denorm_mode_32 3
.end_amdhsa_kernel
```
